```python
import torch

def _softmax(x, axis=-1):
    return torch.softmax(x, dim=axis)

def _gelu(x):
    return torch.nn.functional.gelu(x, approximate='tanh')

def _silu(x):
    return torch.nn.functional.silu(x)

def _sigmoid(x):
    return torch.sigmoid(x)

def _layernorm(x, axis=-1, eps=1e-05):
    m = x.mean(dim=axis, keepdim=True)
    v = x.var(dim=axis, keepdim=True, unbiased=False)
    return (x - m) / torch.sqrt(v + eps)

def _scatter_add(tgt, idx, src, axis=0):
    return tgt.clone().index_add_(axis, idx, src)

def _segment_sum(src, seg, n):
    out = torch.zeros((n,) + src.shape[1:], dtype=src.dtype)
    return out.index_add_(0, seg, src)

def _pad(x, pw):
    flat = tuple((v for pair in reversed(pw) for v in pair))
    return torch.nn.functional.pad(x, flat)
kernel_name = 'adaLN_cond__grouped_kv_mqa__glu_gated_geglu__prompt'

def setup_inputs():

    _w = lambda a: (lambda t: t.to(torch.bfloat16) if t.is_floating_point() else t)(torch.as_tensor(a))

    def _A_setup():
        B, S, D, H = (1, 2048, 640, 32)
        Dh = D // H
        return {'x': _w((lambda *s: torch.randn(*s, dtype=torch.bfloat16) * 0.05)(B, S, D)), 'wq': _w((lambda *s: torch.randn(*s, dtype=torch.bfloat16) * 0.05)(D, H * Dh)), 'wk': _w((lambda *s: torch.randn(*s, dtype=torch.bfloat16) * 0.05)(D, Dh)), 'wv': _w((lambda *s: torch.randn(*s, dtype=torch.bfloat16) * 0.05)(D, Dh)), 'wo': _w((lambda *s: torch.randn(*s, dtype=torch.bfloat16) * 0.05)(H * Dh, D))}
    _A_in = _A_setup()

    def _B_setup():
        B, S, Dm, Df = (1, 2048, 640, 1536)
        return {'x': _w((lambda *s: torch.randn(*s, dtype=torch.bfloat16) * 0.05)(B, S, Dm)), 'w_gate': _w((lambda *s: torch.randn(*s, dtype=torch.bfloat16) * 0.8)(Dm, Df) * Dm ** (-0.5)), 'w_up': _w((lambda *s: torch.randn(*s, dtype=torch.bfloat16) * 0.8)(Dm, Df) * Dm ** (-0.5)), 'w_down': _w((lambda *s: torch.randn(*s, dtype=torch.bfloat16) * 0.8)(Df, Dm) * Df ** (-0.5))}
    _B_in = _B_setup()
    return {'A_x': _A_in['x'], 'A_wq': _A_in['wq'], 'A_wk': _A_in['wk'], 'A_wv': _A_in['wv'], 'A_wo': _A_in['wo'], 'B_x': _B_in['x'], 'B_w_gate': _B_in['w_gate'], 'B_w_up': _B_in['w_up'], 'B_w_down': _B_in['w_down'], 'c': _w((lambda *s: torch.randn(*s, dtype=torch.bfloat16) * 0.1)(1, 640) * 8.0), 'w_mod': _w((lambda *s: torch.randn(*s, dtype=torch.bfloat16) * 0.1)(640, 6 * 640) * 640 ** (-0.5) * 8.0)}

def reference(A_x, A_wq, A_wk, A_wv, A_wo, B_x, B_w_gate, B_w_up, B_w_down, c, w_mod):

    def _A_ref(x, wq, wk, wv, wo):
        B, S, D = x.shape
        H = 32
        Dh = D // H
        q = (lambda x, *d: x.permute(*d))((x @ wq).reshape(B, S, H, Dh), 0, 2, 1, 3)
        k = x @ wk
        v = x @ wv
        scores = torch.einsum('bhqd,bkd->bhqk', q, k) * Dh ** (-0.5)
        p = _softmax(scores, axis=-1)
        o = torch.einsum('bhqk,bkd->bhqd', p, v)
        return (lambda x, *d: x.permute(*d))(o, 0, 2, 1, 3).reshape(B, S, H * Dh) @ wo

    def _B_ref(x, w_gate, w_up, w_down):
        g = torch.einsum('bsd,df->bsf', x, w_gate)
        u = torch.einsum('bsd,df->bsf', x, w_up)
        h = _gelu(g) * u
        return torch.einsum('bsf,fd->bsd', h, w_down)
    x = A_x
    mod = (_silu(c) @ w_mod).reshape(c.shape[0], 6, 1, -1)
    sa, ca, ga, sb, cb, gb = (mod[:, 0].clone(), mod[:, 1].clone(), mod[:, 2].clone(), mod[:, 3].clone(), mod[:, 4].clone(), mod[:, 5].clone())
    h = _layernorm(x, axis=-1) * (1 + ca) + sa
    x = x + ga * _A_ref(h, A_wq, A_wk, A_wv, A_wo)
    h = _layernorm(x, axis=-1) * (1 + cb) + sb
    x = x + gb * _B_ref(h, B_w_gate, B_w_up, B_w_down)
    return x
```

```asm
; @launch grid=(256,1,1) block=(256,1,1) lds=163840
.amdgcn_target "amdgcn-amd-amdhsa--gfx950"
.text
.globl adaLN_cond__grouped_kv_mqa__glu_gated_geglu__prompt_kernel
.p2align 8
.type adaLN_cond__grouped_kv_mqa__glu_gated_geglu__prompt_kernel,@function
adaLN_cond__grouped_kv_mqa__glu_gated_geglu__prompt_kernel:
    s_cmp_ge_u32 s2, 256
    s_cbranch_scc1 L_end
    s_load_dwordx16 s[4:19], s[0:1], 0
    s_load_dwordx8 s[20:27], s[0:1], 64
    s_load_dwordx2 s[28:29], s[0:1], 104
    s_getpc_b64 s[96:97]
L_pc:
    s_lshr_b32 s3, s2, 3
    s_lshl_b32 s3, s3, 11
    v_lshrrev_b32 v2, 6, v0
    v_and_b32 v0, 63, v0
    v_lshlrev_b32 v202, 9, v2
    v_lshl_add_u32 v202, v0, 7, v202
    v_add_u32 v202, s3, v202
    v_min_u32 v202, L_end - L_pc, v202
    v_mov_b32 v203, s97
    v_add_co_u32 v202, vcc, s96, v202
    s_nop 1
    v_addc_co_u32 v203, vcc, 0, v203, vcc
    s_mov_b64 exec, 15
    global_load_dword v244, v[202:203], off
    s_mov_b64 exec, -1
    v_readfirstlane_b32 s80, v2
    v_lshlrev_b32 v1, 4, v0
    s_and_b32 s3, s2, 7
    s_lshr_b32 s30, s2, 3
    s_lshr_b32 s81, s3, 1
    s_lshl_b32 s81, s81, 3
    s_lshr_b32 s31, s30, 2
    s_add_u32 s81, s81, s31
    s_and_b32 s82, s3, 1
    s_lshl_b32 s82, s82, 2
    s_and_b32 s31, s30, 3
    s_add_u32 s82, s82, s31
    s_lshr_b32 s31, s30, 3
    s_lshl_b32 s81, s3, 2
    s_add_u32 s81, s81, s31
    s_and_b32 s82, s30, 7
    s_lshl_b32 s83, s81, 3
    s_add_u32 s83, s83, s82
    s_mov_b32 s101, s2
    s_mul_i32 s64, s101, 3277
    s_lshr_b32 s64, s64, 16
    s_mul_i32 s65, s64, 20
    s_sub_u32 s65, s101, s65
    s_sub_u32 s3, s101, 80
    s_mul_i32 s2, s3, 1639
    s_lshr_b32 s2, s2, 16
    s_mul_i32 s66, s2, 40
    s_sub_u32 s66, s3, s66
    s_add_u32 s66, s66, 20
    s_cmp_ge_u32 s101, 80
    s_cselect_b32 s64, s2, s64
    s_cselect_b32 s65, s66, s65
    s_mul_i32 s66, s64, 160
    s_mul_i32 s67, s80, 40
    s_add_u32 s66, s66, s67
    v_lshrrev_b32 v2, 3, v0
    v_add_u32 v2, s66, v2
    v_lshlrev_b32 v3, 1, v2
    v_mul_u32_u24 v4, 7680, v2
    v_and_b32 v5, 7, v0
    v_lshlrev_b32 v5, 4, v5
    s_lshl_b32 s66, s65, 7
    v_add3_u32 v4, v4, v5, s66
    s_waitcnt lgkmcnt(0)
    s_mov_b32 s68, s22
    s_mov_b32 s69, s23
    s_mov_b32 s70, 1280
    s_mov_b32 s71, 0x20000
    s_mov_b32 s72, s24
    s_mov_b32 s73, s25
    s_mov_b32 s74, 4915200
    s_mov_b32 s75, 0x20000
    s_cmp_lt_u32 s101, 80
    s_cbranch_scc1 L_notouch_1
    s_cmp_ge_u32 s101, 240
    s_cbranch_scc1 L_touchkv_2
    s_and_b32 s3, s101, 3
    s_cmp_lg_u32 s3, s80
    s_cbranch_scc1 L_notouch_1
    s_mov_b32 s40, s6
    s_mov_b32 s41, s7
    s_mov_b32 s42, 819200
    s_mov_b32 s43, 0x20000
    s_sub_u32 s3, s101, 80
    s_lshr_b32 s2, s3, 3
    s_mul_i32 s2, s2, 40960
    s_and_b32 s3, s3, 7
    s_mul_i32 s3, s3, 160
    s_add_u32 s3, s3, s2
    v_mul_u32_u24 v200, 6554, v0
    v_lshrrev_b32 v200, 16, v200
    v_mul_u32_u24 v200, 1120, v200
    v_add3_u32 v200, v200, v1, s3
    s_mul_i32 s2, s80, 25600
    s_add_u32 m0, s2, 0
    s_nop 0
    buffer_load_dwordx4 v200, s[40:43], 0 offen  lds
    s_mov_b32 s89, 7680
    s_add_u32 m0, s2, 960
    s_nop 0
    buffer_load_dwordx4 v200, s[40:43], s89 offen  lds
    s_mov_b32 s89, 15360
    s_add_u32 m0, s2, 1920
    s_nop 0
    buffer_load_dwordx4 v200, s[40:43], s89 offen  lds
    s_mov_b32 s89, 23040
    s_add_u32 m0, s2, 2880
    s_nop 0
    buffer_load_dwordx4 v200, s[40:43], s89 offen  lds
    s_mov_b32 s89, 30720
    s_add_u32 m0, s2, 3840
    s_nop 0
    buffer_load_dwordx4 v200, s[40:43], s89 offen  lds
    s_mov_b64 exec, 0xfffff
    s_mov_b32 s89, 38400
    s_add_u32 m0, s2, 4800
    s_nop 0
    buffer_load_dwordx4 v200, s[40:43], s89 offen  lds
    s_mov_b64 exec, -1
    s_branch L_notouch_1
L_touchkv_2:
    s_mov_b32 s44, s8
    s_mov_b32 s45, s9
    s_mov_b32 s46, 25600
    s_mov_b32 s47, 0x20000
    s_mov_b32 s48, s10
    s_mov_b32 s49, s11
    s_mov_b32 s50, 25600
    s_mov_b32 s51, 0x20000
    s_lshr_b32 s3, s101, 3
    s_sub_u32 s3, s3, 30
    s_lshl_b32 s3, s3, 2
    s_add_u32 s3, s3, s80
    s_mul_i32 s3, s3, 3200
    v_lshlrev_b32 v200, 7, v0
    v_add_u32 v200, s3, v200
    s_mov_b64 exec, 0x1ffffff
    buffer_load_dword v244, v200, s[44:47], 0 offen
    buffer_load_dword v244, v200, s[48:51], 0 offen
    s_mov_b64 exec, -1
L_notouch_1:
    buffer_load_ushort v74, v3, s[68:71], 0 offen offset:0
    buffer_load_ushort v75, v3, s[68:71], 0 offen offset:16
    buffer_load_ushort v76, v3, s[68:71], 0 offen offset:32
    buffer_load_ushort v77, v3, s[68:71], 0 offen offset:48
    buffer_load_ushort v78, v3, s[68:71], 0 offen offset:64
    s_cmp_ge_u32 s101, 80
    s_cselect_b32 s66, 2130706432, 0
    s_cselect_b32 s67, 0, 2130706432
    v_add_u32 v7, s66, v4
    v_add_u32 v4, s67, v4
    buffer_load_dwordx4 v[96:99], v7, s[72:75], 0 offen offset:0
    s_mov_b32 s89, 61440
    buffer_load_dwordx4 v[100:103], v7, s[72:75], s89 offen offset:0
    s_mov_b32 s89, 122880
    buffer_load_dwordx4 v[104:107], v7, s[72:75], s89 offen offset:0
    s_mov_b32 s89, 184320
    buffer_load_dwordx4 v[108:111], v7, s[72:75], s89 offen offset:0
    s_mov_b32 s89, 245760
    buffer_load_dwordx4 v[112:115], v7, s[72:75], s89 offen offset:0
    s_mov_b32 s32, s28
    s_mov_b32 s33, s29
    s_mov_b32 s34, 27262976
    s_mov_b32 s35, 0x20000
    s_load_dword s85, s[28:29], 0
    s_mov_b32 s36, s4
    s_mov_b32 s37, s5
    s_mov_b32 s38, 2621440
    s_mov_b32 s39, 0x20000
    s_mov_b32 s44, s8
    s_mov_b32 s45, s9
    s_mov_b32 s46, 25600
    s_mov_b32 s47, 0x20000
    s_mov_b32 s48, s10
    s_mov_b32 s49, s11
    s_mov_b32 s50, 25600
    s_mov_b32 s51, 0x20000
    s_mov_b32 s40, s6
    s_mov_b32 s41, s7
    s_mov_b32 s42, 819200
    s_mov_b32 s43, 0x20000
    s_mov_b32 s56, s16
    s_mov_b32 s57, s17
    s_mov_b32 s58, 1966080
    s_mov_b32 s59, 0x20000
    s_mov_b32 s60, s18
    s_mov_b32 s61, s19
    s_mov_b32 s62, 1966080
    s_mov_b32 s63, 0x20000
    s_mov_b32 s76, s26
    s_mov_b32 s77, s27
    s_mov_b32 s78, 2621440
    s_mov_b32 s79, 0x20000
    v_accvgpr_write_b32 a238, v4
    s_add_u32 s26, s80, s82
    s_and_b32 s26, s26, 3
    s_mul_i32 s3, s83, 768
    s_add_u32 s3, s3, 589824
    v_and_b32 v36, 15, v0
    v_lshrrev_b32 v37, 4, v0
    s_mov_b64 s[90:91], 0
    s_cmp_eq_u32 s80, 1
    s_cbranch_scc1 L_kvw1_4
    s_cmp_eq_u32 s80, 2
    s_cbranch_scc1 L_kvw2_5
    s_cmp_eq_u32 s80, 3
    s_cbranch_scc1 L_kvw3_6
    v_lshrrev_b32 v38, 1, v37
    v_lshlrev_b32 v38, 7, v38
    v_lshl_add_u32 v38, v36, 4, v38
    v_and_b32 v37, 1, v37
    v_lshl_add_u32 v38, v37, 3, v38
    v_cmp_gt_u32 vcc, 8, v36
    s_branch L_kvd_7
L_kvw1_4:
    s_bfe_u32 s2, s83, 0x10002
    s_mul_i32 s2, s2, 3064
    s_sub_u32 s2, 640, s2
    v_lshl_add_u32 v38, v0, 4, s2
    v_lshlrev_b32 v39, 3, v0
    v_add_u32 v39, 448, v39
    v_cmp_gt_u32 vcc, 8, v0
    s_nop 1
    v_cndmask_b32 v38, v39, v38, vcc
    s_mov_b64 vcc, 0xf00ff
    s_mov_b64 s[90:91], 0xf0000
    s_branch L_kvd_7
L_kvw2_5:
    v_lshlrev_b32 v38, 4, v36
    v_lshl_add_u32 v38, v37, 3, v38
    v_add_u32 v38, 256, v38
    s_mov_b32 vcc_lo, -1
    s_mov_b32 vcc_hi, 0
    s_branch L_kvd_7
L_kvw3_6:
    v_lshlrev_b32 v38, 4, v36
    v_lshl_add_u32 v38, v37, 3, v38
    v_add_u32 v38, 512, v38
    s_mov_b64 vcc, 0xf000f
L_kvd_7:
    v_mov_b32 v39, 2130706432
    v_cndmask_b32 v38, v39, v38, vcc
    v_add_u32 v38, s3, v38
    v_mov_b32 v39, 0x3f803f80
    v_cmp_gt_u32 vcc, 18, v0
    s_nop 1
    v_cndmask_b32 v39, 0, v39, vcc
    v_accvgpr_write_b32 a200, v38
    v_accvgpr_write_b32 a201, v39
    s_lshl_b32 s3, s81, 12
    s_add_u32 s3, s3, 7602176
    s_lshl_b32 s2, s80, 10
    s_lshl_b32 s66, s82, 7
    s_add_u32 s3, s3, s2
    s_add_u32 s3, s3, s66
    v_mov_b32 v38, s3
    v_accvgpr_write_b32 a202, v38
    s_mul_i32 s66, s80, 6400
    v_add_u32 v12, s66, v1
    s_mul_i32 s99, s80, 12864
    s_add_u32 s99, s99, 102400
    s_mul_i32 s98, s80, 25600
    s_mul_i32 s3, s80, 160
    s_mul_i32 s2, s80, 1280
    s_add_u32 s2, s2, 157440
    v_lshlrev_b32 v13, 1, v0
    s_add_u32 s28, s3, 640
    v_add_u32 v4, s28, v13
    s_add_u32 s29, s3, 768
    s_sub_u32 s30, s3, 32
    v_mov_b32 v14, s30
    v_mov_b32 v15, s29
    v_cmp_gt_u32 vcc, 16, v0
    s_nop 1
    v_cndmask_b32 v14, v14, v15, vcc
    v_add_u32 v5, v14, v13
    v_lshl_add_u32 v8, v0, 3, s2
    v_add_u32 v9, 512, v8
    v_min_u32 v14, 31, v0
    s_add_u32 s28, s3, 96
    v_lshl_add_u32 v6, v14, 1, s28
    s_add_u32 s2, s2, 1024
    v_lshl_add_u32 v10, v14, 3, s2
    v_lshlrev_b32 v4, 3, v4
    v_add_u32 v4, 65536, v4
    v_lshlrev_b32 v5, 3, v5
    v_add_u32 v5, 65536, v5
    v_lshlrev_b32 v6, 3, v6
    v_add_u32 v6, 65536, v6
    v_and_b32 v13, 15, v0
    s_and_b32 s3, s26, 1
    s_lshl_b32 s3, s3, 4
    v_add_u32 v13, s3, v13
    s_lshr_b32 s3, s26, 1
    s_mul_i32 s3, s3, 5120
    s_add_u32 s3, s3, 102400
    v_lshrrev_b32 v14, 4, v0
    v_lshlrev_b32 v14, 4, v14
    v_lshlrev_b32 v38, 4, v13
    v_lshlrev_b32 v39, 3, v13
    v_add_u32 v38, s3, v38
    v_add_u32 v39, s3, v39
    s_mov_b32 s96, 524288
    s_mov_b32 s97, 34079232
    v_lshrrev_b64 v[36:37], v14, s[96:97]
    v_cmp_gt_i16 vcc, 0, v36
    v_and_b32 v36, 0x7fff, v36
    s_nop 0
    v_cndmask_b32 v15, v38, v39, vcc
    v_add_u32 v15, v15, v36
    v_accvgpr_write_b32 a247, v15
    s_mov_b32 s96, 83919872
    s_mov_b32 s97, 117441800
    v_lshrrev_b64 v[36:37], v14, s[96:97]
    v_cmp_gt_i16 vcc, 0, v36
    v_and_b32 v36, 0x7fff, v36
    s_nop 0
    v_cndmask_b32 v15, v38, v39, vcc
    v_add_u32 v15, v15, v36
    v_accvgpr_write_b32 a248, v15
    s_mov_b32 s96, 2298480392
    s_mov_b32 s97, 168299008
    v_lshrrev_b64 v[36:37], v14, s[96:97]
    v_cmp_gt_i16 vcc, 0, v36
    v_and_b32 v36, 0x7fff, v36
    s_nop 0
    v_cndmask_b32 v15, v38, v39, vcc
    v_add_u32 v15, v15, v36
    v_accvgpr_write_b32 a249, v15
    s_mov_b32 s96, 201853952
    s_mov_b32 s97, 251694592
    v_lshrrev_b64 v[36:37], v14, s[96:97]
    v_cmp_gt_i16 vcc, 0, v36
    v_and_b32 v36, 0x7fff, v36
    s_nop 0
    v_cndmask_b32 v15, v38, v39, vcc
    v_add_u32 v15, v15, v36
    v_accvgpr_write_b32 a250, v15
    s_mov_b32 s96, 285216520
    s_mov_b32 s97, 2466255112
    v_lshrrev_b64 v[36:37], v14, s[96:97]
    v_cmp_gt_i16 vcc, 0, v36
    v_and_b32 v36, 0x7fff, v36
    s_nop 0
    v_cndmask_b32 v15, v38, v39, vcc
    v_add_u32 v15, v15, v36
    v_accvgpr_write_b32 a251, v15
    s_lshl_b32 s3, s81, 12
    s_lshl_b32 s2, s80, 10
    s_add_u32 s3, s3, s2
    s_add_u32 s3, s3, 7602176
    v_and_b32 v200, 7, v0
    v_lshl_add_u32 v200, v200, 7, s3
    v_lshrrev_b32 v201, 3, v0
    v_lshl_add_u32 v200, v201, 17, v200
    s_mov_b64 exec, 0xff
    buffer_load_dword v244, v200, s[32:35], 0 offen offset:0 sc1
    s_mov_b64 exec, -1
    v_add_u32 v200, 0x20000, v200
    v_accvgpr_write_b32 a231, v200
    s_mul_i32 s3, s82, 20
    s_mul_i32 s2, s26, 5
    s_add_u32 s3, s3, s2
    s_lshl_b32 s3, s3, 7
    s_add_u32 s3, s3, 950272
    v_min_u32 v200, 4, v0
    v_lshl_add_u32 v200, v200, 7, s3
    s_lshr_b32 s3, s101, 3
    s_lshl_b32 s3, s3, 2
    s_add_u32 s3, s3, s80
    s_mul_i32 s3, s3, 3
    s_sub_u32 s3, s3, 5
    v_add_u32 v201, s3, v0
    v_min_u32 v201, 319, v201
    v_mul_u32_u24 v202, 820, v201
    v_lshrrev_b32 v202, 16, v202
    v_mul_u32_u24 v202, 20480, v202
    v_lshl_add_u32 v201, v201, 7, v202
    v_add_u32 v201, 65536, v201
    v_cmp_gt_u32 vcc, 5, v0
    s_nop 1
    v_cndmask_b32 v200, v201, v200, vcc
    s_mov_b64 exec, 0xff
    buffer_load_dword v244, v200, s[32:35], 0 offen offset:0 sc1
    s_mov_b64 exec, -1
    s_mul_i32 s66, s83, 10240
    s_mul_i32 s67, s80, 320
    s_add_u32 s66, s66, s67
    s_mul_i32 s25, s80, 25600
    v_add_u32 v117, 0, v0
    v_mul_u32_u24 v118, 3277, v117
    v_lshrrev_b32 v118, 16, v118
    v_mul_u32_u24 v118, 960, v118
    v_lshl_add_u32 v117, v117, 4, v118
    v_add_u32 v117, s66, v117
    v_add_u32 v119, 64, v0
    v_mul_u32_u24 v118, 3277, v119
    v_lshrrev_b32 v118, 16, v118
    v_mul_u32_u24 v118, 960, v118
    v_lshl_add_u32 v119, v119, 4, v118
    v_add_u32 v119, s66, v119
    v_add_u32 v120, 128, v0
    v_mul_u32_u24 v118, 3277, v120
    v_lshrrev_b32 v118, 16, v118
    v_mul_u32_u24 v118, 960, v118
    v_lshl_add_u32 v120, v120, 4, v118
    v_add_u32 v120, s66, v120
    s_add_u32 m0, s25, 8192
    s_nop 0
    buffer_load_dwordx4 v117, s[36:39], 0 offen  lds
    s_add_u32 m0, s25, 9216
    s_nop 0
    buffer_load_dwordx4 v119, s[36:39], 0 offen  lds
    s_mov_b32 exec_lo, -1
    s_mov_b32 exec_hi, 0x0
    s_add_u32 m0, s25, 10240
    s_nop 0
    buffer_load_dwordx4 v120, s[36:39], 0 offen  lds
    s_mov_b64 exec, -1
    v_and_b32 v13, 7, v0
    v_mul_u32_u24 v13, 320, v13
    v_lshrrev_b32 v118, 4, v0
    v_lshl_add_u32 v13, v118, 4, v13
    s_add_u32 s67, s25, 8192
    v_add_u32 v118, s67, v13
    v_add_u32 v36, 0, v0
    v_mul_u32_u24 v37, 6554, v36
    v_lshrrev_b32 v37, 16, v37
    v_mul_u32_u24 v13, 10, v37
    v_sub_u32 v36, v36, v13
    v_lshlrev_b32 v126, 4, v36
    v_bfe_u32 v13, v37, 2, 2
    v_lshlrev_b32 v13, 3, v13
    v_lshrrev_b32 v14, 4, v37
    v_lshl_add_u32 v13, v14, 2, v13
    v_and_b32 v37, 3, v37
    v_add_u32 v121, v13, v37
    v_add_u32 v36, 64, v0
    v_mul_u32_u24 v37, 6554, v36
    v_lshrrev_b32 v37, 16, v37
    v_mul_u32_u24 v13, 10, v37
    v_sub_u32 v36, v36, v13
    v_lshlrev_b32 v127, 4, v36
    v_bfe_u32 v13, v37, 2, 2
    v_lshlrev_b32 v13, 3, v13
    v_lshrrev_b32 v14, 4, v37
    v_lshl_add_u32 v13, v14, 2, v13
    v_and_b32 v37, 3, v37
    v_add_u32 v122, v13, v37
    v_add_u32 v36, 128, v0
    v_mul_u32_u24 v37, 6554, v36
    v_lshrrev_b32 v37, 16, v37
    v_mul_u32_u24 v13, 10, v37
    v_sub_u32 v36, v36, v13
    v_lshlrev_b32 v128, 4, v36
    v_bfe_u32 v13, v37, 2, 2
    v_lshlrev_b32 v13, 3, v13
    v_lshrrev_b32 v14, 4, v37
    v_lshl_add_u32 v13, v14, 2, v13
    v_and_b32 v37, 3, v37
    v_add_u32 v123, v13, v37
    v_add_u32 v36, 192, v0
    v_mul_u32_u24 v37, 6554, v36
    v_lshrrev_b32 v37, 16, v37
    v_mul_u32_u24 v13, 10, v37
    v_sub_u32 v36, v36, v13
    v_lshlrev_b32 v129, 4, v36
    v_bfe_u32 v13, v37, 2, 2
    v_lshlrev_b32 v13, 3, v13
    v_lshrrev_b32 v14, 4, v37
    v_lshl_add_u32 v13, v14, 2, v13
    v_and_b32 v37, 3, v37
    v_add_u32 v124, v13, v37
    v_add_u32 v36, 256, v0
    v_mul_u32_u24 v37, 6554, v36
    v_lshrrev_b32 v37, 16, v37
    v_mul_u32_u24 v13, 10, v37
    v_sub_u32 v36, v36, v13
    v_lshlrev_b32 v130, 4, v36
    v_bfe_u32 v13, v37, 2, 2
    v_lshlrev_b32 v13, 3, v13
    v_lshrrev_b32 v14, 4, v37
    v_lshl_add_u32 v13, v14, 2, v13
    v_and_b32 v37, 3, v37
    v_add_u32 v125, v13, v37
    s_mul_i32 s3, s83, 3
    s_add_u32 s3, s3, s80
    s_cmp_eq_u32 s80, 3
    s_cselect_b32 s3, 1000, s3
    s_cmp_ge_u32 s3, 384
    s_cselect_b32 s52, s12, s20
    s_cselect_b32 s53, s13, s21
    s_mov_b32 s54, 1966080
    s_cselect_b32 s54, 819200, s54
    s_mov_b32 s55, 0x20000
    s_cselect_b32 s2, 384, 0
    s_sub_u32 s2, s3, s2
    s_lshr_b32 s66, s2, 3
    s_and_b32 s2, s2, 7
    s_cmp_ge_u32 s3, 384
    s_cbranch_scc1 L_iswo_8
    s_mul_i32 s87, s2, 48
    s_add_u32 s87, s87, s66
    s_mul_i32 s87, s87, 5120
    s_add_u32 s87, s87, 23068672
    s_lshl_b32 s67, s66, 5
    v_and_b32 v37, 0x13, v121
    v_bfe_u32 v38, v121, 3, 1
    v_lshl_add_u32 v37, v38, 2, v37
    v_bfe_u32 v38, v121, 2, 1
    v_lshl_add_u32 v37, v38, 3, v37
    v_add_u32 v121, s67, v37
    v_and_b32 v37, 0x13, v122
    v_bfe_u32 v38, v122, 3, 1
    v_lshl_add_u32 v37, v38, 2, v37
    v_bfe_u32 v38, v122, 2, 1
    v_lshl_add_u32 v37, v38, 3, v37
    v_add_u32 v122, s67, v37
    v_and_b32 v37, 0x13, v123
    v_bfe_u32 v38, v123, 3, 1
    v_lshl_add_u32 v37, v38, 2, v37
    v_bfe_u32 v38, v123, 2, 1
    v_lshl_add_u32 v37, v38, 3, v37
    v_add_u32 v123, s67, v37
    v_and_b32 v37, 0x13, v124
    v_bfe_u32 v38, v124, 3, 1
    v_lshl_add_u32 v37, v38, 2, v37
    v_bfe_u32 v38, v124, 2, 1
    v_lshl_add_u32 v37, v38, 3, v37
    v_add_u32 v124, s67, v37
    v_and_b32 v37, 0x13, v125
    v_bfe_u32 v38, v125, 3, 1
    v_lshl_add_u32 v37, v38, 2, v37
    v_bfe_u32 v38, v125, 2, 1
    v_lshl_add_u32 v37, v38, 3, v37
    v_add_u32 v125, s67, v37
    s_branch L_pdd_9
L_iswo_8:
    s_mul_i32 s87, s2, 20
    s_add_u32 s87, s87, s66
    s_mul_i32 s87, s87, 5120
    s_add_u32 s87, s87, 25165824
    s_and_b32 s67, s66, 7
    s_lshl_b32 s67, s67, 2
    s_lshr_b32 s28, s66, 3
    s_add_u32 s67, s67, s28
    s_sub_u32 s28, s66, 16
    s_lshl_b32 s28, s28, 3
    s_cmp_ge_u32 s66, 16
    s_cbranch_scc1 L_isex_10
    v_bfe_u32 v37, v121, 4, 1
    v_lshl_add_u32 v37, v37, 1, s67
    v_mul_u32_u24 v37, 20, v37
    v_bfe_u32 v38, v121, 3, 1
    v_lshl_add_u32 v37, v38, 2, v37
    v_bfe_u32 v38, v121, 2, 1
    v_lshl_add_u32 v37, v38, 3, v37
    v_and_b32 v38, 3, v121
    v_add_u32 v121, v37, v38
    v_bfe_u32 v37, v122, 4, 1
    v_lshl_add_u32 v37, v37, 1, s67
    v_mul_u32_u24 v37, 20, v37
    v_bfe_u32 v38, v122, 3, 1
    v_lshl_add_u32 v37, v38, 2, v37
    v_bfe_u32 v38, v122, 2, 1
    v_lshl_add_u32 v37, v38, 3, v37
    v_and_b32 v38, 3, v122
    v_add_u32 v122, v37, v38
    v_bfe_u32 v37, v123, 4, 1
    v_lshl_add_u32 v37, v37, 1, s67
    v_mul_u32_u24 v37, 20, v37
    v_bfe_u32 v38, v123, 3, 1
    v_lshl_add_u32 v37, v38, 2, v37
    v_bfe_u32 v38, v123, 2, 1
    v_lshl_add_u32 v37, v38, 3, v37
    v_and_b32 v38, 3, v123
    v_add_u32 v123, v37, v38
    v_bfe_u32 v37, v124, 4, 1
    v_lshl_add_u32 v37, v37, 1, s67
    v_mul_u32_u24 v37, 20, v37
    v_bfe_u32 v38, v124, 3, 1
    v_lshl_add_u32 v37, v38, 2, v37
    v_bfe_u32 v38, v124, 2, 1
    v_lshl_add_u32 v37, v38, 3, v37
    v_and_b32 v38, 3, v124
    v_add_u32 v124, v37, v38
    v_bfe_u32 v37, v125, 4, 1
    v_lshl_add_u32 v37, v37, 1, s67
    v_mul_u32_u24 v37, 20, v37
    v_bfe_u32 v38, v125, 3, 1
    v_lshl_add_u32 v37, v38, 2, v37
    v_bfe_u32 v38, v125, 2, 1
    v_lshl_add_u32 v37, v38, 3, v37
    v_and_b32 v38, 3, v125
    v_add_u32 v125, v37, v38
    s_branch L_pdd_9
L_isex_10:
    v_lshrrev_b32 v37, 2, v121
    v_add_u32 v37, s28, v37
    v_mul_u32_u24 v37, 20, v37
    v_and_b32 v38, 3, v121
    v_add3_u32 v121, v37, v38, 16
    v_lshrrev_b32 v37, 2, v122
    v_add_u32 v37, s28, v37
    v_mul_u32_u24 v37, 20, v37
    v_and_b32 v38, 3, v122
    v_add3_u32 v122, v37, v38, 16
    v_lshrrev_b32 v37, 2, v123
    v_add_u32 v37, s28, v37
    v_mul_u32_u24 v37, 20, v37
    v_and_b32 v38, 3, v123
    v_add3_u32 v123, v37, v38, 16
    v_lshrrev_b32 v37, 2, v124
    v_add_u32 v37, s28, v37
    v_mul_u32_u24 v37, 20, v37
    v_and_b32 v38, 3, v124
    v_add3_u32 v124, v37, v38, 16
    v_lshrrev_b32 v37, 2, v125
    v_add_u32 v37, s28, v37
    v_mul_u32_u24 v37, 20, v37
    v_and_b32 v38, 3, v125
    v_add3_u32 v125, v37, v38, 16
L_pdd_9:
    s_mul_i32 s67, s2, 160
    s_cmp_ge_u32 s3, 544
    s_cselect_b32 s66, 2130706432, 0
    s_add_u32 s67, s67, s66
    s_add_u32 s87, s87, s66
    v_mul_u32_u24 v37, 1280, v121
    v_add3_u32 v37, v37, v126, s67
    v_accvgpr_write_b32 a232, v37
    v_mul_u32_u24 v37, 1280, v122
    v_add3_u32 v37, v37, v127, s67
    v_accvgpr_write_b32 a233, v37
    v_mul_u32_u24 v37, 1280, v123
    v_add3_u32 v37, v37, v128, s67
    v_accvgpr_write_b32 a234, v37
    v_mul_u32_u24 v37, 1280, v124
    v_add3_u32 v37, v37, v129, s67
    v_accvgpr_write_b32 a235, v37
    v_mul_u32_u24 v37, 1280, v125
    v_add3_u32 v37, v37, v130, s67
    v_accvgpr_write_b32 a236, v37
    s_mul_i32 s86, s83, 2731
    s_lshr_b32 s86, s86, 16
    s_mul_i32 s2, s86, 24
    s_sub_u32 s2, s83, s2
    s_lshl_b32 s66, s86, 2
    s_add_u32 s66, s66, s80
    s_lshl_b32 s66, s66, 4
    v_lshrrev_b32 v37, 3, v0
    v_add_u32 v37, s66, v37
    v_mul_u32_u24 v37, 3072, v37
    v_and_b32 v38, 7, v0
    v_lshlrev_b32 v38, 4, v38
    s_lshl_b32 s67, s2, 7
    v_add3_u32 v37, v37, v38, s67
    v_accvgpr_write_b32 a237, v37
    s_mul_i32 s66, s82, 80
    s_lshl_b32 s67, s86, 6
    v_min_u32 v13, 45, v0
    s_mul_i32 s28, s80, 30
    v_add_u32 v14, s28, v13
    v_mul_u32_u24 v15, 1639, v14
    v_lshrrev_b32 v15, 16, v15
    v_mul_u32_u24 v36, 40, v15
    v_sub_u32 v36, v14, v36
    v_lshlrev_b32 v36, 1, v36
    v_cmp_eq_u32 s[90:91], 1, v15
    v_mov_b32 v37, 1280
    v_mov_b32 v38, 2560
    v_cndmask_b32 v37, v37, v38, s[90:91]
    v_mov_b32 v38, 3200
    v_cmp_eq_u32 vcc, 2, v15
    s_nop 1
    v_cndmask_b32 v37, v37, v38, vcc
    v_add3_u32 v72, v36, v37, s66
    v_lshlrev_b32 v14, 3, v14
    v_add_u32 v73, 155904, v14
    v_cndmask_b32 v39, 0, 1.0, s[90:91]
    s_lshl_b32 s28, s80, 4
    s_sub_u32 s28, s28, 30
    v_add_u32 v14, s28, v13
    v_and_b32 v15, 31, v14
    v_lshlrev_b32 v15, 1, v15
    v_mov_b32 v37, 2560
    v_mov_b32 v38, 1920
    v_cmp_le_u32 s[94:95], 32, v14
    s_nop 1
    v_cndmask_b32 v37, v37, v38, s[94:95]
    v_add3_u32 v15, v15, v37, s67
    v_lshlrev_b32 v14, 3, v14
    v_add_u32 v14, 156864, v14
    v_cndmask_b32 v36, 1.0, 0, s[94:95]
    v_cmp_le_u32 vcc, 30, v13
    s_nop 1
    v_cndmask_b32 v72, v72, v15, vcc
    v_cndmask_b32 v73, v73, v14, vcc
    v_cndmask_b32 v39, v39, v36, vcc
    v_lshlrev_b32 v72, 3, v72
    v_add_u32 v72, 65536, v72
    v_accvgpr_write_b32 a244, v72
    v_accvgpr_write_b32 a245, v73
    v_accvgpr_write_b32 a246, v39
    s_lshl_b32 s3, s81, 2
    s_add_u32 s3, s3, s26
    s_mul_i32 s3, s3, 20480
    s_mul_i32 s2, s82, 160
    s_add_u32 s3, s3, s2
    v_and_b32 v13, 15, v0
    v_mul_u32_u24 v13, 1280, v13
    v_lshrrev_b32 v14, 4, v0
    v_lshlrev_b32 v14, 3, v14
    v_add3_u32 v13, v13, v14, s3
    v_accvgpr_write_b32 a252, v13
    s_mul_i32 s67, s80, 9216
    s_add_u32 s67, s67, 112640
    v_bfe_u32 v13, v0, 4, 1
    v_lshlrev_b32 v13, 11, v13
    v_lshrrev_b32 v14, 5, v0
    v_lshlrev_b32 v14, 3, v14
    v_bfe_u32 v15, v0, 2, 2
    v_add_u32 v14, v14, v15
    v_lshl_add_u32 v13, v14, 7, v13
    v_and_b32 v14, 3, v0
    v_lshl_add_u32 v13, v14, 3, v13
    v_add_u32 v13, s67, v13
    v_accvgpr_write_b32 a253, v13
    v_lshrrev_b32 v72, 4, v0
    v_lshl_add_u32 v72, v72, 2, v15
    v_mul_u32_u24 v72, 160, v72
    v_lshl_add_u32 v72, v14, 3, v72
    v_add_u32 v72, s67, v72
    v_accvgpr_write_b32 a254, v72
    v_bfe_u32 v14, v0, 2, 1
    v_lshlrev_b32 v14, 8, v14
    v_lshrrev_b32 v15, 5, v0
    v_lshl_add_u32 v14, v15, 5, v14
    s_lshl_b32 s3, s80, 6
    s_add_u32 s3, s3, 156864
    v_add_u32 v14, s3, v14
    v_accvgpr_write_b32 a255, v14
    s_mul_i32 s3, s80, 5
    v_add_u32 v14, s3, v0
    s_lshl_b32 s2, s82, 1
    v_add_u32 v13, s2, v14
    v_and_b32 v13, 7, v13
    v_and_b32 v15, 8, v14
    v_add_u32 v13, v13, v15
    v_cmp_le_u32 vcc, 16, v14
    s_nop 1
    v_cndmask_b32 v13, v13, v14, vcc
    s_add_u32 s3, s82, 384
    v_lshl_add_u32 v13, v13, 3, s3
    s_mul_i32 s3, s80, 96
    s_add_u32 s3, s3, s82
    s_sub_u32 s3, s3, 40
    v_lshl_add_u32 v14, v0, 3, s3
    v_cmp_gt_u32 vcc, 5, v0
    s_nop 1
    v_cndmask_b32 v13, v14, v13, vcc
    v_mul_u32_u24 v13, 21846, v13
    v_lshrrev_b32 v13, 16, v13
    v_min_u32 v14, 36, v0
    v_subrev_u32 v14, 17, v14
    v_lshrrev_b32 v15, 1, v14
    v_mul_u32_u24 v15, 24, v15
    v_and_b32 v14, 1, v14
    s_mul_i32 s3, s82, 12
    s_mul_i32 s2, s80, 3
    s_add_u32 s3, s3, s2
    v_lshl_add_u32 v14, v14, 1, s3
    v_lshrrev_b32 v14, 2, v14
    v_add_u32 v14, v14, v15
    v_cmp_gt_u32 vcc, 17, v0
    s_nop 1
    v_cndmask_b32 v13, v14, v13, vcc
    v_lshlrev_b32 v13, 7, v13
    v_accvgpr_write_b32 a230, v13
    s_waitcnt vmcnt(10)
    v_lshlrev_b32 v74, 16, v74
    v_lshlrev_b32 v75, 16, v75
    v_lshlrev_b32 v76, 16, v76
    v_lshlrev_b32 v77, 16, v77
    v_lshlrev_b32 v78, 16, v78
    v_mul_f32 v40, 0xbfb8aa3b, v74
    v_mul_f32 v41, 0xbfb8aa3b, v75
    v_mul_f32 v42, 0xbfb8aa3b, v76
    v_mul_f32 v43, 0xbfb8aa3b, v77
    v_mul_f32 v44, 0xbfb8aa3b, v78
    v_exp_f32 v40, v40
    v_exp_f32 v41, v41
    v_exp_f32 v42, v42
    v_exp_f32 v43, v43
    v_exp_f32 v44, v44
    v_add_f32 v40, 1.0, v40
    v_add_f32 v41, 1.0, v41
    v_add_f32 v42, 1.0, v42
    v_add_f32 v43, 1.0, v43
    v_add_f32 v44, 1.0, v44
    v_rcp_f32 v40, v40
    v_rcp_f32 v41, v41
    v_rcp_f32 v42, v42
    v_rcp_f32 v43, v43
    v_rcp_f32 v44, v44
    v_mul_f32 v40, v40, v74
    v_mul_f32 v41, v41, v75
    v_mul_f32 v42, v42, v76
    v_mul_f32 v43, v43, v77
    v_mul_f32 v44, v44, v78
    v_cvt_pk_bf16_f32 v40, v40, v40
    v_cvt_pk_bf16_f32 v41, v41, v41
    v_cvt_pk_bf16_f32 v42, v42, v42
    v_cvt_pk_bf16_f32 v43, v43, v43
    v_cvt_pk_bf16_f32 v44, v44, v44
    v_and_b32 v50, 0xffff0000, v40
    v_and_b32 v52, 0xffff0000, v41
    v_and_b32 v54, 0xffff0000, v42
    v_and_b32 v56, 0xffff0000, v43
    v_and_b32 v58, 0xffff0000, v44
    v_accvgpr_write_b32 a239, v50
    v_accvgpr_write_b32 a240, v52
    v_accvgpr_write_b32 a241, v54
    v_accvgpr_write_b32 a242, v56
    v_accvgpr_write_b32 a243, v58
    s_waitcnt lgkmcnt(0)
    s_add_u32 s85, s85, 1
    s_mul_i32 s84, s85, 0x9e3779b1
    s_xor_b32 s84, s84, 0x5bd1e995
    s_cmp_ge_u32 s101, 80
    s_cbranch_scc1 L_wqu_12
    s_waitcnt vmcnt(5)
    v_lshlrev_b32 v60, 16, v96
    v_and_b32 v61, 0xffff0000, v96
    v_pk_mul_f32 v[64:65], v[60:61], v[50:51] op_sel_hi:[1,0]
    v_lshlrev_b32 v62, 16, v97
    v_and_b32 v63, 0xffff0000, v97
    v_pk_mul_f32 v[66:67], v[62:63], v[50:51] op_sel_hi:[1,0]
    v_lshlrev_b32 v60, 16, v98
    v_and_b32 v61, 0xffff0000, v98
    v_pk_mul_f32 v[68:69], v[60:61], v[50:51] op_sel_hi:[1,0]
    v_lshlrev_b32 v62, 16, v99
    v_and_b32 v63, 0xffff0000, v99
    v_pk_mul_f32 v[70:71], v[62:63], v[50:51] op_sel_hi:[1,0]
    v_lshlrev_b32 v60, 16, v100
    v_and_b32 v61, 0xffff0000, v100
    v_pk_fma_f32 v[64:65], v[60:61], v[52:53], v[64:65] op_sel_hi:[1,0,1]
    v_lshlrev_b32 v62, 16, v101
    v_and_b32 v63, 0xffff0000, v101
    v_pk_fma_f32 v[66:67], v[62:63], v[52:53], v[66:67] op_sel_hi:[1,0,1]
    v_lshlrev_b32 v60, 16, v102
    v_and_b32 v61, 0xffff0000, v102
    v_pk_fma_f32 v[68:69], v[60:61], v[52:53], v[68:69] op_sel_hi:[1,0,1]
    v_lshlrev_b32 v62, 16, v103
    v_and_b32 v63, 0xffff0000, v103
    v_pk_fma_f32 v[70:71], v[62:63], v[52:53], v[70:71] op_sel_hi:[1,0,1]
    v_lshlrev_b32 v60, 16, v104
    v_and_b32 v61, 0xffff0000, v104
    v_pk_fma_f32 v[64:65], v[60:61], v[54:55], v[64:65] op_sel_hi:[1,0,1]
    v_lshlrev_b32 v62, 16, v105
    v_and_b32 v63, 0xffff0000, v105
    v_pk_fma_f32 v[66:67], v[62:63], v[54:55], v[66:67] op_sel_hi:[1,0,1]
    v_lshlrev_b32 v60, 16, v106
    v_and_b32 v61, 0xffff0000, v106
    v_pk_fma_f32 v[68:69], v[60:61], v[54:55], v[68:69] op_sel_hi:[1,0,1]
    v_lshlrev_b32 v62, 16, v107
    v_and_b32 v63, 0xffff0000, v107
    v_pk_fma_f32 v[70:71], v[62:63], v[54:55], v[70:71] op_sel_hi:[1,0,1]
    v_lshlrev_b32 v60, 16, v108
    v_and_b32 v61, 0xffff0000, v108
    v_pk_fma_f32 v[64:65], v[60:61], v[56:57], v[64:65] op_sel_hi:[1,0,1]
    v_lshlrev_b32 v62, 16, v109
    v_and_b32 v63, 0xffff0000, v109
    v_pk_fma_f32 v[66:67], v[62:63], v[56:57], v[66:67] op_sel_hi:[1,0,1]
    v_lshlrev_b32 v60, 16, v110
    v_and_b32 v61, 0xffff0000, v110
    v_pk_fma_f32 v[68:69], v[60:61], v[56:57], v[68:69] op_sel_hi:[1,0,1]
    v_lshlrev_b32 v62, 16, v111
    v_and_b32 v63, 0xffff0000, v111
    v_pk_fma_f32 v[70:71], v[62:63], v[56:57], v[70:71] op_sel_hi:[1,0,1]
    v_lshlrev_b32 v60, 16, v112
    v_and_b32 v61, 0xffff0000, v112
    v_pk_fma_f32 v[64:65], v[60:61], v[58:59], v[64:65] op_sel_hi:[1,0,1]
    v_lshlrev_b32 v62, 16, v113
    v_and_b32 v63, 0xffff0000, v113
    v_pk_fma_f32 v[66:67], v[62:63], v[58:59], v[66:67] op_sel_hi:[1,0,1]
    v_lshlrev_b32 v60, 16, v114
    v_and_b32 v61, 0xffff0000, v114
    v_pk_fma_f32 v[68:69], v[60:61], v[58:59], v[68:69] op_sel_hi:[1,0,1]
    v_lshlrev_b32 v62, 16, v115
    v_and_b32 v63, 0xffff0000, v115
    v_pk_fma_f32 v[70:71], v[62:63], v[58:59], v[70:71] op_sel_hi:[1,0,1]
    v_and_b32 v13, 7, v0
    v_lshlrev_b32 v13, 5, v13
    v_lshrrev_b32 v14, 4, v0
    v_lshl_add_u32 v13, v14, 3, v13
    v_permlane32_swap_b32 v64, v68
    v_permlane32_swap_b32 v65, v69
    v_permlane32_swap_b32 v66, v70
    v_permlane32_swap_b32 v67, v71
    s_lshl_b32 s66, s80, 8
    s_add_u32 s66, s66, 157440
    v_add_u32 v13, s66, v13
    v_add_f32 v64, v64, v68
    v_add_f32 v65, v65, v69
    v_add_f32 v66, v66, v70
    v_add_f32 v67, v67, v71
    v_lshlrev_b32 v14, 2, v0
    v_add_u32 v14, 157440, v14
    v_permlane16_swap_b32 v64, v66
    v_permlane16_swap_b32 v65, v67
    s_mul_i32 s3, s64, 30720
    s_lshl_b32 s2, s65, 9
    v_add_f32 v64, v64, v66
    v_add_f32 v65, v65, v67
    s_add_u32 s3, s3, s2
    s_mov_b32 s2, 2130706432
    s_cmp_eq_u32 s80, 0
    s_cselect_b32 s2, 65536, s2
    s_add_u32 s3, s3, s2
    v_add_f32_dpp v64, v64, v64 row_ror:8 row_mask:0xf bank_mask:0xf
    v_add_f32_dpp v65, v65, v65 row_ror:8 row_mask:0xf bank_mask:0xf
    ds_write_b64 v13, v[64:65]
    v_lshl_add_u32 v15, v0, 3, s3
    v_mov_b32 v69, s84
    s_waitcnt lgkmcnt(0)
    s_barrier
    ds_read_b32 v64, v14 offset:0
    ds_read_b32 v65, v14 offset:256
    ds_read_b32 v66, v14 offset:512
    ds_read_b32 v67, v14 offset:768
    s_waitcnt lgkmcnt(0)
    v_add_f32 v64, v64, v65
    v_add_f32 v66, v66, v67
    v_add_f32 v68, v64, v66
    buffer_store_dwordx2 v[68:69], v15, s[32:35], 0 offen offset:0 sc1
    s_mov_b32 s64, 4
    s_branch L_nomodu_11
L_wqu_12:
    s_cmp_ge_u32 s101, 240
    s_cbranch_scc1 L_nomodu_11
    s_and_b32 s3, s101, 3
    s_cmp_lg_u32 s3, s80
    s_cbranch_scc1 L_nomodu_11
    v_lshrrev_b32 v13, 4, v0
    v_bfe_u32 v14, v0, 2, 2
    v_and_b32 v15, 3, v0
    v_lshl_add_u32 v37, v13, 3, v14
    v_mul_u32_u24 v37, 160, v37
    v_lshl_add_u32 v37, v15, 3, v37
    s_mul_i32 s66, s80, 25600
    v_add_u32 v37, s66, v37
    s_sub_u32 s3, s101, 80
    s_lshr_b32 s2, s3, 3
    s_and_b32 s3, s3, 7
    s_mul_i32 s3, s3, 20
    s_add_u32 s67, s3, s2
    s_mul_i32 s3, s67, 5120
    s_add_u32 s3, s3, 26214400
    v_add_u32 v38, s3, v1
    s_waitcnt vmcnt(5)
    ds_read_b64_tr_b16 v[60:61], v37 offset:0
    ds_read_b64_tr_b16 v[62:63], v37 offset:640
    ds_read_b64_tr_b16 v[64:65], v37 offset:32
    ds_read_b64_tr_b16 v[66:67], v37 offset:672
    ds_read_b64_tr_b16 v[68:69], v37 offset:64
    ds_read_b64_tr_b16 v[70:71], v37 offset:704
    ds_read_b64_tr_b16 v[72:73], v37 offset:96
    ds_read_b64_tr_b16 v[74:75], v37 offset:736
    ds_read_b64_tr_b16 v[76:77], v37 offset:128
    ds_read_b64_tr_b16 v[78:79], v37 offset:768
    s_waitcnt lgkmcnt(8)
    buffer_store_dwordx4 v[60:63], v38, s[32:35], 0 offen offset:0 sc1
    s_waitcnt lgkmcnt(6)
    buffer_store_dwordx4 v[64:67], v38, s[32:35], 0 offen offset:1024 sc1
    s_waitcnt lgkmcnt(4)
    buffer_store_dwordx4 v[68:71], v38, s[32:35], 0 offen offset:2048 sc1
    s_waitcnt lgkmcnt(2)
    buffer_store_dwordx4 v[72:75], v38, s[32:35], 0 offen offset:3072 sc1
    s_waitcnt lgkmcnt(0)
    s_mov_b32 s89, 4096
    buffer_store_dwordx4 v[76:79], v38, s[32:35], s89 offen offset:0 sc1
L_nomodu_11:
    s_mov_b32 s27, 0
    s_add_u32 m0, s99, 0
    s_nop 0
    buffer_load_dwordx4 v12, s[44:47], s27 offen  lds
    s_mov_b32 s27, 1024
    s_add_u32 m0, s99, 1024
    s_nop 0
    buffer_load_dwordx4 v12, s[44:47], s27 offen  lds
    s_mov_b32 s27, 2048
    s_add_u32 m0, s99, 2048
    s_nop 0
    buffer_load_dwordx4 v12, s[44:47], s27 offen  lds
    s_mov_b32 s27, 3072
    s_add_u32 m0, s99, 3072
    s_nop 0
    buffer_load_dwordx4 v12, s[44:47], s27 offen  lds
    s_mov_b32 s27, 4096
    s_add_u32 m0, s99, 4096
    s_nop 0
    buffer_load_dwordx4 v12, s[44:47], s27 offen  lds
    s_mov_b32 s27, 5120
    s_add_u32 m0, s99, 5120
    s_nop 0
    buffer_load_dwordx4 v12, s[44:47], s27 offen  lds
    s_mov_b64 exec, 0xffff
    s_mov_b32 s27, 6144
    s_add_u32 m0, s99, 6144
    s_nop 0
    buffer_load_dwordx4 v12, s[44:47], s27 offen  lds
    s_mov_b64 exec, -1
    s_mov_b32 s27, 0
    s_add_u32 m0, s99, 6400
    s_nop 0
    buffer_load_dwordx4 v12, s[48:51], s27 offen  lds
    s_mov_b32 s27, 1024
    s_add_u32 m0, s99, 7424
    s_nop 0
    buffer_load_dwordx4 v12, s[48:51], s27 offen  lds
    s_mov_b32 s27, 2048
    s_add_u32 m0, s99, 8448
    s_nop 0
    buffer_load_dwordx4 v12, s[48:51], s27 offen  lds
    s_mov_b32 s27, 3072
    s_add_u32 m0, s99, 9472
    s_nop 0
    buffer_load_dwordx4 v12, s[48:51], s27 offen  lds
    s_mov_b32 s27, 4096
    s_add_u32 m0, s99, 10496
    s_nop 0
    buffer_load_dwordx4 v12, s[48:51], s27 offen  lds
    s_mov_b32 s27, 5120
    s_add_u32 m0, s99, 11520
    s_nop 0
    buffer_load_dwordx4 v12, s[48:51], s27 offen  lds
    s_mov_b64 exec, 0xffff
    s_mov_b32 s27, 6144
    s_add_u32 m0, s99, 12544
    s_nop 0
    buffer_load_dwordx4 v12, s[48:51], s27 offen  lds
    s_mov_b64 exec, -1
    v_lshrrev_b32 v13, 4, v0
    v_bfe_u32 v14, v0, 2, 2
    v_and_b32 v15, 3, v0
    v_lshl_add_u32 v36, v13, 3, v14
    v_mul_u32_u24 v36, 40, v36
    v_lshl_add_u32 v36, v15, 3, v36
    v_add_u32 v36, s99, v36
    s_waitcnt vmcnt(14)
    ds_read_b128 v[16:19], v118 offset:0
    ds_read_b128 v[20:23], v118 offset:64
    ds_read_b128 v[24:27], v118 offset:128
    ds_read_b128 v[28:31], v118 offset:192
    ds_read_b128 v[32:35], v118 offset:256
    s_sub_u32 s3, s101, 80
    s_cmp_ge_u32 s3, 160
    s_cbranch_scc1 L_noqf_13
    s_and_b32 s3, s101, 3
    s_cmp_lg_u32 s3, s80
    s_cbranch_scc1 L_noqf_13
    s_sub_u32 s3, s101, 80
    s_lshr_b32 s2, s3, 3
    s_and_b32 s3, s3, 7
    s_mul_i32 s3, s3, 20
    s_add_u32 s3, s3, s2
    s_lshl_b32 s3, s3, 7
    s_add_u32 s3, s3, 950272
    v_mov_b32 v13, s3
    v_mov_b32 v14, s84
    s_waitcnt vmcnt(14)
    s_mov_b64 exec, 1
    buffer_store_dword v14, v13, s[32:35], 0 offen sc1
    s_mov_b64 exec, -1
L_noqf_13:
    s_waitcnt lgkmcnt(0)
    v_lshlrev_b32 v40, 16, v16
    v_and_b32 v41, 0xffff0000, v16
    v_lshlrev_b32 v42, 16, v17
    v_and_b32 v43, 0xffff0000, v17
    v_lshlrev_b32 v44, 16, v18
    v_and_b32 v45, 0xffff0000, v18
    v_lshlrev_b32 v46, 16, v19
    v_and_b32 v47, 0xffff0000, v19
    v_lshlrev_b32 v48, 16, v20
    buffer_load_dwordx4 v[128:131], v4, s[32:35], 0 offen offset:0 sc1
    v_and_b32 v49, 0xffff0000, v20
    v_lshlrev_b32 v50, 16, v21
    v_and_b32 v51, 0xffff0000, v21
    v_lshlrev_b32 v52, 16, v22
    v_and_b32 v53, 0xffff0000, v22
    v_lshlrev_b32 v54, 16, v23
    v_and_b32 v55, 0xffff0000, v23
    v_lshlrev_b32 v56, 16, v24
    v_and_b32 v57, 0xffff0000, v24
    s_mov_b32 s89, 30720
    buffer_load_dwordx4 v[132:135], v4, s[32:35], s89 offen offset:0 sc1
    v_lshlrev_b32 v58, 16, v25
    v_and_b32 v59, 0xffff0000, v25
    v_lshlrev_b32 v60, 16, v26
    v_and_b32 v61, 0xffff0000, v26
    v_lshlrev_b32 v62, 16, v27
    v_and_b32 v63, 0xffff0000, v27
    v_lshlrev_b32 v64, 16, v28
    v_and_b32 v65, 0xffff0000, v28
    v_lshlrev_b32 v66, 16, v29
    s_mov_b32 s89, 61440
    buffer_load_dwordx4 v[136:139], v4, s[32:35], s89 offen offset:0 sc1
    v_and_b32 v67, 0xffff0000, v29
    v_lshlrev_b32 v68, 16, v30
    v_and_b32 v69, 0xffff0000, v30
    v_lshlrev_b32 v70, 16, v31
    v_and_b32 v71, 0xffff0000, v31
    v_lshlrev_b32 v72, 16, v32
    v_and_b32 v73, 0xffff0000, v32
    v_lshlrev_b32 v74, 16, v33
    v_and_b32 v75, 0xffff0000, v33
    s_mov_b32 s89, 92160
    buffer_load_dwordx4 v[140:143], v4, s[32:35], s89 offen offset:0 sc1
    v_lshlrev_b32 v76, 16, v34
    v_and_b32 v77, 0xffff0000, v34
    v_lshlrev_b32 v78, 16, v35
    v_and_b32 v79, 0xffff0000, v35
    v_pk_add_f32 v[80:81], v[40:41], v[42:43]
    v_pk_mul_f32 v[82:83], v[40:41], v[40:41]
    v_pk_fma_f32 v[82:83], v[42:43], v[42:43], v[82:83]
    v_pk_add_f32 v[80:81], v[80:81], v[44:45]
    v_pk_fma_f32 v[82:83], v[44:45], v[44:45], v[82:83]
    buffer_load_dwordx4 v[144:147], v5, s[32:35], 0 offen offset:0 sc1
    v_pk_add_f32 v[80:81], v[80:81], v[46:47]
    v_pk_fma_f32 v[82:83], v[46:47], v[46:47], v[82:83]
    v_pk_add_f32 v[80:81], v[80:81], v[48:49]
    v_pk_fma_f32 v[82:83], v[48:49], v[48:49], v[82:83]
    v_pk_add_f32 v[80:81], v[80:81], v[50:51]
    v_pk_fma_f32 v[82:83], v[50:51], v[50:51], v[82:83]
    v_pk_add_f32 v[80:81], v[80:81], v[52:53]
    v_pk_fma_f32 v[82:83], v[52:53], v[52:53], v[82:83]
    v_pk_add_f32 v[80:81], v[80:81], v[54:55]
    s_mov_b32 s89, 30720
    buffer_load_dwordx4 v[148:151], v5, s[32:35], s89 offen offset:0 sc1
    v_pk_fma_f32 v[82:83], v[54:55], v[54:55], v[82:83]
    v_pk_add_f32 v[80:81], v[80:81], v[56:57]
    v_pk_fma_f32 v[82:83], v[56:57], v[56:57], v[82:83]
    v_pk_add_f32 v[80:81], v[80:81], v[58:59]
    v_pk_fma_f32 v[82:83], v[58:59], v[58:59], v[82:83]
    v_pk_add_f32 v[80:81], v[80:81], v[60:61]
    v_pk_fma_f32 v[82:83], v[60:61], v[60:61], v[82:83]
    v_pk_add_f32 v[80:81], v[80:81], v[62:63]
    v_pk_fma_f32 v[82:83], v[62:63], v[62:63], v[82:83]
    s_mov_b32 s89, 61440
    buffer_load_dwordx4 v[152:155], v5, s[32:35], s89 offen offset:0 sc1
    v_pk_add_f32 v[80:81], v[80:81], v[64:65]
    v_pk_fma_f32 v[82:83], v[64:65], v[64:65], v[82:83]
    v_pk_add_f32 v[80:81], v[80:81], v[66:67]
    v_pk_fma_f32 v[82:83], v[66:67], v[66:67], v[82:83]
    v_pk_add_f32 v[80:81], v[80:81], v[68:69]
    v_pk_fma_f32 v[82:83], v[68:69], v[68:69], v[82:83]
    v_pk_add_f32 v[80:81], v[80:81], v[70:71]
    v_pk_fma_f32 v[82:83], v[70:71], v[70:71], v[82:83]
    v_pk_add_f32 v[80:81], v[80:81], v[72:73]
    s_mov_b32 s89, 92160
    buffer_load_dwordx4 v[156:159], v5, s[32:35], s89 offen offset:0 sc1
    v_pk_fma_f32 v[82:83], v[72:73], v[72:73], v[82:83]
    v_pk_add_f32 v[80:81], v[80:81], v[74:75]
    v_pk_fma_f32 v[82:83], v[74:75], v[74:75], v[82:83]
    v_pk_add_f32 v[80:81], v[80:81], v[76:77]
    v_pk_fma_f32 v[82:83], v[76:77], v[76:77], v[82:83]
    v_pk_add_f32 v[80:81], v[80:81], v[78:79]
    v_pk_fma_f32 v[82:83], v[78:79], v[78:79], v[82:83]
    v_add_f32 v80, v80, v81
    v_add_f32 v81, v82, v83
    buffer_load_dwordx4 v[160:163], v6, s[32:35], 0 offen offset:0 sc1
    v_and_b32 v13, 15, v0
    v_lshlrev_b32 v13, 5, v13
    v_add_u32 v14, 153856, v13
    s_lshl_b32 s66, s80, 3
    v_add_u32 v13, s66, v14
    v_permlane32_swap_b32 v80, v81
    v_add_f32 v80, v80, v81
    v_mov_b32 v81, v80
    v_lshrrev_b32 v15, 5, v0
    v_lshl_add_u32 v13, v15, 2, v13
    s_mov_b32 s89, 30720
    buffer_load_dwordx4 v[164:167], v6, s[32:35], s89 offen offset:0 sc1
    v_permlane16_swap_b32 v80, v81
    v_add_f32 v80, v80, v81
    ds_write_b32 v13, v80
    s_waitcnt lgkmcnt(0)
    s_barrier
    ds_read_b128 v[80:83], v14
    ds_read_b128 v[84:87], v14 offset:16
    s_waitcnt lgkmcnt(0)
    v_pk_add_f32 v[80:81], v[80:81], v[82:83]
    v_pk_add_f32 v[84:85], v[84:85], v[86:87]
    v_pk_add_f32 v[80:81], v[80:81], v[84:85]
    v_mul_f32 v80, 0x3acccccd, v80
    s_mov_b32 s89, 61440
    buffer_load_dwordx4 v[168:171], v6, s[32:35], s89 offen offset:0 sc1
    v_mul_f32 v81, 0x3acccccd, v81
    v_fma_f32 v81, -v80, v80, v81
    v_max_f32 v81, 0, v81
    v_add_f32 v81, 0x3727c5ac, v81
    v_rsq_f32 v82, v81
    s_nop 0
    v_mul_f32 v84, v80, v82
    v_sub_f32 v84, 0, v84
    v_pk_fma_f32 v[40:41], v[40:41], v[82:83], v[84:85] op_sel_hi:[1,0,0]
    s_mov_b32 s89, 92160
    buffer_load_dwordx4 v[172:175], v6, s[32:35], s89 offen offset:0 sc1
    v_pk_fma_f32 v[42:43], v[42:43], v[82:83], v[84:85] op_sel_hi:[1,0,0]
    v_pk_fma_f32 v[44:45], v[44:45], v[82:83], v[84:85] op_sel_hi:[1,0,0]
    v_pk_fma_f32 v[46:47], v[46:47], v[82:83], v[84:85] op_sel_hi:[1,0,0]
    v_pk_fma_f32 v[48:49], v[48:49], v[82:83], v[84:85] op_sel_hi:[1,0,0]
    v_pk_fma_f32 v[50:51], v[50:51], v[82:83], v[84:85] op_sel_hi:[1,0,0]
    v_pk_fma_f32 v[52:53], v[52:53], v[82:83], v[84:85] op_sel_hi:[1,0,0]
    v_pk_fma_f32 v[54:55], v[54:55], v[82:83], v[84:85] op_sel_hi:[1,0,0]
    v_pk_fma_f32 v[56:57], v[56:57], v[82:83], v[84:85] op_sel_hi:[1,0,0]
    v_pk_fma_f32 v[58:59], v[58:59], v[82:83], v[84:85] op_sel_hi:[1,0,0]
    v_pk_fma_f32 v[60:61], v[60:61], v[82:83], v[84:85] op_sel_hi:[1,0,0]
    v_pk_fma_f32 v[62:63], v[62:63], v[82:83], v[84:85] op_sel_hi:[1,0,0]
    v_pk_fma_f32 v[64:65], v[64:65], v[82:83], v[84:85] op_sel_hi:[1,0,0]
    v_pk_fma_f32 v[66:67], v[66:67], v[82:83], v[84:85] op_sel_hi:[1,0,0]
    v_pk_fma_f32 v[68:69], v[68:69], v[82:83], v[84:85] op_sel_hi:[1,0,0]
    v_pk_fma_f32 v[70:71], v[70:71], v[82:83], v[84:85] op_sel_hi:[1,0,0]
    v_pk_fma_f32 v[72:73], v[72:73], v[82:83], v[84:85] op_sel_hi:[1,0,0]
    v_pk_fma_f32 v[74:75], v[74:75], v[82:83], v[84:85] op_sel_hi:[1,0,0]
    v_pk_fma_f32 v[76:77], v[76:77], v[82:83], v[84:85] op_sel_hi:[1,0,0]
    v_pk_fma_f32 v[78:79], v[78:79], v[82:83], v[84:85] op_sel_hi:[1,0,0]
    s_mul_i32 s3, s82, 20
    s_mul_i32 s2, s26, 5
    s_add_u32 s3, s3, s2
    s_lshl_b32 s3, s3, 7
    s_add_u32 s3, s3, 950272
    v_min_u32 v7, 4, v0
    v_lshl_add_u32 v7, v7, 7, s3
    s_lshl_b32 s3, s82, 2
    s_add_u32 s3, s3, s26
    s_mul_i32 s3, s3, 25600
    s_add_u32 s3, s3, 26214400
    v_add_u32 v116, s3, v1
    s_and_b32 s2, s81, 3
    s_mul_i32 s2, s2, 6400
    s_add_u32 s3, s3, s2
    v_lshl_add_u32 v11, v0, 7, s3
    s_mov_b64 exec, 0xff
    buffer_load_dword v12, v7, s[32:35], 0 offen sc1
    s_mov_b64 exec, -1
    s_waitcnt vmcnt(13)
    ds_read_b64_tr_b16 a[100:101], v36 offset:0
    ds_read_b64_tr_b16 a[102:103], v36 offset:160
    ds_read_b64_tr_b16 a[120:121], v36 offset:32
    ds_read_b64_tr_b16 a[122:123], v36 offset:192
    ds_read_b64_tr_b16 a[140:141], v36 offset:6400
    ds_read_b64_tr_b16 a[142:143], v36 offset:6560
    ds_read_b64_tr_b16 a[160:161], v36 offset:6432
    ds_read_b64_tr_b16 a[162:163], v36 offset:6592
    ds_read_b64_tr_b16 a[104:105], v36 offset:1280
    ds_read_b64_tr_b16 a[106:107], v36 offset:1440
    ds_read_b64_tr_b16 a[124:125], v36 offset:1312
    ds_read_b64_tr_b16 a[126:127], v36 offset:1472
    ds_read_b64_tr_b16 a[144:145], v36 offset:7680
    ds_read_b64_tr_b16 a[146:147], v36 offset:7840
    ds_read_b64_tr_b16 a[164:165], v36 offset:7712
    ds_read_b64_tr_b16 a[166:167], v36 offset:7872
    ds_read_b64_tr_b16 a[108:109], v36 offset:2560
    ds_read_b64_tr_b16 a[110:111], v36 offset:2720
    ds_read_b64_tr_b16 a[128:129], v36 offset:2592
    ds_read_b64_tr_b16 a[130:131], v36 offset:2752
    ds_read_b64_tr_b16 a[148:149], v36 offset:8960
    ds_read_b64_tr_b16 a[150:151], v36 offset:9120
    ds_read_b64_tr_b16 a[168:169], v36 offset:8992
    ds_read_b64_tr_b16 a[170:171], v36 offset:9152
    ds_read_b64_tr_b16 a[112:113], v36 offset:3840
    ds_read_b64_tr_b16 a[114:115], v36 offset:4000
    ds_read_b64_tr_b16 a[132:133], v36 offset:3872
    ds_read_b64_tr_b16 a[134:135], v36 offset:4032
    ds_read_b64_tr_b16 a[152:153], v36 offset:10240
    ds_read_b64_tr_b16 a[154:155], v36 offset:10400
    ds_read_b64_tr_b16 a[172:173], v36 offset:10272
    ds_read_b64_tr_b16 a[174:175], v36 offset:10432
    ds_read_b64_tr_b16 a[116:117], v36 offset:5120
    ds_read_b64_tr_b16 a[118:119], v36 offset:5280
    ds_read_b64_tr_b16 a[136:137], v36 offset:5152
    ds_read_b64_tr_b16 a[138:139], v36 offset:5312
    ds_read_b64_tr_b16 a[156:157], v36 offset:11520
    ds_read_b64_tr_b16 a[158:159], v36 offset:11680
    ds_read_b64_tr_b16 a[176:177], v36 offset:11552
    ds_read_b64_tr_b16 a[178:179], v36 offset:11712
    s_waitcnt vmcnt(0)
    s_mov_b64 exec, 0xff
    v_cmp_ne_u32 vcc, s84, v12
    s_mov_b64 exec, -1
    s_cbranch_vccz L_ptok_14
    s_mov_b32 s88, 400000
L_poll_15:
    s_mov_b64 exec, 0xff
    buffer_load_dword v12, v7, s[32:35], 0 offen sc1
    s_sub_u32 s88, s88, 1
    s_cbranch_scc1 L_end
    s_waitcnt vmcnt(0)
    v_cmp_ne_u32 vcc, s84, v12
    s_cbranch_vccnz L_poll_15
    s_mov_b64 exec, -1
L_ptok_14:
    s_mov_b64 exec, 0xfff
    buffer_load_dword v244, v11, s[32:35], 0 offen offset:0 sc1
    s_mov_b64 exec, -1
    s_mov_b32 s88, 400000
L_modchk_17:
    v_min_u32 v14, v129, v131
    v_max_u32 v15, v129, v131
    v_min3_u32 v14, v14, v133, v135
    v_max3_u32 v15, v15, v133, v135
    v_min3_u32 v14, v14, v137, v139
    v_max3_u32 v15, v15, v137, v139
    v_min3_u32 v14, v14, v141, v143
    v_max3_u32 v15, v15, v141, v143
    v_min3_u32 v14, v14, v145, v147
    v_max3_u32 v15, v15, v145, v147
    v_min3_u32 v14, v14, v149, v151
    v_max3_u32 v15, v15, v149, v151
    v_min3_u32 v14, v14, v153, v155
    v_max3_u32 v15, v15, v153, v155
    v_min3_u32 v14, v14, v157, v159
    v_max3_u32 v15, v15, v157, v159
    v_min3_u32 v14, v14, v161, v163
    v_max3_u32 v15, v15, v161, v163
    v_min3_u32 v14, v14, v165, v167
    v_max3_u32 v15, v15, v165, v167
    v_min3_u32 v14, v14, v169, v171
    v_max3_u32 v15, v15, v169, v171
    v_min3_u32 v14, v14, v173, v175
    v_max3_u32 v15, v15, v173, v175
    v_cmp_ne_u32 vcc, s84, v14
    v_cmp_ne_u32 s[96:97], s84, v15
    s_or_b64 vcc, vcc, s[96:97]
    s_cbranch_vccz L_modok_18
    s_sub_u32 s88, s88, 1
    s_cbranch_scc1 L_end
    buffer_load_dwordx4 v[128:131], v4, s[32:35], 0 offen offset:0 sc1
    s_mov_b32 s89, 30720
    buffer_load_dwordx4 v[132:135], v4, s[32:35], s89 offen offset:0 sc1
    s_mov_b32 s89, 61440
    buffer_load_dwordx4 v[136:139], v4, s[32:35], s89 offen offset:0 sc1
    s_mov_b32 s89, 92160
    buffer_load_dwordx4 v[140:143], v4, s[32:35], s89 offen offset:0 sc1
    buffer_load_dwordx4 v[144:147], v5, s[32:35], 0 offen offset:0 sc1
    s_mov_b32 s89, 30720
    buffer_load_dwordx4 v[148:151], v5, s[32:35], s89 offen offset:0 sc1
    s_mov_b32 s89, 61440
    buffer_load_dwordx4 v[152:155], v5, s[32:35], s89 offen offset:0 sc1
    s_mov_b32 s89, 92160
    buffer_load_dwordx4 v[156:159], v5, s[32:35], s89 offen offset:0 sc1
    buffer_load_dwordx4 v[160:163], v6, s[32:35], 0 offen offset:0 sc1
    s_mov_b32 s89, 30720
    buffer_load_dwordx4 v[164:167], v6, s[32:35], s89 offen offset:0 sc1
    s_mov_b32 s89, 61440
    buffer_load_dwordx4 v[168:171], v6, s[32:35], s89 offen offset:0 sc1
    s_mov_b32 s89, 92160
    buffer_load_dwordx4 v[172:175], v6, s[32:35], s89 offen offset:0 sc1
    s_waitcnt vmcnt(0)
    s_branch L_modchk_17
L_modok_18:
    s_mov_b64 s[92:93], 0xffff
    v_cndmask_b32 v14, 0, 1.0, s[92:93]
    v_add_f32 v128, v128, v132
    v_add_f32 v130, v130, v134
    v_add_f32 v136, v136, v140
    v_add_f32 v138, v138, v142
    v_add_f32 v128, v128, v136
    v_add_f32 v130, v130, v138
    v_cvt_pk_bf16_f32 v132, v128, v130
    v_lshlrev_b32 v128, 16, v132
    v_and_b32 v129, 0xffff0000, v132
    v_add_f32 v128, 1.0, v128
    v_add_f32 v129, 1.0, v129
    v_cvt_pk_bf16_f32 v132, v128, v129
    v_lshlrev_b32 v128, 16, v132
    v_and_b32 v129, 0xffff0000, v132
    ds_write_b64 v8, v[128:129]
    v_add_f32 v144, v144, v148
    v_add_f32 v146, v146, v150
    v_add_f32 v152, v152, v156
    v_add_f32 v154, v154, v158
    v_add_f32 v144, v144, v152
    v_add_f32 v146, v146, v154
    v_cvt_pk_bf16_f32 v148, v144, v146
    v_lshlrev_b32 v144, 16, v148
    v_and_b32 v145, 0xffff0000, v148
    v_add_f32 v144, v14, v144
    v_add_f32 v145, v14, v145
    v_cvt_pk_bf16_f32 v148, v144, v145
    v_lshlrev_b32 v144, 16, v148
    v_and_b32 v145, 0xffff0000, v148
    ds_write_b64 v9, v[144:145]
    v_add_f32 v160, v160, v164
    v_add_f32 v162, v162, v166
    v_add_f32 v168, v168, v172
    v_add_f32 v170, v170, v174
    v_add_f32 v160, v160, v168
    v_add_f32 v162, v162, v170
    v_cvt_pk_bf16_f32 v164, v160, v162
    v_lshlrev_b32 v160, 16, v164
    v_and_b32 v161, 0xffff0000, v164
    ds_write_b64 v10, v[160:161]
    v_lshrrev_b32 v13, 4, v0
    s_mul_i32 s66, s80, 1280
    s_add_u32 s66, s66, 157440
    v_lshl_add_u32 v2, v13, 5, s66
    ds_read_b128 v[128:131], v2 offset:0
    ds_read_b128 v[132:135], v2 offset:16
    ds_read_b128 v[168:171], v2 offset:640
    ds_read_b128 v[172:175], v2 offset:656
    s_mov_b32 s27, 0
    s_add_u32 m0, s98, 0
    s_nop 0
    buffer_load_dwordx4 v116, s[32:35], s27 offen sc1 lds
    ds_read_b128 v[136:139], v2 offset:128
    ds_read_b128 v[140:143], v2 offset:144
    ds_read_b128 v[176:179], v2 offset:768
    ds_read_b128 v[180:183], v2 offset:784
    ds_read_b128 v[144:147], v2 offset:256
    ds_read_b128 v[148:151], v2 offset:272
    s_mov_b32 s27, 1024
    s_add_u32 m0, s98, 1024
    s_nop 0
    buffer_load_dwordx4 v116, s[32:35], s27 offen sc1 lds
    ds_read_b128 v[184:187], v2 offset:896
    ds_read_b128 v[188:191], v2 offset:912
    ds_read_b128 v[152:155], v2 offset:384
    ds_read_b128 v[156:159], v2 offset:400
    ds_read_b128 v[192:195], v2 offset:1024
    ds_read_b128 v[196:199], v2 offset:1040
    s_mov_b32 s27, 2048
    s_add_u32 m0, s98, 2048
    s_nop 0
    buffer_load_dwordx4 v116, s[32:35], s27 offen sc1 lds
    ds_read_b128 v[160:163], v2 offset:512
    ds_read_b128 v[164:167], v2 offset:528
    ds_read_b128 v[200:203], v2 offset:1152
    ds_read_b128 v[204:207], v2 offset:1168
    s_mul_i32 s3, s81, 81920
    s_lshr_b32 s2, s82, 1
    s_mul_i32 s2, s2, 20480
    s_add_u32 s3, s3, s2
    s_mul_i32 s2, s80, 5120
    s_add_u32 s3, s3, s2
    s_and_b32 s2, s82, 1
    s_lshl_b32 s2, s2, 7
    s_add_u32 s3, s3, s2
    s_add_u32 s3, s3, 15204352
    v_add_u32 v3, s3, v1
    s_mov_b32 s27, 3072
    s_add_u32 m0, s98, 3072
    s_nop 0
    buffer_load_dwordx4 v116, s[32:35], s27 offen sc1 lds
    v_and_b32 v13, 8, v0
    v_lshlrev_b32 v13, 27, v13
    v_add_u32 v3, v13, v3
    s_waitcnt lgkmcnt(15)
    v_pk_fma_f32 v[40:41], v[40:41], v[128:129], v[168:169]
    v_pk_fma_f32 v[42:43], v[42:43], v[130:131], v[170:171]
    v_pk_fma_f32 v[44:45], v[44:45], v[132:133], v[172:173]
    s_mov_b32 s27, 4096
    s_add_u32 m0, s98, 4096
    s_nop 0
    buffer_load_dwordx4 v116, s[32:35], s27 offen sc1 lds
    v_pk_fma_f32 v[46:47], v[46:47], v[134:135], v[174:175]
    v_cvt_pk_bf16_f32 v16, v40, v41
    v_cvt_pk_bf16_f32 v17, v42, v43
    v_cvt_pk_bf16_f32 v18, v44, v45
    v_cvt_pk_bf16_f32 v19, v46, v47
    buffer_store_dwordx4 v[16:19], v3, s[32:35], 0 offen offset:0 sc1
    s_mov_b32 s27, 5120
    s_add_u32 m0, s98, 5120
    s_nop 0
    buffer_load_dwordx4 v116, s[32:35], s27 offen sc1 lds
    v_mfma_f32_16x16x32_bf16 v[80:83], a[100:103], v[16:19], 0
    v_mfma_f32_16x16x32_bf16 v[84:87], a[120:123], v[16:19], 0
    v_mfma_f32_16x16x32_bf16 v[88:91], v[16:19], a[140:143], 0
    v_mfma_f32_16x16x32_bf16 v[92:95], v[16:19], a[160:163], 0
    s_waitcnt lgkmcnt(12)
    v_pk_fma_f32 v[48:49], v[48:49], v[136:137], v[176:177]
    v_pk_fma_f32 v[50:51], v[50:51], v[138:139], v[178:179]
    s_mov_b32 s27, 6144
    s_add_u32 m0, s98, 6144
    s_nop 0
    buffer_load_dwordx4 v116, s[32:35], s27 offen sc1 lds
    v_pk_fma_f32 v[52:53], v[52:53], v[140:141], v[180:181]
    v_pk_fma_f32 v[54:55], v[54:55], v[142:143], v[182:183]
    v_cvt_pk_bf16_f32 v20, v48, v49
    v_cvt_pk_bf16_f32 v21, v50, v51
    v_cvt_pk_bf16_f32 v22, v52, v53
    v_cvt_pk_bf16_f32 v23, v54, v55
    s_mov_b32 s27, 7168
    s_add_u32 m0, s98, 7168
    s_nop 0
    buffer_load_dwordx4 v116, s[32:35], s27 offen sc1 lds
    buffer_store_dwordx4 v[20:23], v3, s[32:35], 0 offen offset:1024 sc1
    v_mfma_f32_16x16x32_bf16 v[80:83], a[104:107], v[20:23], v[80:83]
    v_mfma_f32_16x16x32_bf16 v[84:87], a[124:127], v[20:23], v[84:87]
    v_mfma_f32_16x16x32_bf16 v[88:91], v[20:23], a[144:147], v[88:91]
    v_mfma_f32_16x16x32_bf16 v[92:95], v[20:23], a[164:167], v[92:95]
    s_waitcnt lgkmcnt(8)
    v_pk_fma_f32 v[56:57], v[56:57], v[144:145], v[184:185]
    s_mov_b32 s27, 8192
    s_add_u32 m0, s98, 8192
    s_nop 0
    buffer_load_dwordx4 v116, s[32:35], s27 offen sc1 lds
    v_pk_fma_f32 v[58:59], v[58:59], v[146:147], v[186:187]
    v_pk_fma_f32 v[60:61], v[60:61], v[148:149], v[188:189]
    v_pk_fma_f32 v[62:63], v[62:63], v[150:151], v[190:191]
    v_cvt_pk_bf16_f32 v24, v56, v57
    v_cvt_pk_bf16_f32 v25, v58, v59
    v_cvt_pk_bf16_f32 v26, v60, v61
    s_mov_b32 s27, 9216
    s_add_u32 m0, s98, 9216
    s_nop 0
    buffer_load_dwordx4 v116, s[32:35], s27 offen sc1 lds
    v_cvt_pk_bf16_f32 v27, v62, v63
    buffer_store_dwordx4 v[24:27], v3, s[32:35], 0 offen offset:2048 sc1
    s_nop 0
    v_mfma_f32_16x16x32_bf16 v[80:83], a[108:111], v[24:27], v[80:83]
    v_mfma_f32_16x16x32_bf16 v[84:87], a[128:131], v[24:27], v[84:87]
    v_mfma_f32_16x16x32_bf16 v[88:91], v[24:27], a[148:151], v[88:91]
    v_mfma_f32_16x16x32_bf16 v[92:95], v[24:27], a[168:171], v[92:95]
    s_mov_b32 s27, 10240
    s_add_u32 m0, s98, 10240
    s_nop 0
    buffer_load_dwordx4 v116, s[32:35], s27 offen sc1 lds
    s_waitcnt lgkmcnt(4)
    v_pk_fma_f32 v[64:65], v[64:65], v[152:153], v[192:193]
    v_pk_fma_f32 v[66:67], v[66:67], v[154:155], v[194:195]
    v_pk_fma_f32 v[68:69], v[68:69], v[156:157], v[196:197]
    v_pk_fma_f32 v[70:71], v[70:71], v[158:159], v[198:199]
    v_cvt_pk_bf16_f32 v28, v64, v65
    v_cvt_pk_bf16_f32 v29, v66, v67
    s_mov_b32 s27, 11264
    s_add_u32 m0, s98, 11264
    s_nop 0
    buffer_load_dwordx4 v116, s[32:35], s27 offen sc1 lds
    v_cvt_pk_bf16_f32 v30, v68, v69
    v_cvt_pk_bf16_f32 v31, v70, v71
    buffer_store_dwordx4 v[28:31], v3, s[32:35], 0 offen offset:3072 sc1
    s_nop 0
    v_mfma_f32_16x16x32_bf16 v[80:83], a[112:115], v[28:31], v[80:83]
    v_mfma_f32_16x16x32_bf16 v[84:87], a[132:135], v[28:31], v[84:87]
    v_mfma_f32_16x16x32_bf16 v[88:91], v[28:31], a[152:155], v[88:91]
    s_mov_b32 s27, 12288
    s_add_u32 m0, s98, 12288
    s_nop 0
    buffer_load_dwordx4 v116, s[32:35], s27 offen sc1 lds
    v_mfma_f32_16x16x32_bf16 v[92:95], v[28:31], a[172:175], v[92:95]
    s_waitcnt lgkmcnt(0)
    v_pk_fma_f32 v[72:73], v[72:73], v[160:161], v[200:201]
    v_pk_fma_f32 v[74:75], v[74:75], v[162:163], v[202:203]
    v_pk_fma_f32 v[76:77], v[76:77], v[164:165], v[204:205]
    v_pk_fma_f32 v[78:79], v[78:79], v[166:167], v[206:207]
    v_cvt_pk_bf16_f32 v32, v72, v73
    s_mov_b32 s27, 13312
    s_add_u32 m0, s98, 13312
    s_nop 0
    buffer_load_dwordx4 v116, s[32:35], s27 offen sc1 lds
    v_cvt_pk_bf16_f32 v33, v74, v75
    v_cvt_pk_bf16_f32 v34, v76, v77
    v_cvt_pk_bf16_f32 v35, v78, v79
    s_mov_b32 s89, 4096
    buffer_store_dwordx4 v[32:35], v3, s[32:35], s89 offen offset:0 sc1
    v_mfma_f32_16x16x32_bf16 v[80:83], a[116:119], v[32:35], v[80:83]
    v_mfma_f32_16x16x32_bf16 v[84:87], a[136:139], v[32:35], v[84:87]
    s_mov_b32 s27, 14336
    s_add_u32 m0, s98, 14336
    s_nop 0
    buffer_load_dwordx4 v116, s[32:35], s27 offen sc1 lds
    v_mfma_f32_16x16x32_bf16 v[88:91], v[32:35], a[156:159], v[88:91]
    v_mfma_f32_16x16x32_bf16 v[92:95], v[32:35], a[176:179], v[92:95]
    s_mul_i32 s66, s80, 12864
    s_add_u32 s66, s66, 102400
    v_add_u32 v13, s66, v1
    s_lshl_b32 s66, s80, 10
    s_add_u32 s66, s66, 102400
    v_add_u32 v14, s66, v1
    v_accvgpr_read_b32 v38, a200
    v_accvgpr_read_b32 v39, a201
    s_mov_b32 s27, 15360
    s_add_u32 m0, s98, 15360
    s_nop 0
    buffer_load_dwordx4 v116, s[32:35], s27 offen sc1 lds
    s_cmp_eq_u32 s80, 1
    s_cselect_b32 s90, 0xf0000, 0
    s_mov_b32 s91, 0
    s_mov_b32 s3, 0x3ea52b5c
    s_cmp_lt_u32 s80, 2
    s_cselect_b32 s3, s3, 1.0
    ds_write_b128 v13, v[80:83] offset:0
    ds_write_b128 v13, v[84:87] offset:1024
    ds_write_b128 v13, v[88:91] offset:2048
    ds_write_b128 v13, v[92:95] offset:3072
    v_accvgpr_read_b32 v4, a202
    v_mov_b32 v6, s84
    s_mov_b32 s27, 16384
    s_add_u32 m0, s98, 16384
    s_nop 0
    buffer_load_dwordx4 v116, s[32:35], s27 offen sc1 lds
    s_waitcnt vmcnt(3)
    s_mov_b64 exec, 1
    buffer_store_dword v6, v4, s[32:35], 0 offen sc1
    s_mov_b64 exec, -1
    s_waitcnt lgkmcnt(0)
    s_barrier
    ds_read_b128 v[80:83], v14 offset:0
    ds_read_b128 v[84:87], v14 offset:12864
    ds_read_b128 v[88:91], v14 offset:25728
    ds_read_b128 v[92:95], v14 offset:38592
    s_waitcnt lgkmcnt(0)
    v_pk_add_f32 v[80:81], v[80:81], v[84:85]
    v_pk_add_f32 v[82:83], v[82:83], v[86:87]
    s_mov_b32 s27, 17408
    s_add_u32 m0, s98, 17408
    s_nop 0
    buffer_load_dwordx4 v116, s[32:35], s27 offen sc1 lds
    v_pk_add_f32 v[88:89], v[88:89], v[92:93]
    v_pk_add_f32 v[90:91], v[90:91], v[94:95]
    v_mov_b32 v84, s3
    v_pk_add_f32 v[80:81], v[80:81], v[88:89]
    v_pk_add_f32 v[82:83], v[82:83], v[90:91]
    v_pk_mul_f32 v[80:81], v[80:81], v[84:85] op_sel_hi:[1,0]
    s_mov_b32 s27, 18432
    s_add_u32 m0, s98, 18432
    s_nop 0
    buffer_load_dwordx4 v116, s[32:35], s27 offen sc1 lds
    v_pk_mul_f32 v[82:83], v[82:83], v[84:85] op_sel_hi:[1,0]
    v_cvt_pk_bf16_f32 v80, v80, v81
    v_cvt_pk_bf16_f32 v81, v82, v83
    v_cndmask_b32 v80, v80, v39, s[90:91]
    v_cndmask_b32 v81, v81, v39, s[90:91]
    buffer_store_dwordx2 v[80:81], v38, s[32:35], 0 offen offset:0 sc1
    s_mov_b32 s27, 19456
    s_add_u32 m0, s98, 19456
    s_nop 0
    buffer_load_dwordx4 v116, s[32:35], s27 offen sc1 lds
    s_mov_b32 s27, 20480
    s_add_u32 m0, s98, 20480
    s_nop 0
    buffer_load_dwordx4 v116, s[32:35], s27 offen sc1 lds
    s_mov_b32 s27, 21504
    s_add_u32 m0, s98, 21504
    s_nop 0
    buffer_load_dwordx4 v116, s[32:35], s27 offen sc1 lds
    s_mov_b32 s27, 22528
    s_add_u32 m0, s98, 22528
    s_nop 0
    buffer_load_dwordx4 v116, s[32:35], s27 offen sc1 lds
    s_mov_b32 s27, 23552
    s_add_u32 m0, s98, 23552
    s_nop 0
    buffer_load_dwordx4 v116, s[32:35], s27 offen sc1 lds
    s_mov_b32 s27, 24576
    s_add_u32 m0, s98, 24576
    s_nop 0
    buffer_load_dwordx4 v116, s[32:35], s27 offen sc1 lds
    v_accvgpr_read_b32 v8, a247
    v_accvgpr_read_b32 v9, a248
    v_accvgpr_read_b32 v10, a249
    v_accvgpr_read_b32 v11, a250
    v_accvgpr_read_b32 v12, a251
    s_add_u32 s3, s82, 0
    s_and_b32 s3, s3, 3
    s_mul_i32 s20, s3, 5120
    s_add_u32 s3, s82, 1
    s_and_b32 s3, s3, 3
    s_mul_i32 s21, s3, 5120
    s_add_u32 s3, s82, 2
    s_and_b32 s3, s3, 3
    s_mul_i32 s22, s3, 5120
    s_add_u32 s3, s82, 3
    s_and_b32 s3, s3, 3
    s_mul_i32 s23, s3, 5120
    s_lshl_b32 s3, s81, 12
    s_add_u32 s3, s3, 7602176
    s_lshl_b32 s2, s26, 8
    s_add_u32 s3, s3, s2
    v_and_b32 v7, 1, v0
    v_lshl_add_u32 v7, v7, 7, s3
    v_bfe_u32 v15, v0, 1, 2
    v_lshl_add_u32 v7, v15, 10, v7
    s_mul_i32 s3, s81, 81920
    s_mul_i32 s2, s26, 20480
    s_add_u32 s3, s3, s2
    s_add_u32 s3, s3, 15204352
    v_add_u32 v3, s3, v1
    v_add_u32 v2, 51200, v1
    s_mul_i32 s3, s80, 49152
    s_add_u32 s3, s3, 589824
    v_bfe_u32 v13, v0, 2, 1
    v_mul_u32_u24 v13, 768, v13
    v_bfe_u32 v14, v0, 4, 1
    v_mul_u32_u24 v14, 1536, v14
    v_add3_u32 v13, v13, v14, s3
    v_and_b32 v14, 3, v0
    v_bfe_u32 v36, v0, 3, 1
    v_lshl_add_u32 v14, v36, 2, v14
    v_lshrrev_b32 v36, 5, v0
    v_lshlrev_b32 v104, 7, v36
    v_lshl_add_u32 v104, v14, 4, v104
    v_add_u32 v104, v104, v13
    v_lshl_add_u32 v105, v14, 4, v13
    v_add_u32 v105, 640, v105
    s_add_u32 s2, s3, 592
    v_mov_b32 v38, s2
    v_cmp_gt_u32 vcc, 32, v0
    s_nop 1
    v_cndmask_b32 v105, v38, v105, vcc
    v_and_b32 v14, 31, v0
    v_lshlrev_b32 v38, 4, v14
    v_add_u32 v38, 256, v38
    v_min_u32 v38, 592, v38
    v_mul_u32_u24 v36, 768, v36
    v_add3_u32 v106, v38, v36, s3
    v_add_u32 v107, 1536, v106
    s_lshl_b32 s3, s80, 13
    s_add_u32 s3, s3, 983040
    v_lshl_add_u32 v4, v0, 7, s3
    s_mul_i32 s3, s80, 49152
    s_lshr_b32 s2, s101, 3
    s_mul_i32 s2, s2, 1536
    s_add_u32 s3, s3, s2
    s_add_u32 s3, s3, 589824
    v_lshl_add_u32 v108, v0, 7, s3
    s_lshl_b32 s3, s83, 7
    s_add_u32 s3, s3, 983040
    s_cmp_eq_u32 s80, 0
    s_cselect_b32 s3, s3, 2130706432
    v_mov_b32 v13, s3
    v_mov_b32 v14, s84
    s_waitcnt vmcnt(6)
    s_barrier
    s_mov_b64 exec, 1
    buffer_store_dword v14, v13, s[32:35], 0 offen sc1
    s_mov_b64 exec, -1
    s_waitcnt vmcnt(1)
    s_barrier
    s_mov_b32 s88, 400000
L_poll_19:
    s_mov_b64 exec, 0xff
    buffer_load_dword v14, v7, s[32:35], 0 offen sc1
    s_sub_u32 s88, s88, 1
    s_cbranch_scc1 L_end
    s_waitcnt vmcnt(0)
    v_cmp_ne_u32 vcc, s84, v14
    s_cbranch_vccnz L_poll_19
    s_mov_b64 exec, -1
    buffer_load_dwordx4 v[128:131], v3, s[32:35], s20 offen offset:0 sc1
    buffer_load_dwordx4 v[132:135], v3, s[32:35], s20 offen offset:1024 sc1
    buffer_load_dwordx4 v[136:139], v3, s[32:35], s20 offen offset:2048 sc1
    buffer_load_dwordx4 v[140:143], v3, s[32:35], s20 offen offset:3072 sc1
    s_add_u32 s89, s20, 4096
    buffer_load_dwordx4 v[144:147], v3, s[32:35], s89 offen offset:0 sc1
    buffer_load_dwordx4 v[148:151], v3, s[32:35], s21 offen offset:0 sc1
    buffer_load_dwordx4 v[152:155], v3, s[32:35], s21 offen offset:1024 sc1
    buffer_load_dwordx4 v[156:159], v3, s[32:35], s21 offen offset:2048 sc1
    buffer_load_dwordx4 v[160:163], v3, s[32:35], s21 offen offset:3072 sc1
    s_add_u32 s89, s21, 4096
    buffer_load_dwordx4 v[164:167], v3, s[32:35], s89 offen offset:0 sc1
    buffer_load_dwordx4 v[168:171], v3, s[32:35], s22 offen offset:0 sc1
    buffer_load_dwordx4 v[172:175], v3, s[32:35], s22 offen offset:1024 sc1
    ds_read_b128 v[16:19], v1 offset:0
    ds_read_b128 v[20:23], v1 offset:1024
    ds_read_b128 v[24:27], v1 offset:2048
    ds_read_b128 v[28:31], v1 offset:3072
    ds_read_b128 v[32:35], v1 offset:4096
    ds_read_b128 v[36:39], v1 offset:5120
    ds_read_b128 v[40:43], v1 offset:6144
    ds_read_b128 v[44:47], v1 offset:7168
    ds_read_b128 v[48:51], v1 offset:8192
    ds_read_b128 v[52:55], v1 offset:9216
    s_waitcnt vmcnt(11)
    s_waitcnt lgkmcnt(7)
    v_mfma_f32_16x16x32_bf16 v[80:83], v[16:19], v[128:131], 0
    ds_read_b128 v[56:59], v1 offset:10240
    v_mfma_f32_16x16x32_bf16 v[84:87], v[20:23], v[128:131], 0
    ds_read_b128 v[60:63], v1 offset:11264
    v_mfma_f32_16x16x32_bf16 v[88:91], v[24:27], v[128:131], 0
    ds_read_b128 v[64:67], v1 offset:12288
    buffer_load_dwordx4 v[176:179], v3, s[32:35], s22 offen offset:2048 sc1
    s_waitcnt lgkmcnt(8)
    v_mfma_f32_16x16x32_bf16 v[92:95], v[28:31], v[128:131], 0
    ds_read_b128 v[68:71], v1 offset:13312
    v_mfma_f32_16x16x32_bf16 v[96:99], v[32:35], v[128:131], 0
    ds_read_b128 v[72:75], v1 offset:14336
    s_waitcnt vmcnt(11)
    s_waitcnt lgkmcnt(7)
    v_mfma_f32_16x16x32_bf16 v[80:83], v[36:39], v[132:135], v[80:83]
    ds_read_b128 v[16:19], v1 offset:15360
    v_mfma_f32_16x16x32_bf16 v[84:87], v[40:43], v[132:135], v[84:87]
    ds_read_b128 v[20:23], v1 offset:16384
    v_mfma_f32_16x16x32_bf16 v[88:91], v[44:47], v[132:135], v[88:91]
    ds_read_b128 v[24:27], v1 offset:17408
    buffer_load_dwordx4 v[180:183], v3, s[32:35], s22 offen offset:3072 sc1
    s_waitcnt lgkmcnt(8)
    v_mfma_f32_16x16x32_bf16 v[92:95], v[48:51], v[132:135], v[92:95]
    ds_read_b128 v[28:31], v1 offset:18432
    v_mfma_f32_16x16x32_bf16 v[96:99], v[52:55], v[132:135], v[96:99]
    ds_read_b128 v[32:35], v1 offset:19456
    s_waitcnt vmcnt(11)
    s_waitcnt lgkmcnt(7)
    v_mfma_f32_16x16x32_bf16 v[80:83], v[56:59], v[136:139], v[80:83]
    ds_read_b128 v[36:39], v1 offset:20480
    v_mfma_f32_16x16x32_bf16 v[84:87], v[60:63], v[136:139], v[84:87]
    ds_read_b128 v[40:43], v1 offset:21504
    v_mfma_f32_16x16x32_bf16 v[88:91], v[64:67], v[136:139], v[88:91]
    ds_read_b128 v[44:47], v1 offset:22528
    s_add_u32 s89, s22, 4096
    buffer_load_dwordx4 v[184:187], v3, s[32:35], s89 offen offset:0 sc1
    s_waitcnt lgkmcnt(8)
    v_mfma_f32_16x16x32_bf16 v[92:95], v[68:71], v[136:139], v[92:95]
    ds_read_b128 v[48:51], v1 offset:23552
    v_mfma_f32_16x16x32_bf16 v[96:99], v[72:75], v[136:139], v[96:99]
    ds_read_b128 v[52:55], v1 offset:24576
    s_waitcnt vmcnt(11)
    s_waitcnt lgkmcnt(7)
    v_mfma_f32_16x16x32_bf16 v[80:83], v[16:19], v[140:143], v[80:83]
    ds_read_b128 v[56:59], v1 offset:25600
    v_mfma_f32_16x16x32_bf16 v[84:87], v[20:23], v[140:143], v[84:87]
    ds_read_b128 v[60:63], v1 offset:26624
    v_mfma_f32_16x16x32_bf16 v[88:91], v[24:27], v[140:143], v[88:91]
    ds_read_b128 v[64:67], v1 offset:27648
    buffer_load_dwordx4 v[188:191], v3, s[32:35], s23 offen offset:0 sc1
    s_waitcnt lgkmcnt(8)
    v_mfma_f32_16x16x32_bf16 v[92:95], v[28:31], v[140:143], v[92:95]
    ds_read_b128 v[68:71], v1 offset:28672
    v_mfma_f32_16x16x32_bf16 v[96:99], v[32:35], v[140:143], v[96:99]
    ds_read_b128 v[72:75], v1 offset:29696
    s_waitcnt vmcnt(11)
    s_waitcnt lgkmcnt(7)
    v_mfma_f32_16x16x32_bf16 v[80:83], v[36:39], v[144:147], v[80:83]
    ds_read_b128 v[16:19], v1 offset:30720
    v_mfma_f32_16x16x32_bf16 v[84:87], v[40:43], v[144:147], v[84:87]
    ds_read_b128 v[20:23], v1 offset:31744
    v_mfma_f32_16x16x32_bf16 v[88:91], v[44:47], v[144:147], v[88:91]
    ds_read_b128 v[24:27], v1 offset:32768
    buffer_load_dwordx4 v[192:195], v3, s[32:35], s23 offen offset:1024 sc1
    s_waitcnt lgkmcnt(8)
    v_mfma_f32_16x16x32_bf16 v[92:95], v[48:51], v[144:147], v[92:95]
    ds_read_b128 v[28:31], v1 offset:33792
    v_mfma_f32_16x16x32_bf16 v[96:99], v[52:55], v[144:147], v[96:99]
    ds_read_b128 v[32:35], v1 offset:34816
    s_waitcnt vmcnt(11)
    s_waitcnt lgkmcnt(7)
    v_mfma_f32_16x16x32_bf16 v[80:83], v[56:59], v[148:151], v[80:83]
    ds_read_b128 v[36:39], v1 offset:35840
    v_mfma_f32_16x16x32_bf16 v[84:87], v[60:63], v[148:151], v[84:87]
    ds_read_b128 v[40:43], v1 offset:36864
    v_mfma_f32_16x16x32_bf16 v[88:91], v[64:67], v[148:151], v[88:91]
    ds_read_b128 v[44:47], v1 offset:37888
    buffer_load_dwordx4 v[196:199], v3, s[32:35], s23 offen offset:2048 sc1
    s_waitcnt lgkmcnt(8)
    v_mfma_f32_16x16x32_bf16 v[92:95], v[68:71], v[148:151], v[92:95]
    ds_read_b128 v[48:51], v1 offset:38912
    v_mfma_f32_16x16x32_bf16 v[96:99], v[72:75], v[148:151], v[96:99]
    ds_read_b128 v[52:55], v1 offset:39936
    s_waitcnt vmcnt(11)
    s_waitcnt lgkmcnt(7)
    v_mfma_f32_16x16x32_bf16 v[80:83], v[16:19], v[152:155], v[80:83]
    ds_read_b128 v[56:59], v1 offset:40960
    v_mfma_f32_16x16x32_bf16 v[84:87], v[20:23], v[152:155], v[84:87]
    ds_read_b128 v[60:63], v1 offset:41984
    v_mfma_f32_16x16x32_bf16 v[88:91], v[24:27], v[152:155], v[88:91]
    ds_read_b128 v[64:67], v1 offset:43008
    buffer_load_dwordx4 v[200:203], v3, s[32:35], s23 offen offset:3072 sc1
    buffer_load_dword v100, v4, s[32:35], 0 offen sc1
    s_waitcnt lgkmcnt(8)
    v_mfma_f32_16x16x32_bf16 v[92:95], v[28:31], v[152:155], v[92:95]
    ds_read_b128 v[68:71], v1 offset:44032
    v_mfma_f32_16x16x32_bf16 v[96:99], v[32:35], v[152:155], v[96:99]
    ds_read_b128 v[72:75], v1 offset:45056
    s_waitcnt vmcnt(12)
    s_waitcnt lgkmcnt(7)
    v_mfma_f32_16x16x32_bf16 v[80:83], v[36:39], v[156:159], v[80:83]
    ds_read_b128 v[16:19], v1 offset:46080
    v_mfma_f32_16x16x32_bf16 v[84:87], v[40:43], v[156:159], v[84:87]
    ds_read_b128 v[20:23], v1 offset:47104
    v_mfma_f32_16x16x32_bf16 v[88:91], v[44:47], v[156:159], v[88:91]
    ds_read_b128 v[24:27], v1 offset:48128
    s_add_u32 s89, s23, 4096
    buffer_load_dwordx4 v[204:207], v3, s[32:35], s89 offen offset:0 sc1
    s_waitcnt lgkmcnt(8)
    v_mfma_f32_16x16x32_bf16 v[92:95], v[48:51], v[156:159], v[92:95]
    ds_read_b128 v[28:31], v1 offset:49152
    v_mfma_f32_16x16x32_bf16 v[96:99], v[52:55], v[156:159], v[96:99]
    ds_read_b128 v[32:35], v1 offset:50176
    s_waitcnt vmcnt(12)
    s_waitcnt lgkmcnt(7)
    v_mfma_f32_16x16x32_bf16 v[80:83], v[56:59], v[160:163], v[80:83]
    ds_read_b128 v[36:39], v2 offset:0
    v_mfma_f32_16x16x32_bf16 v[84:87], v[60:63], v[160:163], v[84:87]
    ds_read_b128 v[40:43], v2 offset:1024
    v_mfma_f32_16x16x32_bf16 v[88:91], v[64:67], v[160:163], v[88:91]
    ds_read_b128 v[44:47], v2 offset:2048
    s_waitcnt lgkmcnt(8)
    v_mfma_f32_16x16x32_bf16 v[92:95], v[68:71], v[160:163], v[92:95]
    ds_read_b128 v[48:51], v2 offset:3072
    v_mfma_f32_16x16x32_bf16 v[96:99], v[72:75], v[160:163], v[96:99]
    ds_read_b128 v[52:55], v2 offset:4096
    s_waitcnt vmcnt(11)
    s_waitcnt lgkmcnt(7)
    v_mfma_f32_16x16x32_bf16 v[80:83], v[16:19], v[164:167], v[80:83]
    ds_read_b128 v[56:59], v2 offset:5120
    v_mfma_f32_16x16x32_bf16 v[84:87], v[20:23], v[164:167], v[84:87]
    ds_read_b128 v[60:63], v2 offset:6144
    v_mfma_f32_16x16x32_bf16 v[88:91], v[24:27], v[164:167], v[88:91]
    ds_read_b128 v[64:67], v2 offset:7168
    s_waitcnt lgkmcnt(8)
    v_mfma_f32_16x16x32_bf16 v[92:95], v[28:31], v[164:167], v[92:95]
    ds_read_b128 v[68:71], v2 offset:8192
    v_mfma_f32_16x16x32_bf16 v[96:99], v[32:35], v[164:167], v[96:99]
    ds_read_b128 v[72:75], v2 offset:9216
    s_waitcnt vmcnt(10)
    s_waitcnt lgkmcnt(7)
    v_mfma_f32_16x16x32_bf16 v[80:83], v[36:39], v[168:171], v[80:83]
    ds_read_b128 v[16:19], v2 offset:10240
    v_mfma_f32_16x16x32_bf16 v[84:87], v[40:43], v[168:171], v[84:87]
    ds_read_b128 v[20:23], v2 offset:11264
    v_mfma_f32_16x16x32_bf16 v[88:91], v[44:47], v[168:171], v[88:91]
    ds_read_b128 v[24:27], v2 offset:12288
    s_waitcnt lgkmcnt(8)
    v_mfma_f32_16x16x32_bf16 v[92:95], v[48:51], v[168:171], v[92:95]
    ds_read_b128 v[28:31], v2 offset:13312
    v_mfma_f32_16x16x32_bf16 v[96:99], v[52:55], v[168:171], v[96:99]
    ds_read_b128 v[32:35], v2 offset:14336
    s_waitcnt vmcnt(9)
    s_waitcnt lgkmcnt(7)
    v_mfma_f32_16x16x32_bf16 v[80:83], v[56:59], v[172:175], v[80:83]
    ds_read_b128 v[36:39], v2 offset:15360
    v_mfma_f32_16x16x32_bf16 v[84:87], v[60:63], v[172:175], v[84:87]
    ds_read_b128 v[40:43], v2 offset:16384
    v_mfma_f32_16x16x32_bf16 v[88:91], v[64:67], v[172:175], v[88:91]
    ds_read_b128 v[44:47], v2 offset:17408
    s_waitcnt vmcnt(1)
    v_cmp_ne_u32 vcc, s84, v100
    s_cbranch_vccz L_ptok_21
    s_mov_b32 s88, 400000
L_poll_22:
    buffer_load_dword v100, v4, s[32:35], 0 offen sc1
    s_sub_u32 s88, s88, 1
    s_cbranch_scc1 L_end
    s_waitcnt vmcnt(0)
    v_cmp_ne_u32 vcc, s84, v100
    s_cbranch_vccnz L_poll_22
L_ptok_21:
    s_mov_b64 exec, 0xfff
    buffer_load_dword v244, v108, s[32:35], 0 offen offset:0 sc1
    s_mov_b64 exec, -1
    s_waitcnt lgkmcnt(8)
    v_mfma_f32_16x16x32_bf16 v[92:95], v[68:71], v[172:175], v[92:95]
    ds_read_b128 v[48:51], v2 offset:18432
    v_mfma_f32_16x16x32_bf16 v[96:99], v[72:75], v[172:175], v[96:99]
    ds_read_b128 v[52:55], v2 offset:19456
    s_waitcnt lgkmcnt(7)
    v_mfma_f32_16x16x32_bf16 v[80:83], v[16:19], v[176:179], v[80:83]
    ds_read_b128 v[56:59], v2 offset:20480
    buffer_load_dwordx4 a[0:3], v104, s[32:35], 0 offen offset:0 sc1
    v_mfma_f32_16x16x32_bf16 v[84:87], v[20:23], v[176:179], v[84:87]
    ds_read_b128 v[60:63], v2 offset:21504
    v_mfma_f32_16x16x32_bf16 v[88:91], v[24:27], v[176:179], v[88:91]
    ds_read_b128 v[64:67], v2 offset:22528
    s_waitcnt lgkmcnt(8)
    v_mfma_f32_16x16x32_bf16 v[92:95], v[28:31], v[176:179], v[92:95]
    ds_read_b128 v[68:71], v2 offset:23552
    v_mfma_f32_16x16x32_bf16 v[96:99], v[32:35], v[176:179], v[96:99]
    ds_read_b128 v[72:75], v2 offset:24576
    buffer_load_dwordx4 a[8:11], v105, s[32:35], 0 offen offset:0 sc1
    s_waitcnt lgkmcnt(7)
    v_mfma_f32_16x16x32_bf16 v[80:83], v[36:39], v[180:183], v[80:83]
    ds_read_b128 v[16:19], v2 offset:25600
    buffer_load_dwordx4 a[12:15], v106, s[32:35], 0 offen offset:0 sc1
    v_mfma_f32_16x16x32_bf16 v[84:87], v[40:43], v[180:183], v[84:87]
    ds_read_b128 v[20:23], v2 offset:26624
    v_mfma_f32_16x16x32_bf16 v[88:91], v[44:47], v[180:183], v[88:91]
    ds_read_b128 v[24:27], v2 offset:27648
    s_waitcnt lgkmcnt(8)
    v_mfma_f32_16x16x32_bf16 v[92:95], v[48:51], v[180:183], v[92:95]
    ds_read_b128 v[28:31], v2 offset:28672
    v_mfma_f32_16x16x32_bf16 v[96:99], v[52:55], v[180:183], v[96:99]
    ds_read_b128 v[32:35], v2 offset:29696
    buffer_load_dwordx4 a[16:19], v107, s[32:35], 0 offen offset:0 sc1
    s_waitcnt lgkmcnt(7)
    v_mfma_f32_16x16x32_bf16 v[80:83], v[56:59], v[184:187], v[80:83]
    ds_read_b128 v[36:39], v2 offset:30720
    buffer_load_dwordx4 a[4:7], v104, s[32:35], 0 offen offset:3072 sc1
    v_mfma_f32_16x16x32_bf16 v[84:87], v[60:63], v[184:187], v[84:87]
    ds_read_b128 v[40:43], v2 offset:31744
    v_mfma_f32_16x16x32_bf16 v[88:91], v[64:67], v[184:187], v[88:91]
    ds_read_b128 v[44:47], v2 offset:32768
    s_waitcnt lgkmcnt(8)
    v_mfma_f32_16x16x32_bf16 v[92:95], v[68:71], v[184:187], v[92:95]
    ds_read_b128 v[48:51], v2 offset:33792
    v_mfma_f32_16x16x32_bf16 v[96:99], v[72:75], v[184:187], v[96:99]
    ds_read_b128 v[52:55], v2 offset:34816
    buffer_load_dwordx4 a[20:23], v106, s[32:35], 0 offen offset:3072 sc1
    s_waitcnt lgkmcnt(7)
    v_mfma_f32_16x16x32_bf16 v[80:83], v[16:19], v[188:191], v[80:83]
    ds_read_b128 v[56:59], v2 offset:35840
    buffer_load_dwordx4 a[24:27], v107, s[32:35], 0 offen offset:3072 sc1
    v_mfma_f32_16x16x32_bf16 v[84:87], v[20:23], v[188:191], v[84:87]
    ds_read_b128 v[60:63], v2 offset:36864
    v_mfma_f32_16x16x32_bf16 v[88:91], v[24:27], v[188:191], v[88:91]
    ds_read_b128 v[64:67], v2 offset:37888
    s_waitcnt lgkmcnt(8)
    v_mfma_f32_16x16x32_bf16 v[92:95], v[28:31], v[188:191], v[92:95]
    ds_read_b128 v[68:71], v2 offset:38912
    v_mfma_f32_16x16x32_bf16 v[96:99], v[32:35], v[188:191], v[96:99]
    ds_read_b128 v[72:75], v2 offset:39936
    s_mov_b32 s89, 6144
    buffer_load_dwordx4 a[28:31], v104, s[32:35], s89 offen offset:0 sc1
    s_waitcnt lgkmcnt(7)
    v_mfma_f32_16x16x32_bf16 v[80:83], v[36:39], v[192:195], v[80:83]
    ds_read_b128 v[16:19], v2 offset:40960
    buffer_load_dwordx4 a[36:39], v105, s[32:35], s89 offen offset:0 sc1
    v_mfma_f32_16x16x32_bf16 v[84:87], v[40:43], v[192:195], v[84:87]
    ds_read_b128 v[20:23], v2 offset:41984
    v_mfma_f32_16x16x32_bf16 v[88:91], v[44:47], v[192:195], v[88:91]
    ds_read_b128 v[24:27], v2 offset:43008
    s_waitcnt lgkmcnt(8)
    v_mfma_f32_16x16x32_bf16 v[92:95], v[48:51], v[192:195], v[92:95]
    ds_read_b128 v[28:31], v2 offset:44032
    v_mfma_f32_16x16x32_bf16 v[96:99], v[52:55], v[192:195], v[96:99]
    ds_read_b128 v[32:35], v2 offset:45056
    s_waitcnt lgkmcnt(7)
    v_mfma_f32_16x16x32_bf16 v[80:83], v[56:59], v[196:199], v[80:83]
    ds_read_b128 v[36:39], v2 offset:46080
    v_mfma_f32_16x16x32_bf16 v[84:87], v[60:63], v[196:199], v[84:87]
    ds_read_b128 v[40:43], v2 offset:47104
    v_mfma_f32_16x16x32_bf16 v[88:91], v[64:67], v[196:199], v[88:91]
    ds_read_b128 v[44:47], v2 offset:48128
    s_waitcnt lgkmcnt(8)
    v_mfma_f32_16x16x32_bf16 v[92:95], v[68:71], v[196:199], v[92:95]
    ds_read_b128 v[48:51], v2 offset:49152
    v_mfma_f32_16x16x32_bf16 v[96:99], v[72:75], v[196:199], v[96:99]
    ds_read_b128 v[52:55], v2 offset:50176
    s_waitcnt lgkmcnt(7)
    v_mfma_f32_16x16x32_bf16 v[80:83], v[16:19], v[200:203], v[80:83]
    v_mfma_f32_16x16x32_bf16 v[84:87], v[20:23], v[200:203], v[84:87]
    v_mfma_f32_16x16x32_bf16 v[88:91], v[24:27], v[200:203], v[88:91]
    s_waitcnt lgkmcnt(5)
    v_mfma_f32_16x16x32_bf16 v[92:95], v[28:31], v[200:203], v[92:95]
    v_mfma_f32_16x16x32_bf16 v[96:99], v[32:35], v[200:203], v[96:99]
    s_waitcnt vmcnt(10)
    s_waitcnt lgkmcnt(2)
    v_mfma_f32_16x16x32_bf16 v[80:83], v[36:39], v[204:207], v[80:83]
    v_mfma_f32_16x16x32_bf16 v[84:87], v[40:43], v[204:207], v[84:87]
    v_mfma_f32_16x16x32_bf16 v[88:91], v[44:47], v[204:207], v[88:91]
    s_waitcnt lgkmcnt(0)
    v_mfma_f32_16x16x32_bf16 v[92:95], v[48:51], v[204:207], v[92:95]
    v_mfma_f32_16x16x32_bf16 v[96:99], v[52:55], v[204:207], v[96:99]
    s_nop 2
    v_cvt_pk_bf16_f32 v80, v80, v81
    v_cvt_pk_bf16_f32 v81, v82, v83
    ds_write_b64 v8, v[80:81]
    v_cvt_pk_bf16_f32 v84, v84, v85
    v_cvt_pk_bf16_f32 v85, v86, v87
    ds_write_b64 v9, v[84:85]
    v_cvt_pk_bf16_f32 v88, v88, v89
    v_cvt_pk_bf16_f32 v89, v90, v91
    ds_write_b64 v10, v[88:89]
    v_cvt_pk_bf16_f32 v92, v92, v93
    v_cvt_pk_bf16_f32 v93, v94, v95
    ds_write_b64 v11, v[92:93]
    v_cvt_pk_bf16_f32 v96, v96, v97
    v_cvt_pk_bf16_f32 v97, v98, v99
    ds_write_b64 v12, v[96:97]
    v_mov_b32 v13, 157376
    v_mov_b32 v14, 0
    ds_write_b32 v13, v14
    s_waitcnt lgkmcnt(0)
    s_barrier
    v_and_b32 v13, 31, v0
    v_lshrrev_b32 v14, 5, v0
    v_lshlrev_b32 v14, 9, v14
    v_lshl_add_u32 v14, v13, 4, v14
    v_add_u32 v2, 102400, v14
    v_lshlrev_b32 v13, 3, v13
    v_add_u32 v3, 103424, v13
    s_lshl_b32 s22, s80, 1
    s_add_u32 s22, s22, 0
    s_and_b32 s22, s22, 7
    s_mul_i32 s23, s22, 1280
    v_add_u32 v8, s23, v2
    v_add_u32 v9, s23, v3
    ds_read_b128 v[88:91], v8
    ds_read_b64 v[92:93], v9
    s_waitcnt lgkmcnt(0)
    s_waitcnt vmcnt(7)
    v_mfma_f32_32x32x16_bf16 v[16:31], a[0:3], v[88:91], 0
    v_mfma_f32_32x32x8_bf16 v[16:31], a[8:9], v[92:93], v[16:31]
    s_nop 11
    v_exp_f32 v16, v16
    v_exp_f32 v17, v17
    s_lshl_b32 s22, s80, 1
    s_add_u32 s22, s22, 1
    buffer_load_dwordx4 a[40:43], v106, s[32:35], s89 offen offset:0 sc1
    v_exp_f32 v18, v18
    v_cvt_pk_bf16_f32 v48, v16, v17
    v_exp_f32 v19, v19
    v_exp_f32 v20, v20
    v_cvt_pk_bf16_f32 v49, v18, v19
    s_waitcnt vmcnt(5)
    v_mfma_f32_32x32x16_bf16 v[32:47], a[4:7], v[88:91], 0
    s_and_b32 s22, s22, 7
    s_mul_i32 s23, s22, 1280
    buffer_load_dwordx4 a[44:47], v107, s[32:35], s89 offen offset:0 sc1
    v_exp_f32 v21, v21
    v_exp_f32 v22, v22
    v_cvt_pk_bf16_f32 v50, v20, v21
    v_exp_f32 v23, v23
    v_exp_f32 v24, v24
    v_cvt_pk_bf16_f32 v51, v22, v23
    v_mfma_f32_32x32x8_bf16 v[32:47], a[10:11], v[92:93], v[32:47]
    v_add_u32 v8, s23, v2
    v_add_u32 v9, s23, v3
    s_mul_i32 s23, s22, 3072
    buffer_load_dwordx4 a[32:35], v104, s[32:35], s89 offen offset:3072 sc1
    v_exp_f32 v25, v25
    v_exp_f32 v26, v26
    v_cvt_pk_bf16_f32 v52, v24, v25
    v_exp_f32 v27, v27
    v_exp_f32 v28, v28
    v_mfma_f32_32x32x16_bf16 v[56:71], a[12:15], v[48:51], 0
    v_add_u32 v10, s23, v1
    s_add_u32 s22, s22, 6
    buffer_load_dwordx4 a[48:51], v106, s[32:35], s89 offen offset:3072 sc1
    v_exp_f32 v29, v29
    v_cvt_pk_bf16_f32 v53, v26, v27
    v_exp_f32 v30, v30
    v_exp_f32 v31, v31
    v_cvt_pk_bf16_f32 v54, v28, v29
    v_cvt_pk_bf16_f32 v55, v30, v31
    v_exp_f32 v32, v32
    v_exp_f32 v33, v33
    v_mfma_f32_32x32x16_bf16 v[56:71], a[16:19], v[52:55], v[56:71]
    s_and_b32 s22, s22, 7
    s_mul_i32 s23, s22, 3072
    v_add_u32 v4, s23, v1
    buffer_load_dwordx4 a[52:55], v107, s[32:35], s89 offen offset:3072 sc1
    v_exp_f32 v34, v34
    v_cvt_pk_bf16_f32 v48, v32, v33
    v_exp_f32 v35, v35
    v_exp_f32 v36, v36
    v_cvt_pk_bf16_f32 v49, v34, v35
    s_waitcnt vmcnt(5)
    v_mfma_f32_32x32x16_bf16 v[16:31], a[28:31], v[88:91], 0
    s_mov_b32 s89, 12288
    buffer_load_dwordx4 a[56:59], v104, s[32:35], s89 offen offset:0 sc1
    v_exp_f32 v37, v37
    v_exp_f32 v38, v38
    v_cvt_pk_bf16_f32 v50, v36, v37
    v_exp_f32 v39, v39
    v_exp_f32 v40, v40
    v_cvt_pk_bf16_f32 v51, v38, v39
    v_mfma_f32_32x32x8_bf16 v[16:31], a[36:37], v[92:93], v[16:31]
    buffer_load_dwordx4 a[64:67], v105, s[32:35], s89 offen offset:0 sc1
    v_exp_f32 v41, v41
    v_exp_f32 v42, v42
    v_cvt_pk_bf16_f32 v52, v40, v41
    v_exp_f32 v43, v43
    v_exp_f32 v44, v44
    v_mfma_f32_32x32x16_bf16 v[56:71], a[20:23], v[48:51], v[56:71]
    buffer_load_dwordx4 a[68:71], v106, s[32:35], s89 offen offset:0 sc1
    v_exp_f32 v45, v45
    v_cvt_pk_bf16_f32 v53, v42, v43
    v_exp_f32 v46, v46
    v_exp_f32 v47, v47
    v_cvt_pk_bf16_f32 v54, v44, v45
    v_cvt_pk_bf16_f32 v55, v46, v47
    v_exp_f32 v16, v16
    v_exp_f32 v17, v17
    v_mfma_f32_32x32x16_bf16 v[56:71], a[24:27], v[52:55], v[56:71]
    ds_read_b128 v[96:99], v8
    ds_read_b64 v[100:101], v9
    buffer_load_dwordx4 a[72:75], v107, s[32:35], s89 offen offset:0 sc1
    v_exp_f32 v18, v18
    v_cvt_pk_bf16_f32 v48, v16, v17
    v_exp_f32 v19, v19
    v_exp_f32 v20, v20
    v_cvt_pk_bf16_f32 v49, v18, v19
    s_waitcnt vmcnt(6)
    v_mfma_f32_32x32x16_bf16 v[32:47], a[32:35], v[88:91], 0
    buffer_load_dwordx4 a[60:63], v104, s[32:35], s89 offen offset:3072 sc1
    v_exp_f32 v21, v21
    v_exp_f32 v22, v22
    v_cvt_pk_bf16_f32 v50, v20, v21
    v_exp_f32 v23, v23
    v_exp_f32 v24, v24
    v_cvt_pk_bf16_f32 v51, v22, v23
    v_mfma_f32_32x32x8_bf16 v[32:47], a[38:39], v[92:93], v[32:47]
    buffer_load_dwordx4 a[76:79], v106, s[32:35], s89 offen offset:3072 sc1
    v_exp_f32 v25, v25
    v_exp_f32 v26, v26
    v_cvt_pk_bf16_f32 v52, v24, v25
    v_exp_f32 v27, v27
    v_exp_f32 v28, v28
    v_mfma_f32_32x32x16_bf16 v[56:71], a[40:43], v[48:51], v[56:71]
    buffer_load_dwordx4 a[80:83], v107, s[32:35], s89 offen offset:3072 sc1
    v_exp_f32 v29, v29
    v_cvt_pk_bf16_f32 v53, v26, v27
    v_exp_f32 v30, v30
    v_exp_f32 v31, v31
    v_cvt_pk_bf16_f32 v54, v28, v29
    v_cvt_pk_bf16_f32 v55, v30, v31
    v_exp_f32 v32, v32
    v_exp_f32 v33, v33
    v_mfma_f32_32x32x16_bf16 v[56:71], a[44:47], v[52:55], v[56:71]
    s_mov_b32 s89, 18432
    buffer_load_dwordx4 a[84:87], v104, s[32:35], s89 offen offset:0 sc1
    v_exp_f32 v34, v34
    v_cvt_pk_bf16_f32 v48, v32, v33
    v_exp_f32 v35, v35
    v_exp_f32 v36, v36
    v_cvt_pk_bf16_f32 v49, v34, v35
    s_waitcnt vmcnt(6)
    v_mfma_f32_32x32x16_bf16 v[16:31], a[56:59], v[88:91], 0
    buffer_load_dwordx4 a[92:95], v105, s[32:35], s89 offen offset:0 sc1
    v_exp_f32 v37, v37
    v_exp_f32 v38, v38
    v_cvt_pk_bf16_f32 v50, v36, v37
    v_exp_f32 v39, v39
    v_exp_f32 v40, v40
    v_cvt_pk_bf16_f32 v51, v38, v39
    v_mfma_f32_32x32x8_bf16 v[16:31], a[64:65], v[92:93], v[16:31]
    buffer_load_dwordx4 a[96:99], v106, s[32:35], s89 offen offset:0 sc1
    v_exp_f32 v41, v41
    v_exp_f32 v42, v42
    v_cvt_pk_bf16_f32 v52, v40, v41
    v_exp_f32 v43, v43
    v_exp_f32 v44, v44
    v_mfma_f32_32x32x16_bf16 v[56:71], a[48:51], v[48:51], v[56:71]
    buffer_load_dwordx4 a[100:103], v107, s[32:35], s89 offen offset:0 sc1
    v_exp_f32 v45, v45
    v_cvt_pk_bf16_f32 v53, v42, v43
    v_exp_f32 v46, v46
    v_exp_f32 v47, v47
    v_cvt_pk_bf16_f32 v54, v44, v45
    v_cvt_pk_bf16_f32 v55, v46, v47
    v_exp_f32 v16, v16
    v_exp_f32 v17, v17
    v_mfma_f32_32x32x16_bf16 v[56:71], a[52:55], v[52:55], v[56:71]
    buffer_load_dwordx4 a[88:91], v104, s[32:35], s89 offen offset:3072 sc1
    v_exp_f32 v18, v18
    v_cvt_pk_bf16_f32 v48, v16, v17
    v_exp_f32 v19, v19
    v_exp_f32 v20, v20
    v_cvt_pk_bf16_f32 v49, v18, v19
    s_waitcnt vmcnt(7)
    v_mfma_f32_32x32x16_bf16 v[32:47], a[60:63], v[88:91], 0
    buffer_load_dwordx4 a[104:107], v106, s[32:35], s89 offen offset:3072 sc1
    v_exp_f32 v21, v21
    v_exp_f32 v22, v22
    v_cvt_pk_bf16_f32 v50, v20, v21
    v_exp_f32 v23, v23
    v_exp_f32 v24, v24
    v_cvt_pk_bf16_f32 v51, v22, v23
    v_mfma_f32_32x32x8_bf16 v[32:47], a[66:67], v[92:93], v[32:47]
    buffer_load_dwordx4 a[108:111], v107, s[32:35], s89 offen offset:3072 sc1
    v_exp_f32 v25, v25
    v_exp_f32 v26, v26
    v_cvt_pk_bf16_f32 v52, v24, v25
    v_exp_f32 v27, v27
    v_exp_f32 v28, v28
    v_mfma_f32_32x32x16_bf16 v[56:71], a[68:71], v[48:51], v[56:71]
    s_mov_b32 s89, 24576
    buffer_load_dwordx4 a[112:115], v104, s[32:35], s89 offen offset:0 sc1
    v_exp_f32 v29, v29
    v_cvt_pk_bf16_f32 v53, v26, v27
    v_exp_f32 v30, v30
    v_exp_f32 v31, v31
    v_cvt_pk_bf16_f32 v54, v28, v29
    v_cvt_pk_bf16_f32 v55, v30, v31
    v_exp_f32 v32, v32
    v_exp_f32 v33, v33
    v_mfma_f32_32x32x16_bf16 v[56:71], a[72:75], v[52:55], v[56:71]
    buffer_load_dwordx4 a[120:123], v105, s[32:35], s89 offen offset:0 sc1
    v_exp_f32 v34, v34
    v_cvt_pk_bf16_f32 v48, v32, v33
    v_exp_f32 v35, v35
    v_exp_f32 v36, v36
    v_cvt_pk_bf16_f32 v49, v34, v35
    s_waitcnt vmcnt(7)
    v_mfma_f32_32x32x16_bf16 v[16:31], a[84:87], v[88:91], 0
    buffer_load_dwordx4 a[124:127], v106, s[32:35], s89 offen offset:0 sc1
    v_exp_f32 v37, v37
    v_exp_f32 v38, v38
    v_cvt_pk_bf16_f32 v50, v36, v37
    v_exp_f32 v39, v39
    v_exp_f32 v40, v40
    v_cvt_pk_bf16_f32 v51, v38, v39
    v_mfma_f32_32x32x8_bf16 v[16:31], a[92:93], v[92:93], v[16:31]
    buffer_load_dwordx4 a[128:131], v107, s[32:35], s89 offen offset:0 sc1
    v_exp_f32 v41, v41
    v_exp_f32 v42, v42
    v_cvt_pk_bf16_f32 v52, v40, v41
    v_exp_f32 v43, v43
    v_exp_f32 v44, v44
    v_mfma_f32_32x32x16_bf16 v[56:71], a[76:79], v[48:51], v[56:71]
    buffer_load_dwordx4 a[116:119], v104, s[32:35], s89 offen offset:3072 sc1
    v_exp_f32 v45, v45
    v_cvt_pk_bf16_f32 v53, v42, v43
    v_exp_f32 v46, v46
    v_exp_f32 v47, v47
    v_cvt_pk_bf16_f32 v54, v44, v45
    v_cvt_pk_bf16_f32 v55, v46, v47
    v_exp_f32 v16, v16
    v_exp_f32 v17, v17
    v_mfma_f32_32x32x16_bf16 v[56:71], a[80:83], v[52:55], v[56:71]
    buffer_load_dwordx4 a[132:135], v106, s[32:35], s89 offen offset:3072 sc1
    v_exp_f32 v18, v18
    v_cvt_pk_bf16_f32 v48, v16, v17
    v_exp_f32 v19, v19
    v_exp_f32 v20, v20
    v_cvt_pk_bf16_f32 v49, v18, v19
    s_waitcnt vmcnt(8)
    v_mfma_f32_32x32x16_bf16 v[32:47], a[88:91], v[88:91], 0
    buffer_load_dwordx4 a[136:139], v107, s[32:35], s89 offen offset:3072 sc1
    v_exp_f32 v21, v21
    v_exp_f32 v22, v22
    v_cvt_pk_bf16_f32 v50, v20, v21
    v_exp_f32 v23, v23
    v_exp_f32 v24, v24
    v_cvt_pk_bf16_f32 v51, v22, v23
    v_mfma_f32_32x32x8_bf16 v[32:47], a[94:95], v[92:93], v[32:47]
    s_mov_b32 s89, 30720
    buffer_load_dwordx4 a[140:143], v104, s[32:35], s89 offen offset:0 sc1
    v_exp_f32 v25, v25
    v_exp_f32 v26, v26
    v_cvt_pk_bf16_f32 v52, v24, v25
    v_exp_f32 v27, v27
    v_exp_f32 v28, v28
    v_mfma_f32_32x32x16_bf16 v[56:71], a[96:99], v[48:51], v[56:71]
    buffer_load_dwordx4 a[148:151], v105, s[32:35], s89 offen offset:0 sc1
    v_exp_f32 v29, v29
    v_cvt_pk_bf16_f32 v53, v26, v27
    v_exp_f32 v30, v30
    v_exp_f32 v31, v31
    v_cvt_pk_bf16_f32 v54, v28, v29
    v_cvt_pk_bf16_f32 v55, v30, v31
    v_exp_f32 v32, v32
    v_exp_f32 v33, v33
    v_mfma_f32_32x32x16_bf16 v[56:71], a[100:103], v[52:55], v[56:71]
    buffer_load_dwordx4 a[152:155], v106, s[32:35], s89 offen offset:0 sc1
    v_exp_f32 v34, v34
    v_cvt_pk_bf16_f32 v48, v32, v33
    v_exp_f32 v35, v35
    v_exp_f32 v36, v36
    v_cvt_pk_bf16_f32 v49, v34, v35
    s_waitcnt vmcnt(8)
    v_mfma_f32_32x32x16_bf16 v[16:31], a[112:115], v[88:91], 0
    buffer_load_dwordx4 a[156:159], v107, s[32:35], s89 offen offset:0 sc1
    v_exp_f32 v37, v37
    v_exp_f32 v38, v38
    v_cvt_pk_bf16_f32 v50, v36, v37
    v_exp_f32 v39, v39
    v_exp_f32 v40, v40
    v_cvt_pk_bf16_f32 v51, v38, v39
    v_mfma_f32_32x32x8_bf16 v[16:31], a[120:121], v[92:93], v[16:31]
    buffer_load_dwordx4 a[144:147], v104, s[32:35], s89 offen offset:3072 sc1
    v_exp_f32 v41, v41
    v_exp_f32 v42, v42
    v_cvt_pk_bf16_f32 v52, v40, v41
    v_exp_f32 v43, v43
    v_exp_f32 v44, v44
    v_mfma_f32_32x32x16_bf16 v[56:71], a[104:107], v[48:51], v[56:71]
    buffer_load_dwordx4 a[160:163], v106, s[32:35], s89 offen offset:3072 sc1
    v_exp_f32 v45, v45
    v_cvt_pk_bf16_f32 v53, v42, v43
    v_exp_f32 v46, v46
    v_exp_f32 v47, v47
    v_cvt_pk_bf16_f32 v54, v44, v45
    v_cvt_pk_bf16_f32 v55, v46, v47
    v_exp_f32 v16, v16
    v_exp_f32 v17, v17
    v_mfma_f32_32x32x16_bf16 v[56:71], a[108:111], v[52:55], v[56:71]
    buffer_load_dwordx4 a[164:167], v107, s[32:35], s89 offen offset:3072 sc1
    v_exp_f32 v18, v18
    v_cvt_pk_bf16_f32 v48, v16, v17
    v_exp_f32 v19, v19
    v_exp_f32 v20, v20
    v_cvt_pk_bf16_f32 v49, v18, v19
    s_waitcnt vmcnt(9)
    v_mfma_f32_32x32x16_bf16 v[32:47], a[116:119], v[88:91], 0
    s_mov_b32 s89, 36864
    buffer_load_dwordx4 a[168:171], v104, s[32:35], s89 offen offset:0 sc1
    v_exp_f32 v21, v21
    v_exp_f32 v22, v22
    v_cvt_pk_bf16_f32 v50, v20, v21
    v_exp_f32 v23, v23
    v_exp_f32 v24, v24
    v_cvt_pk_bf16_f32 v51, v22, v23
    v_mfma_f32_32x32x8_bf16 v[32:47], a[122:123], v[92:93], v[32:47]
    buffer_load_dwordx4 a[176:179], v105, s[32:35], s89 offen offset:0 sc1
    v_exp_f32 v25, v25
    v_exp_f32 v26, v26
    v_cvt_pk_bf16_f32 v52, v24, v25
    v_exp_f32 v27, v27
    v_exp_f32 v28, v28
    v_mfma_f32_32x32x16_bf16 v[56:71], a[124:127], v[48:51], v[56:71]
    buffer_load_dwordx4 a[180:183], v106, s[32:35], s89 offen offset:0 sc1
    v_exp_f32 v29, v29
    v_cvt_pk_bf16_f32 v53, v26, v27
    v_exp_f32 v30, v30
    v_exp_f32 v31, v31
    v_cvt_pk_bf16_f32 v54, v28, v29
    v_cvt_pk_bf16_f32 v55, v30, v31
    v_exp_f32 v32, v32
    v_exp_f32 v33, v33
    v_mfma_f32_32x32x16_bf16 v[56:71], a[128:131], v[52:55], v[56:71]
    buffer_load_dwordx4 a[184:187], v107, s[32:35], s89 offen offset:0 sc1
    v_exp_f32 v34, v34
    v_cvt_pk_bf16_f32 v48, v32, v33
    v_exp_f32 v35, v35
    v_exp_f32 v36, v36
    v_cvt_pk_bf16_f32 v49, v34, v35
    s_waitcnt vmcnt(9)
    v_mfma_f32_32x32x16_bf16 v[16:31], a[140:143], v[88:91], 0
    buffer_load_dwordx4 a[172:175], v104, s[32:35], s89 offen offset:3072 sc1
    v_exp_f32 v37, v37
    v_exp_f32 v38, v38
    v_cvt_pk_bf16_f32 v50, v36, v37
    v_exp_f32 v39, v39
    v_exp_f32 v40, v40
    v_cvt_pk_bf16_f32 v51, v38, v39
    v_mfma_f32_32x32x8_bf16 v[16:31], a[148:149], v[92:93], v[16:31]
    buffer_load_dwordx4 a[188:191], v106, s[32:35], s89 offen offset:3072 sc1
    v_exp_f32 v41, v41
    v_exp_f32 v42, v42
    v_cvt_pk_bf16_f32 v52, v40, v41
    v_exp_f32 v43, v43
    v_exp_f32 v44, v44
    v_mfma_f32_32x32x16_bf16 v[56:71], a[132:135], v[48:51], v[56:71]
    buffer_load_dwordx4 a[192:195], v107, s[32:35], s89 offen offset:3072 sc1
    v_exp_f32 v45, v45
    v_cvt_pk_bf16_f32 v53, v42, v43
    v_exp_f32 v46, v46
    v_exp_f32 v47, v47
    v_cvt_pk_bf16_f32 v54, v44, v45
    v_cvt_pk_bf16_f32 v55, v46, v47
    v_exp_f32 v16, v16
    v_exp_f32 v17, v17
    v_mfma_f32_32x32x16_bf16 v[56:71], a[136:139], v[52:55], v[56:71]
    s_mov_b32 s89, 43008
    buffer_load_dwordx4 a[196:199], v104, s[32:35], s89 offen offset:0 sc1
    v_exp_f32 v18, v18
    v_cvt_pk_bf16_f32 v48, v16, v17
    v_exp_f32 v19, v19
    v_exp_f32 v20, v20
    v_cvt_pk_bf16_f32 v49, v18, v19
    s_waitcnt vmcnt(10)
    v_mfma_f32_32x32x16_bf16 v[32:47], a[144:147], v[88:91], 0
    buffer_load_dwordx4 a[204:207], v105, s[32:35], s89 offen offset:0 sc1
    v_exp_f32 v21, v21
    v_exp_f32 v22, v22
    v_cvt_pk_bf16_f32 v50, v20, v21
    v_exp_f32 v23, v23
    v_exp_f32 v24, v24
    v_cvt_pk_bf16_f32 v51, v22, v23
    v_mfma_f32_32x32x8_bf16 v[32:47], a[150:151], v[92:93], v[32:47]
    buffer_load_dwordx4 a[208:211], v106, s[32:35], s89 offen offset:0 sc1
    v_exp_f32 v25, v25
    v_exp_f32 v26, v26
    v_cvt_pk_bf16_f32 v52, v24, v25
    v_exp_f32 v27, v27
    v_exp_f32 v28, v28
    v_mfma_f32_32x32x16_bf16 v[56:71], a[152:155], v[48:51], v[56:71]
    buffer_load_dwordx4 a[212:215], v107, s[32:35], s89 offen offset:0 sc1
    v_exp_f32 v29, v29
    v_cvt_pk_bf16_f32 v53, v26, v27
    v_exp_f32 v30, v30
    v_exp_f32 v31, v31
    v_cvt_pk_bf16_f32 v54, v28, v29
    v_cvt_pk_bf16_f32 v55, v30, v31
    v_exp_f32 v32, v32
    v_exp_f32 v33, v33
    v_mfma_f32_32x32x16_bf16 v[56:71], a[156:159], v[52:55], v[56:71]
    buffer_load_dwordx4 a[200:203], v104, s[32:35], s89 offen offset:3072 sc1
    v_exp_f32 v34, v34
    v_cvt_pk_bf16_f32 v48, v32, v33
    v_exp_f32 v35, v35
    v_exp_f32 v36, v36
    v_cvt_pk_bf16_f32 v49, v34, v35
    s_waitcnt vmcnt(10)
    v_mfma_f32_32x32x16_bf16 v[16:31], a[168:171], v[88:91], 0
    buffer_load_dwordx4 a[216:219], v106, s[32:35], s89 offen offset:3072 sc1
    v_exp_f32 v37, v37
    v_exp_f32 v38, v38
    v_cvt_pk_bf16_f32 v50, v36, v37
    v_exp_f32 v39, v39
    v_exp_f32 v40, v40
    v_cvt_pk_bf16_f32 v51, v38, v39
    v_mfma_f32_32x32x8_bf16 v[16:31], a[176:177], v[92:93], v[16:31]
    buffer_load_dwordx4 a[220:223], v107, s[32:35], s89 offen offset:3072 sc1
    v_exp_f32 v41, v41
    v_exp_f32 v42, v42
    v_cvt_pk_bf16_f32 v52, v40, v41
    v_exp_f32 v43, v43
    v_exp_f32 v44, v44
    v_mfma_f32_32x32x16_bf16 v[56:71], a[160:163], v[48:51], v[56:71]
    v_exp_f32 v45, v45
    v_cvt_pk_bf16_f32 v53, v42, v43
    v_exp_f32 v46, v46
    v_exp_f32 v47, v47
    v_cvt_pk_bf16_f32 v54, v44, v45
    v_cvt_pk_bf16_f32 v55, v46, v47
    v_exp_f32 v16, v16
    v_exp_f32 v17, v17
    v_mfma_f32_32x32x16_bf16 v[56:71], a[164:167], v[52:55], v[56:71]
    v_exp_f32 v18, v18
    v_cvt_pk_bf16_f32 v48, v16, v17
    v_exp_f32 v19, v19
    v_exp_f32 v20, v20
    v_cvt_pk_bf16_f32 v49, v18, v19
    s_waitcnt vmcnt(9)
    v_mfma_f32_32x32x16_bf16 v[32:47], a[172:175], v[88:91], 0
    v_exp_f32 v21, v21
    v_exp_f32 v22, v22
    v_cvt_pk_bf16_f32 v50, v20, v21
    v_exp_f32 v23, v23
    v_exp_f32 v24, v24
    v_cvt_pk_bf16_f32 v51, v22, v23
    v_mfma_f32_32x32x8_bf16 v[32:47], a[178:179], v[92:93], v[32:47]
    v_exp_f32 v25, v25
    v_exp_f32 v26, v26
    v_cvt_pk_bf16_f32 v52, v24, v25
    v_exp_f32 v27, v27
    v_exp_f32 v28, v28
    v_mfma_f32_32x32x16_bf16 v[56:71], a[180:183], v[48:51], v[56:71]
    v_exp_f32 v29, v29
    v_cvt_pk_bf16_f32 v53, v26, v27
    v_exp_f32 v30, v30
    v_exp_f32 v31, v31
    v_cvt_pk_bf16_f32 v54, v28, v29
    v_cvt_pk_bf16_f32 v55, v30, v31
    v_exp_f32 v32, v32
    v_exp_f32 v33, v33
    v_mfma_f32_32x32x16_bf16 v[56:71], a[184:187], v[52:55], v[56:71]
    v_exp_f32 v34, v34
    v_cvt_pk_bf16_f32 v48, v32, v33
    v_exp_f32 v35, v35
    v_exp_f32 v36, v36
    v_cvt_pk_bf16_f32 v49, v34, v35
    s_waitcnt vmcnt(5)
    v_mfma_f32_32x32x16_bf16 v[16:31], a[196:199], v[88:91], 0
    s_mul_i32 s24, s80, 9216
    v_exp_f32 v37, v37
    v_exp_f32 v38, v38
    v_cvt_pk_bf16_f32 v50, v36, v37
    v_exp_f32 v39, v39
    v_exp_f32 v40, v40
    v_cvt_pk_bf16_f32 v51, v38, v39
    v_mfma_f32_32x32x8_bf16 v[16:31], a[204:205], v[92:93], v[16:31]
    s_add_u32 s24, s24, 112640
    v_exp_f32 v41, v41
    v_exp_f32 v42, v42
    v_cvt_pk_bf16_f32 v52, v40, v41
    v_exp_f32 v43, v43
    v_exp_f32 v44, v44
    v_mfma_f32_32x32x16_bf16 v[56:71], a[188:191], v[48:51], v[56:71]
    v_exp_f32 v45, v45
    v_cvt_pk_bf16_f32 v53, v42, v43
    v_exp_f32 v46, v46
    v_exp_f32 v47, v47
    v_cvt_pk_bf16_f32 v54, v44, v45
    v_cvt_pk_bf16_f32 v55, v46, v47
    v_exp_f32 v16, v16
    v_exp_f32 v17, v17
    v_mfma_f32_32x32x16_bf16 v[56:71], a[192:195], v[52:55], v[56:71]
    v_accvgpr_read_b32 v154, a237
    v_exp_f32 v18, v18
    v_cvt_pk_bf16_f32 v48, v16, v17
    v_exp_f32 v19, v19
    v_exp_f32 v20, v20
    v_cvt_pk_bf16_f32 v49, v18, v19
    s_waitcnt vmcnt(2)
    v_mfma_f32_32x32x16_bf16 v[32:47], a[200:203], v[88:91], 0
    s_add_u32 m0, s24, 0
    s_nop 0
    buffer_load_dwordx4 v154, s[56:59], 0 offen  lds
    v_exp_f32 v21, v21
    v_exp_f32 v22, v22
    v_cvt_pk_bf16_f32 v50, v20, v21
    v_exp_f32 v23, v23
    v_exp_f32 v24, v24
    v_cvt_pk_bf16_f32 v51, v22, v23
    v_mfma_f32_32x32x8_bf16 v[32:47], a[206:207], v[92:93], v[32:47]
    v_exp_f32 v25, v25
    v_exp_f32 v26, v26
    v_cvt_pk_bf16_f32 v52, v24, v25
    v_exp_f32 v27, v27
    v_exp_f32 v28, v28
    v_mfma_f32_32x32x16_bf16 v[56:71], a[208:211], v[48:51], v[56:71]
    s_mov_b32 s89, 24576
    s_add_u32 m0, s24, 1024
    s_nop 0
    buffer_load_dwordx4 v154, s[56:59], s89 offen  lds
    v_exp_f32 v29, v29
    v_cvt_pk_bf16_f32 v53, v26, v27
    v_exp_f32 v30, v30
    v_exp_f32 v31, v31
    v_cvt_pk_bf16_f32 v54, v28, v29
    v_cvt_pk_bf16_f32 v55, v30, v31
    v_exp_f32 v32, v32
    v_exp_f32 v33, v33
    v_mfma_f32_32x32x16_bf16 v[56:71], a[212:215], v[52:55], v[56:71]
    s_add_u32 m0, s24, 2048
    s_nop 0
    buffer_load_dwordx4 v154, s[60:63], 0 offen  lds
    v_exp_f32 v34, v34
    v_cvt_pk_bf16_f32 v48, v32, v33
    v_exp_f32 v35, v35
    v_exp_f32 v36, v36
    v_cvt_pk_bf16_f32 v49, v34, v35
    s_waitcnt lgkmcnt(0)
    v_mfma_f32_32x32x16_bf16 v[16:31], a[0:3], v[96:99], 0
    v_exp_f32 v37, v37
    v_exp_f32 v38, v38
    v_cvt_pk_bf16_f32 v50, v36, v37
    v_exp_f32 v39, v39
    v_exp_f32 v40, v40
    v_cvt_pk_bf16_f32 v51, v38, v39
    v_mfma_f32_32x32x8_bf16 v[16:31], a[8:9], v[100:101], v[16:31]
    s_add_u32 m0, s24, 3072
    s_nop 0
    buffer_load_dwordx4 v154, s[60:63], s89 offen  lds
    v_exp_f32 v41, v41
    v_exp_f32 v42, v42
    v_cvt_pk_bf16_f32 v52, v40, v41
    v_exp_f32 v43, v43
    v_exp_f32 v44, v44
    s_waitcnt vmcnt(4)
    v_mfma_f32_32x32x16_bf16 v[56:71], a[216:219], v[48:51], v[56:71]
    v_exp_f32 v45, v45
    v_cvt_pk_bf16_f32 v53, v42, v43
    v_exp_f32 v46, v46
    v_exp_f32 v47, v47
    v_cvt_pk_bf16_f32 v54, v44, v45
    v_cvt_pk_bf16_f32 v55, v46, v47
    v_exp_f32 v16, v16
    v_exp_f32 v17, v17
    v_mfma_f32_32x32x16_bf16 v[56:71], a[220:223], v[52:55], v[56:71]
    s_lshl_b32 s22, s80, 1
    s_add_u32 s22, s22, 2
    v_exp_f32 v18, v18
    v_cvt_pk_bf16_f32 v48, v16, v17
    v_exp_f32 v19, v19
    v_exp_f32 v20, v20
    v_cvt_pk_bf16_f32 v49, v18, v19
    v_mfma_f32_32x32x16_bf16 v[32:47], a[4:7], v[96:99], 0
    s_and_b32 s22, s22, 7
    s_mul_i32 s23, s22, 1280
    v_exp_f32 v21, v21
    v_exp_f32 v22, v22
    v_cvt_pk_bf16_f32 v50, v20, v21
    v_exp_f32 v23, v23
    v_exp_f32 v24, v24
    v_cvt_pk_bf16_f32 v51, v22, v23
    v_mfma_f32_32x32x8_bf16 v[32:47], a[10:11], v[100:101], v[32:47]
    v_add_u32 v8, s23, v2
    v_add_u32 v9, s23, v3
    s_mul_i32 s23, s22, 3072
    v_exp_f32 v25, v25
    v_exp_f32 v26, v26
    v_cvt_pk_bf16_f32 v52, v24, v25
    v_exp_f32 v27, v27
    v_exp_f32 v28, v28
    v_mfma_f32_32x32x16_bf16 v[72:87], a[12:15], v[48:51], 0
    v_add_u32 v10, s23, v1
    s_add_u32 s22, s22, 6
    v_exp_f32 v29, v29
    v_cvt_pk_bf16_f32 v53, v26, v27
    v_exp_f32 v30, v30
    v_exp_f32 v31, v31
    v_cvt_pk_bf16_f32 v54, v28, v29
    v_cvt_pk_bf16_f32 v55, v30, v31
    v_exp_f32 v32, v32
    v_exp_f32 v33, v33
    v_mfma_f32_32x32x16_bf16 v[72:87], a[16:19], v[52:55], v[72:87]
    s_and_b32 s22, s22, 7
    s_mul_i32 s23, s22, 3072
    v_add_u32 v4, s23, v1
    v_exp_f32 v34, v34
    v_cvt_pk_bf16_f32 v48, v32, v33
    v_exp_f32 v35, v35
    v_exp_f32 v36, v36
    v_cvt_pk_bf16_f32 v49, v34, v35
    v_mfma_f32_32x32x16_bf16 v[16:31], a[28:31], v[96:99], 0
    ds_write_b128 v4, v[56:59] offset:0
    v_exp_f32 v37, v37
    v_exp_f32 v38, v38
    v_cvt_pk_bf16_f32 v50, v36, v37
    v_exp_f32 v39, v39
    v_exp_f32 v40, v40
    v_cvt_pk_bf16_f32 v51, v38, v39
    v_mfma_f32_32x32x8_bf16 v[16:31], a[36:37], v[100:101], v[16:31]
    ds_write_b128 v4, v[60:63] offset:1024
    v_exp_f32 v41, v41
    v_exp_f32 v42, v42
    v_cvt_pk_bf16_f32 v52, v40, v41
    v_exp_f32 v43, v43
    v_exp_f32 v44, v44
    v_mfma_f32_32x32x16_bf16 v[72:87], a[20:23], v[48:51], v[72:87]
    ds_write_b128 v4, v[64:67] offset:2048
    v_exp_f32 v45, v45
    v_cvt_pk_bf16_f32 v53, v42, v43
    v_exp_f32 v46, v46
    v_exp_f32 v47, v47
    v_cvt_pk_bf16_f32 v54, v44, v45
    v_cvt_pk_bf16_f32 v55, v46, v47
    v_exp_f32 v16, v16
    v_exp_f32 v17, v17
    v_mfma_f32_32x32x16_bf16 v[72:87], a[24:27], v[52:55], v[72:87]
    ds_read_b128 v[88:91], v8
    ds_read_b64 v[92:93], v9
    v_exp_f32 v18, v18
    v_cvt_pk_bf16_f32 v48, v16, v17
    v_exp_f32 v19, v19
    v_exp_f32 v20, v20
    v_cvt_pk_bf16_f32 v49, v18, v19
    v_mfma_f32_32x32x16_bf16 v[32:47], a[32:35], v[96:99], 0
    v_exp_f32 v21, v21
    v_exp_f32 v22, v22
    v_cvt_pk_bf16_f32 v50, v20, v21
    v_exp_f32 v23, v23
    v_exp_f32 v24, v24
    v_cvt_pk_bf16_f32 v51, v22, v23
    v_mfma_f32_32x32x8_bf16 v[32:47], a[38:39], v[100:101], v[32:47]
    v_exp_f32 v25, v25
    v_exp_f32 v26, v26
    v_cvt_pk_bf16_f32 v52, v24, v25
    v_exp_f32 v27, v27
    v_exp_f32 v28, v28
    v_mfma_f32_32x32x16_bf16 v[72:87], a[40:43], v[48:51], v[72:87]
    v_exp_f32 v29, v29
    v_cvt_pk_bf16_f32 v53, v26, v27
    v_exp_f32 v30, v30
    v_exp_f32 v31, v31
    v_cvt_pk_bf16_f32 v54, v28, v29
    v_cvt_pk_bf16_f32 v55, v30, v31
    v_exp_f32 v32, v32
    v_exp_f32 v33, v33
    v_mfma_f32_32x32x16_bf16 v[72:87], a[44:47], v[52:55], v[72:87]
    s_waitcnt lgkmcnt(0)
    s_barrier
    v_exp_f32 v34, v34
    v_cvt_pk_bf16_f32 v48, v32, v33
    v_exp_f32 v35, v35
    v_exp_f32 v36, v36
    v_cvt_pk_bf16_f32 v49, v34, v35
    v_mfma_f32_32x32x16_bf16 v[16:31], a[56:59], v[96:99], 0
    ds_read_b128 v[56:59], v10
    v_exp_f32 v37, v37
    v_exp_f32 v38, v38
    v_cvt_pk_bf16_f32 v50, v36, v37
    v_exp_f32 v39, v39
    v_exp_f32 v40, v40
    v_cvt_pk_bf16_f32 v51, v38, v39
    v_mfma_f32_32x32x8_bf16 v[16:31], a[64:65], v[100:101], v[16:31]
    ds_read_b128 v[60:63], v10 offset:1024
    v_exp_f32 v41, v41
    v_exp_f32 v42, v42
    v_cvt_pk_bf16_f32 v52, v40, v41
    v_exp_f32 v43, v43
    v_exp_f32 v44, v44
    v_mfma_f32_32x32x16_bf16 v[72:87], a[48:51], v[48:51], v[72:87]
    ds_read_b128 v[64:67], v10 offset:2048
    v_exp_f32 v45, v45
    v_cvt_pk_bf16_f32 v53, v42, v43
    v_exp_f32 v46, v46
    v_exp_f32 v47, v47
    v_cvt_pk_bf16_f32 v54, v44, v45
    v_cvt_pk_bf16_f32 v55, v46, v47
    v_exp_f32 v16, v16
    v_exp_f32 v17, v17
    v_mfma_f32_32x32x16_bf16 v[72:87], a[52:55], v[52:55], v[72:87]
    v_accvgpr_read_b32 v155, a232
    v_exp_f32 v18, v18
    v_cvt_pk_bf16_f32 v48, v16, v17
    v_exp_f32 v19, v19
    v_exp_f32 v20, v20
    v_cvt_pk_bf16_f32 v49, v18, v19
    v_mfma_f32_32x32x16_bf16 v[32:47], a[60:63], v[96:99], 0
    v_exp_f32 v21, v21
    v_exp_f32 v22, v22
    v_cvt_pk_bf16_f32 v50, v20, v21
    v_exp_f32 v23, v23
    v_exp_f32 v24, v24
    v_cvt_pk_bf16_f32 v51, v22, v23
    v_mfma_f32_32x32x8_bf16 v[32:47], a[66:67], v[100:101], v[32:47]
    v_accvgpr_read_b32 v156, a233
    v_exp_f32 v25, v25
    v_exp_f32 v26, v26
    v_cvt_pk_bf16_f32 v52, v24, v25
    v_exp_f32 v27, v27
    v_exp_f32 v28, v28
    v_mfma_f32_32x32x16_bf16 v[72:87], a[68:71], v[48:51], v[72:87]
    v_exp_f32 v29, v29
    v_cvt_pk_bf16_f32 v53, v26, v27
    v_exp_f32 v30, v30
    v_exp_f32 v31, v31
    v_cvt_pk_bf16_f32 v54, v28, v29
    v_cvt_pk_bf16_f32 v55, v30, v31
    v_exp_f32 v32, v32
    v_exp_f32 v33, v33
    v_mfma_f32_32x32x16_bf16 v[72:87], a[72:75], v[52:55], v[72:87]
    v_accvgpr_read_b32 v157, a234
    v_exp_f32 v34, v34
    v_cvt_pk_bf16_f32 v48, v32, v33
    v_exp_f32 v35, v35
    v_exp_f32 v36, v36
    v_cvt_pk_bf16_f32 v49, v34, v35
    v_mfma_f32_32x32x16_bf16 v[16:31], a[84:87], v[96:99], 0
    v_exp_f32 v37, v37
    v_exp_f32 v38, v38
    v_cvt_pk_bf16_f32 v50, v36, v37
    v_exp_f32 v39, v39
    v_exp_f32 v40, v40
    v_cvt_pk_bf16_f32 v51, v38, v39
    v_mfma_f32_32x32x8_bf16 v[16:31], a[92:93], v[100:101], v[16:31]
    v_exp_f32 v41, v41
    v_exp_f32 v42, v42
    v_cvt_pk_bf16_f32 v52, v40, v41
    v_exp_f32 v43, v43
    v_exp_f32 v44, v44
    v_mfma_f32_32x32x16_bf16 v[72:87], a[76:79], v[48:51], v[72:87]
    v_accvgpr_read_b32 v158, a235
    v_exp_f32 v45, v45
    v_cvt_pk_bf16_f32 v53, v42, v43
    v_exp_f32 v46, v46
    v_exp_f32 v47, v47
    v_cvt_pk_bf16_f32 v54, v44, v45
    v_cvt_pk_bf16_f32 v55, v46, v47
    v_exp_f32 v16, v16
    v_exp_f32 v17, v17
    v_mfma_f32_32x32x16_bf16 v[72:87], a[80:83], v[52:55], v[72:87]
    v_exp_f32 v18, v18
    v_cvt_pk_bf16_f32 v48, v16, v17
    v_exp_f32 v19, v19
    v_exp_f32 v20, v20
    v_cvt_pk_bf16_f32 v49, v18, v19
    v_mfma_f32_32x32x16_bf16 v[32:47], a[88:91], v[96:99], 0
    v_accvgpr_read_b32 v159, a236
    v_exp_f32 v21, v21
    v_exp_f32 v22, v22
    v_cvt_pk_bf16_f32 v50, v20, v21
    v_exp_f32 v23, v23
    v_exp_f32 v24, v24
    v_cvt_pk_bf16_f32 v51, v22, v23
    v_mfma_f32_32x32x8_bf16 v[32:47], a[94:95], v[100:101], v[32:47]
    v_exp_f32 v25, v25
    v_exp_f32 v26, v26
    v_cvt_pk_bf16_f32 v52, v24, v25
    v_exp_f32 v27, v27
    v_exp_f32 v28, v28
    v_mfma_f32_32x32x16_bf16 v[72:87], a[96:99], v[48:51], v[72:87]
    v_exp_f32 v29, v29
    v_cvt_pk_bf16_f32 v53, v26, v27
    v_exp_f32 v30, v30
    v_exp_f32 v31, v31
    v_cvt_pk_bf16_f32 v54, v28, v29
    v_cvt_pk_bf16_f32 v55, v30, v31
    v_exp_f32 v32, v32
    v_exp_f32 v33, v33
    v_mfma_f32_32x32x16_bf16 v[72:87], a[100:103], v[52:55], v[72:87]
    s_add_u32 m0, s24, 4096
    s_nop 0
    buffer_load_dwordx4 v155, s[52:55], 0 offen  lds
    v_exp_f32 v34, v34
    v_cvt_pk_bf16_f32 v48, v32, v33
    v_exp_f32 v35, v35
    v_exp_f32 v36, v36
    v_cvt_pk_bf16_f32 v49, v34, v35
    v_mfma_f32_32x32x16_bf16 v[16:31], a[112:115], v[96:99], 0
    v_exp_f32 v37, v37
    v_exp_f32 v38, v38
    v_cvt_pk_bf16_f32 v50, v36, v37
    v_exp_f32 v39, v39
    v_exp_f32 v40, v40
    v_cvt_pk_bf16_f32 v51, v38, v39
    v_mfma_f32_32x32x8_bf16 v[16:31], a[120:121], v[100:101], v[16:31]
    s_add_u32 m0, s24, 5120
    s_nop 0
    buffer_load_dwordx4 v156, s[52:55], 0 offen  lds
    v_exp_f32 v41, v41
    v_exp_f32 v42, v42
    v_cvt_pk_bf16_f32 v52, v40, v41
    v_exp_f32 v43, v43
    v_exp_f32 v44, v44
    v_mfma_f32_32x32x16_bf16 v[72:87], a[104:107], v[48:51], v[72:87]
    v_exp_f32 v45, v45
    v_cvt_pk_bf16_f32 v53, v42, v43
    v_exp_f32 v46, v46
    v_exp_f32 v47, v47
    v_cvt_pk_bf16_f32 v54, v44, v45
    v_cvt_pk_bf16_f32 v55, v46, v47
    v_exp_f32 v16, v16
    v_exp_f32 v17, v17
    v_mfma_f32_32x32x16_bf16 v[72:87], a[108:111], v[52:55], v[72:87]
    s_add_u32 m0, s24, 6144
    s_nop 0
    buffer_load_dwordx4 v157, s[52:55], 0 offen  lds
    v_exp_f32 v18, v18
    v_cvt_pk_bf16_f32 v48, v16, v17
    v_exp_f32 v19, v19
    v_exp_f32 v20, v20
    v_cvt_pk_bf16_f32 v49, v18, v19
    v_mfma_f32_32x32x16_bf16 v[32:47], a[116:119], v[96:99], 0
    v_exp_f32 v21, v21
    v_exp_f32 v22, v22
    v_cvt_pk_bf16_f32 v50, v20, v21
    v_exp_f32 v23, v23
    v_exp_f32 v24, v24
    v_cvt_pk_bf16_f32 v51, v22, v23
    v_mfma_f32_32x32x8_bf16 v[32:47], a[122:123], v[100:101], v[32:47]
    v_exp_f32 v25, v25
    v_exp_f32 v26, v26
    v_cvt_pk_bf16_f32 v52, v24, v25
    v_exp_f32 v27, v27
    v_exp_f32 v28, v28
    v_mfma_f32_32x32x16_bf16 v[72:87], a[124:127], v[48:51], v[72:87]
    s_add_u32 m0, s24, 7168
    s_nop 0
    buffer_load_dwordx4 v158, s[52:55], 0 offen  lds
    v_exp_f32 v29, v29
    v_cvt_pk_bf16_f32 v53, v26, v27
    v_exp_f32 v30, v30
    v_exp_f32 v31, v31
    v_cvt_pk_bf16_f32 v54, v28, v29
    v_cvt_pk_bf16_f32 v55, v30, v31
    v_exp_f32 v32, v32
    v_exp_f32 v33, v33
    v_mfma_f32_32x32x16_bf16 v[72:87], a[128:131], v[52:55], v[72:87]
    v_exp_f32 v34, v34
    v_cvt_pk_bf16_f32 v48, v32, v33
    v_exp_f32 v35, v35
    v_exp_f32 v36, v36
    v_cvt_pk_bf16_f32 v49, v34, v35
    v_mfma_f32_32x32x16_bf16 v[16:31], a[140:143], v[96:99], 0
    s_add_u32 m0, s24, 8192
    s_nop 0
    buffer_load_dwordx4 v159, s[52:55], 0 offen  lds
    v_exp_f32 v37, v37
    v_exp_f32 v38, v38
    v_cvt_pk_bf16_f32 v50, v36, v37
    v_exp_f32 v39, v39
    v_exp_f32 v40, v40
    v_cvt_pk_bf16_f32 v51, v38, v39
    v_mfma_f32_32x32x8_bf16 v[16:31], a[148:149], v[100:101], v[16:31]
    v_exp_f32 v41, v41
    v_exp_f32 v42, v42
    v_cvt_pk_bf16_f32 v52, v40, v41
    v_exp_f32 v43, v43
    v_exp_f32 v44, v44
    v_mfma_f32_32x32x16_bf16 v[72:87], a[132:135], v[48:51], v[72:87]
    v_exp_f32 v45, v45
    v_cvt_pk_bf16_f32 v53, v42, v43
    v_exp_f32 v46, v46
    v_exp_f32 v47, v47
    v_cvt_pk_bf16_f32 v54, v44, v45
    v_cvt_pk_bf16_f32 v55, v46, v47
    v_exp_f32 v16, v16
    v_exp_f32 v17, v17
    v_mfma_f32_32x32x16_bf16 v[72:87], a[136:139], v[52:55], v[72:87]
    v_exp_f32 v18, v18
    v_cvt_pk_bf16_f32 v48, v16, v17
    v_exp_f32 v19, v19
    v_exp_f32 v20, v20
    v_cvt_pk_bf16_f32 v49, v18, v19
    v_mfma_f32_32x32x16_bf16 v[32:47], a[144:147], v[96:99], 0
    v_exp_f32 v21, v21
    v_exp_f32 v22, v22
    v_cvt_pk_bf16_f32 v50, v20, v21
    v_exp_f32 v23, v23
    v_exp_f32 v24, v24
    v_cvt_pk_bf16_f32 v51, v22, v23
    v_mfma_f32_32x32x8_bf16 v[32:47], a[150:151], v[100:101], v[32:47]
    v_exp_f32 v25, v25
    v_exp_f32 v26, v26
    v_cvt_pk_bf16_f32 v52, v24, v25
    v_exp_f32 v27, v27
    v_exp_f32 v28, v28
    v_mfma_f32_32x32x16_bf16 v[72:87], a[152:155], v[48:51], v[72:87]
    v_exp_f32 v29, v29
    v_cvt_pk_bf16_f32 v53, v26, v27
    v_exp_f32 v30, v30
    v_exp_f32 v31, v31
    v_cvt_pk_bf16_f32 v54, v28, v29
    v_cvt_pk_bf16_f32 v55, v30, v31
    v_exp_f32 v32, v32
    v_exp_f32 v33, v33
    v_mfma_f32_32x32x16_bf16 v[72:87], a[156:159], v[52:55], v[72:87]
    v_exp_f32 v34, v34
    v_cvt_pk_bf16_f32 v48, v32, v33
    v_exp_f32 v35, v35
    v_exp_f32 v36, v36
    v_cvt_pk_bf16_f32 v49, v34, v35
    v_mfma_f32_32x32x16_bf16 v[16:31], a[168:171], v[96:99], 0
    v_exp_f32 v37, v37
    v_exp_f32 v38, v38
    v_cvt_pk_bf16_f32 v50, v36, v37
    v_exp_f32 v39, v39
    v_exp_f32 v40, v40
    v_cvt_pk_bf16_f32 v51, v38, v39
    v_mfma_f32_32x32x8_bf16 v[16:31], a[176:177], v[100:101], v[16:31]
    v_exp_f32 v41, v41
    v_exp_f32 v42, v42
    v_cvt_pk_bf16_f32 v52, v40, v41
    v_exp_f32 v43, v43
    v_exp_f32 v44, v44
    v_mfma_f32_32x32x16_bf16 v[72:87], a[160:163], v[48:51], v[72:87]
    v_exp_f32 v45, v45
    v_cvt_pk_bf16_f32 v53, v42, v43
    v_exp_f32 v46, v46
    v_exp_f32 v47, v47
    v_cvt_pk_bf16_f32 v54, v44, v45
    v_cvt_pk_bf16_f32 v55, v46, v47
    v_exp_f32 v16, v16
    v_exp_f32 v17, v17
    v_mfma_f32_32x32x16_bf16 v[72:87], a[164:167], v[52:55], v[72:87]
    v_exp_f32 v18, v18
    v_cvt_pk_bf16_f32 v48, v16, v17
    v_exp_f32 v19, v19
    v_exp_f32 v20, v20
    v_cvt_pk_bf16_f32 v49, v18, v19
    v_mfma_f32_32x32x16_bf16 v[32:47], a[172:175], v[96:99], 0
    v_exp_f32 v21, v21
    v_exp_f32 v22, v22
    v_cvt_pk_bf16_f32 v50, v20, v21
    v_exp_f32 v23, v23
    v_exp_f32 v24, v24
    v_cvt_pk_bf16_f32 v51, v22, v23
    v_mfma_f32_32x32x8_bf16 v[32:47], a[178:179], v[100:101], v[32:47]
    v_exp_f32 v25, v25
    v_exp_f32 v26, v26
    v_cvt_pk_bf16_f32 v52, v24, v25
    v_exp_f32 v27, v27
    v_exp_f32 v28, v28
    v_mfma_f32_32x32x16_bf16 v[72:87], a[180:183], v[48:51], v[72:87]
    v_exp_f32 v29, v29
    v_cvt_pk_bf16_f32 v53, v26, v27
    v_exp_f32 v30, v30
    v_exp_f32 v31, v31
    v_cvt_pk_bf16_f32 v54, v28, v29
    v_cvt_pk_bf16_f32 v55, v30, v31
    v_exp_f32 v32, v32
    v_exp_f32 v33, v33
    v_mfma_f32_32x32x16_bf16 v[72:87], a[184:187], v[52:55], v[72:87]
    v_exp_f32 v34, v34
    v_cvt_pk_bf16_f32 v48, v32, v33
    v_exp_f32 v35, v35
    v_exp_f32 v36, v36
    v_cvt_pk_bf16_f32 v49, v34, v35
    v_mfma_f32_32x32x16_bf16 v[16:31], a[196:199], v[96:99], 0
    v_exp_f32 v37, v37
    v_exp_f32 v38, v38
    v_cvt_pk_bf16_f32 v50, v36, v37
    v_exp_f32 v39, v39
    v_exp_f32 v40, v40
    v_cvt_pk_bf16_f32 v51, v38, v39
    v_mfma_f32_32x32x8_bf16 v[16:31], a[204:205], v[100:101], v[16:31]
    v_exp_f32 v41, v41
    v_exp_f32 v42, v42
    v_cvt_pk_bf16_f32 v52, v40, v41
    v_exp_f32 v43, v43
    v_exp_f32 v44, v44
    v_mfma_f32_32x32x16_bf16 v[72:87], a[188:191], v[48:51], v[72:87]
    v_exp_f32 v45, v45
    v_cvt_pk_bf16_f32 v53, v42, v43
    v_exp_f32 v46, v46
    v_exp_f32 v47, v47
    v_cvt_pk_bf16_f32 v54, v44, v45
    v_cvt_pk_bf16_f32 v55, v46, v47
    v_exp_f32 v16, v16
    v_exp_f32 v17, v17
    v_mfma_f32_32x32x16_bf16 v[72:87], a[192:195], v[52:55], v[72:87]
    v_exp_f32 v18, v18
    v_cvt_pk_bf16_f32 v48, v16, v17
    v_exp_f32 v19, v19
    v_exp_f32 v20, v20
    v_cvt_pk_bf16_f32 v49, v18, v19
    v_mfma_f32_32x32x16_bf16 v[32:47], a[200:203], v[96:99], 0
    v_exp_f32 v21, v21
    v_exp_f32 v22, v22
    v_cvt_pk_bf16_f32 v50, v20, v21
    v_exp_f32 v23, v23
    v_exp_f32 v24, v24
    v_cvt_pk_bf16_f32 v51, v22, v23
    v_mfma_f32_32x32x8_bf16 v[32:47], a[206:207], v[100:101], v[32:47]
    v_accvgpr_read_b32 v14, a231
    v_exp_f32 v25, v25
    v_exp_f32 v26, v26
    v_cvt_pk_bf16_f32 v52, v24, v25
    v_exp_f32 v27, v27
    v_exp_f32 v28, v28
    v_mfma_f32_32x32x16_bf16 v[72:87], a[208:211], v[48:51], v[72:87]
    v_exp_f32 v29, v29
    v_cvt_pk_bf16_f32 v53, v26, v27
    v_exp_f32 v30, v30
    v_exp_f32 v31, v31
    v_cvt_pk_bf16_f32 v54, v28, v29
    v_cvt_pk_bf16_f32 v55, v30, v31
    v_exp_f32 v32, v32
    v_exp_f32 v33, v33
    v_mfma_f32_32x32x16_bf16 v[72:87], a[212:215], v[52:55], v[72:87]
    s_mov_b32 exec_lo, -1
    s_mov_b32 exec_hi, 0xff
    buffer_load_dword v244, v14, s[32:35], 0 offen offset:0 sc1
    s_mov_b64 exec, -1
    v_exp_f32 v34, v34
    v_cvt_pk_bf16_f32 v48, v32, v33
    v_exp_f32 v35, v35
    v_exp_f32 v36, v36
    v_cvt_pk_bf16_f32 v49, v34, v35
    s_waitcnt lgkmcnt(0)
    v_mfma_f32_32x32x16_bf16 v[16:31], a[0:3], v[88:91], 0
    v_exp_f32 v37, v37
    v_exp_f32 v38, v38
    v_cvt_pk_bf16_f32 v50, v36, v37
    v_exp_f32 v39, v39
    v_exp_f32 v40, v40
    v_cvt_pk_bf16_f32 v51, v38, v39
    v_mfma_f32_32x32x8_bf16 v[16:31], a[8:9], v[92:93], v[16:31]
    v_exp_f32 v41, v41
    v_exp_f32 v42, v42
    v_cvt_pk_bf16_f32 v52, v40, v41
    v_exp_f32 v43, v43
    v_exp_f32 v44, v44
    v_mfma_f32_32x32x16_bf16 v[72:87], a[216:219], v[48:51], v[72:87]
    v_exp_f32 v45, v45
    v_cvt_pk_bf16_f32 v53, v42, v43
    v_exp_f32 v46, v46
    v_exp_f32 v47, v47
    v_cvt_pk_bf16_f32 v54, v44, v45
    v_cvt_pk_bf16_f32 v55, v46, v47
    v_exp_f32 v16, v16
    v_exp_f32 v17, v17
    v_mfma_f32_32x32x16_bf16 v[72:87], a[220:223], v[52:55], v[72:87]
    s_lshl_b32 s22, s80, 1
    s_add_u32 s22, s22, 3
    v_accvgpr_read_b32 v153, a238
    v_exp_f32 v18, v18
    v_cvt_pk_bf16_f32 v48, v16, v17
    v_exp_f32 v19, v19
    v_exp_f32 v20, v20
    v_cvt_pk_bf16_f32 v49, v18, v19
    v_mfma_f32_32x32x16_bf16 v[32:47], a[4:7], v[88:91], 0
    s_and_b32 s22, s22, 7
    s_mul_i32 s23, s22, 1280
    v_accvgpr_read_b32 v128, a239
    v_exp_f32 v21, v21
    v_exp_f32 v22, v22
    v_cvt_pk_bf16_f32 v50, v20, v21
    v_exp_f32 v23, v23
    v_exp_f32 v24, v24
    v_cvt_pk_bf16_f32 v51, v22, v23
    v_mfma_f32_32x32x8_bf16 v[32:47], a[10:11], v[92:93], v[32:47]
    v_add_u32 v8, s23, v2
    v_add_u32 v9, s23, v3
    s_mul_i32 s23, s22, 3072
    v_exp_f32 v25, v25
    v_exp_f32 v26, v26
    v_cvt_pk_bf16_f32 v52, v24, v25
    v_exp_f32 v27, v27
    v_exp_f32 v28, v28
    v_mfma_f32_32x32x16_bf16 v[56:71], a[12:15], v[48:51], v[56:71]
    v_add_u32 v10, s23, v1
    s_add_u32 s22, s22, 6
    v_accvgpr_read_b32 v130, a240
    v_exp_f32 v29, v29
    v_cvt_pk_bf16_f32 v53, v26, v27
    v_exp_f32 v30, v30
    v_exp_f32 v31, v31
    v_cvt_pk_bf16_f32 v54, v28, v29
    v_cvt_pk_bf16_f32 v55, v30, v31
    v_exp_f32 v32, v32
    v_exp_f32 v33, v33
    v_mfma_f32_32x32x16_bf16 v[56:71], a[16:19], v[52:55], v[56:71]
    s_and_b32 s22, s22, 7
    s_mul_i32 s23, s22, 3072
    v_add_u32 v4, s23, v1
    v_exp_f32 v34, v34
    v_cvt_pk_bf16_f32 v48, v32, v33
    v_exp_f32 v35, v35
    v_exp_f32 v36, v36
    v_cvt_pk_bf16_f32 v49, v34, v35
    v_mfma_f32_32x32x16_bf16 v[16:31], a[28:31], v[88:91], 0
    ds_write_b128 v4, v[72:75] offset:0
    v_accvgpr_read_b32 v132, a241
    v_exp_f32 v37, v37
    v_exp_f32 v38, v38
    v_cvt_pk_bf16_f32 v50, v36, v37
    v_exp_f32 v39, v39
    v_exp_f32 v40, v40
    v_cvt_pk_bf16_f32 v51, v38, v39
    v_mfma_f32_32x32x8_bf16 v[16:31], a[36:37], v[92:93], v[16:31]
    ds_write_b128 v4, v[76:79] offset:1024
    v_exp_f32 v41, v41
    v_exp_f32 v42, v42
    v_cvt_pk_bf16_f32 v52, v40, v41
    v_exp_f32 v43, v43
    v_exp_f32 v44, v44
    v_mfma_f32_32x32x16_bf16 v[56:71], a[20:23], v[48:51], v[56:71]
    ds_write_b128 v4, v[80:83] offset:2048
    v_accvgpr_read_b32 v134, a242
    v_exp_f32 v45, v45
    v_cvt_pk_bf16_f32 v53, v42, v43
    v_exp_f32 v46, v46
    v_exp_f32 v47, v47
    v_cvt_pk_bf16_f32 v54, v44, v45
    v_cvt_pk_bf16_f32 v55, v46, v47
    v_exp_f32 v16, v16
    v_exp_f32 v17, v17
    v_mfma_f32_32x32x16_bf16 v[56:71], a[24:27], v[52:55], v[56:71]
    ds_read_b128 v[96:99], v8
    ds_read_b64 v[100:101], v9
    v_exp_f32 v18, v18
    v_cvt_pk_bf16_f32 v48, v16, v17
    v_exp_f32 v19, v19
    v_exp_f32 v20, v20
    v_cvt_pk_bf16_f32 v49, v18, v19
    v_mfma_f32_32x32x16_bf16 v[32:47], a[32:35], v[88:91], 0
    v_accvgpr_read_b32 v136, a243
    v_exp_f32 v21, v21
    v_exp_f32 v22, v22
    v_cvt_pk_bf16_f32 v50, v20, v21
    v_exp_f32 v23, v23
    v_exp_f32 v24, v24
    v_cvt_pk_bf16_f32 v51, v22, v23
    v_mfma_f32_32x32x8_bf16 v[32:47], a[38:39], v[92:93], v[32:47]
    buffer_load_dwordx4 v[108:111], v153, s[72:75], 0 offen offset:0
    v_exp_f32 v25, v25
    v_exp_f32 v26, v26
    v_cvt_pk_bf16_f32 v52, v24, v25
    v_exp_f32 v27, v27
    v_exp_f32 v28, v28
    v_mfma_f32_32x32x16_bf16 v[56:71], a[40:43], v[48:51], v[56:71]
    v_exp_f32 v29, v29
    v_cvt_pk_bf16_f32 v53, v26, v27
    v_exp_f32 v30, v30
    v_exp_f32 v31, v31
    v_cvt_pk_bf16_f32 v54, v28, v29
    v_cvt_pk_bf16_f32 v55, v30, v31
    v_exp_f32 v32, v32
    v_exp_f32 v33, v33
    v_mfma_f32_32x32x16_bf16 v[56:71], a[44:47], v[52:55], v[56:71]
    s_waitcnt lgkmcnt(0)
    s_barrier
    s_mov_b32 s89, 61440
    buffer_load_dwordx4 v[112:115], v153, s[72:75], s89 offen offset:0
    v_exp_f32 v34, v34
    v_cvt_pk_bf16_f32 v48, v32, v33
    v_exp_f32 v35, v35
    v_exp_f32 v36, v36
    v_cvt_pk_bf16_f32 v49, v34, v35
    v_mfma_f32_32x32x16_bf16 v[16:31], a[56:59], v[88:91], 0
    ds_read_b128 v[72:75], v10
    v_exp_f32 v37, v37
    v_exp_f32 v38, v38
    v_cvt_pk_bf16_f32 v50, v36, v37
    v_exp_f32 v39, v39
    v_exp_f32 v40, v40
    v_cvt_pk_bf16_f32 v51, v38, v39
    v_mfma_f32_32x32x8_bf16 v[16:31], a[64:65], v[92:93], v[16:31]
    ds_read_b128 v[76:79], v10 offset:1024
    s_mov_b32 s89, 122880
    buffer_load_dwordx4 v[116:119], v153, s[72:75], s89 offen offset:0
    v_exp_f32 v41, v41
    v_exp_f32 v42, v42
    v_cvt_pk_bf16_f32 v52, v40, v41
    v_exp_f32 v43, v43
    v_exp_f32 v44, v44
    v_mfma_f32_32x32x16_bf16 v[56:71], a[48:51], v[48:51], v[56:71]
    ds_read_b128 v[80:83], v10 offset:2048
    v_exp_f32 v45, v45
    v_cvt_pk_bf16_f32 v53, v42, v43
    v_exp_f32 v46, v46
    v_exp_f32 v47, v47
    v_cvt_pk_bf16_f32 v54, v44, v45
    v_cvt_pk_bf16_f32 v55, v46, v47
    v_exp_f32 v16, v16
    v_exp_f32 v17, v17
    v_mfma_f32_32x32x16_bf16 v[56:71], a[52:55], v[52:55], v[56:71]
    s_mov_b32 s89, 184320
    buffer_load_dwordx4 v[120:123], v153, s[72:75], s89 offen offset:0
    v_exp_f32 v18, v18
    v_cvt_pk_bf16_f32 v48, v16, v17
    v_exp_f32 v19, v19
    v_exp_f32 v20, v20
    v_cvt_pk_bf16_f32 v49, v18, v19
    v_mfma_f32_32x32x16_bf16 v[32:47], a[60:63], v[88:91], 0
    v_exp_f32 v21, v21
    v_exp_f32 v22, v22
    v_cvt_pk_bf16_f32 v50, v20, v21
    v_exp_f32 v23, v23
    v_exp_f32 v24, v24
    v_cvt_pk_bf16_f32 v51, v22, v23
    v_mfma_f32_32x32x8_bf16 v[32:47], a[66:67], v[92:93], v[32:47]
    s_mov_b32 s89, 245760
    buffer_load_dwordx4 v[124:127], v153, s[72:75], s89 offen offset:0
    v_exp_f32 v25, v25
    v_exp_f32 v26, v26
    v_cvt_pk_bf16_f32 v52, v24, v25
    v_exp_f32 v27, v27
    v_exp_f32 v28, v28
    v_mfma_f32_32x32x16_bf16 v[56:71], a[68:71], v[48:51], v[56:71]
    v_exp_f32 v29, v29
    v_cvt_pk_bf16_f32 v53, v26, v27
    v_exp_f32 v30, v30
    v_exp_f32 v31, v31
    v_cvt_pk_bf16_f32 v54, v28, v29
    v_cvt_pk_bf16_f32 v55, v30, v31
    v_exp_f32 v32, v32
    v_exp_f32 v33, v33
    v_mfma_f32_32x32x16_bf16 v[56:71], a[72:75], v[52:55], v[56:71]
    v_exp_f32 v34, v34
    v_cvt_pk_bf16_f32 v48, v32, v33
    v_exp_f32 v35, v35
    v_exp_f32 v36, v36
    v_cvt_pk_bf16_f32 v49, v34, v35
    v_mfma_f32_32x32x16_bf16 v[16:31], a[84:87], v[88:91], 0
    v_exp_f32 v37, v37
    v_exp_f32 v38, v38
    v_cvt_pk_bf16_f32 v50, v36, v37
    v_exp_f32 v39, v39
    v_exp_f32 v40, v40
    v_cvt_pk_bf16_f32 v51, v38, v39
    v_mfma_f32_32x32x8_bf16 v[16:31], a[92:93], v[92:93], v[16:31]
    v_exp_f32 v41, v41
    v_exp_f32 v42, v42
    v_cvt_pk_bf16_f32 v52, v40, v41
    v_exp_f32 v43, v43
    v_exp_f32 v44, v44
    v_mfma_f32_32x32x16_bf16 v[56:71], a[76:79], v[48:51], v[56:71]
    v_exp_f32 v45, v45
    v_cvt_pk_bf16_f32 v53, v42, v43
    v_exp_f32 v46, v46
    v_exp_f32 v47, v47
    v_cvt_pk_bf16_f32 v54, v44, v45
    v_cvt_pk_bf16_f32 v55, v46, v47
    v_exp_f32 v16, v16
    v_exp_f32 v17, v17
    v_mfma_f32_32x32x16_bf16 v[56:71], a[80:83], v[52:55], v[56:71]
    v_accvgpr_read_b32 v236, a253
    v_accvgpr_read_b32 v237, a254
    s_mul_i32 s2, s86, 24
    v_exp_f32 v18, v18
    v_cvt_pk_bf16_f32 v48, v16, v17
    v_exp_f32 v19, v19
    v_exp_f32 v20, v20
    v_cvt_pk_bf16_f32 v49, v18, v19
    v_mfma_f32_32x32x16_bf16 v[32:47], a[88:91], v[88:91], 0
    s_sub_u32 s2, s83, s2
    s_lshl_b32 s25, s2, 2
    v_exp_f32 v21, v21
    v_exp_f32 v22, v22
    v_cvt_pk_bf16_f32 v50, v20, v21
    v_exp_f32 v23, v23
    v_exp_f32 v24, v24
    v_cvt_pk_bf16_f32 v51, v22, v23
    v_mfma_f32_32x32x8_bf16 v[32:47], a[94:95], v[92:93], v[32:47]
    s_lshl_b32 s66, s86, 2
    s_add_u32 s66, s66, s80
    v_exp_f32 v25, v25
    v_exp_f32 v26, v26
    v_cvt_pk_bf16_f32 v52, v24, v25
    v_exp_f32 v27, v27
    v_exp_f32 v28, v28
    v_mfma_f32_32x32x16_bf16 v[56:71], a[96:99], v[48:51], v[56:71]
    s_mul_i32 s28, s66, 6554
    s_lshr_b32 s28, s28, 16
    v_exp_f32 v29, v29
    v_cvt_pk_bf16_f32 v53, v26, v27
    v_exp_f32 v30, v30
    v_exp_f32 v31, v31
    v_cvt_pk_bf16_f32 v54, v28, v29
    v_cvt_pk_bf16_f32 v55, v30, v31
    v_exp_f32 v32, v32
    v_exp_f32 v33, v33
    v_mfma_f32_32x32x16_bf16 v[56:71], a[100:103], v[52:55], v[56:71]
    s_mul_i32 s29, s28, 10
    s_sub_u32 s29, s66, s29
    s_lshl_b32 s66, s28, 1
    v_exp_f32 v34, v34
    v_cvt_pk_bf16_f32 v48, v32, v33
    v_exp_f32 v35, v35
    v_exp_f32 v36, v36
    v_cvt_pk_bf16_f32 v49, v34, v35
    v_mfma_f32_32x32x16_bf16 v[16:31], a[112:115], v[88:91], 0
    s_add_u32 s66, s66, s29
    s_mul_i32 s30, s28, 3
    v_exp_f32 v37, v37
    v_exp_f32 v38, v38
    v_cvt_pk_bf16_f32 v50, v36, v37
    v_exp_f32 v39, v39
    v_exp_f32 v40, v40
    v_cvt_pk_bf16_f32 v51, v38, v39
    v_mfma_f32_32x32x8_bf16 v[16:31], a[120:121], v[92:93], v[16:31]
    s_add_u32 s30, s30, s29
    s_add_u32 s30, s30, 6
    v_exp_f32 v41, v41
    v_exp_f32 v42, v42
    v_cvt_pk_bf16_f32 v52, v40, v41
    v_exp_f32 v43, v43
    v_exp_f32 v44, v44
    v_mfma_f32_32x32x16_bf16 v[56:71], a[104:107], v[48:51], v[56:71]
    s_cmp_ge_u32 s29, 2
    s_cselect_b32 s66, s30, s66
    s_mul_i32 s30, s28, 5
    v_exp_f32 v45, v45
    v_cvt_pk_bf16_f32 v53, v42, v43
    v_exp_f32 v46, v46
    v_exp_f32 v47, v47
    v_cvt_pk_bf16_f32 v54, v44, v45
    v_cvt_pk_bf16_f32 v55, v46, v47
    v_exp_f32 v16, v16
    v_exp_f32 v17, v17
    v_mfma_f32_32x32x16_bf16 v[56:71], a[108:111], v[52:55], v[56:71]
    s_add_u32 s30, s30, s29
    s_add_u32 s30, s30, 15
    s_cmp_ge_u32 s29, 5
    s_cselect_b32 s66, s30, s66
    v_exp_f32 v18, v18
    v_cvt_pk_bf16_f32 v48, v16, v17
    v_exp_f32 v19, v19
    v_exp_f32 v20, v20
    v_cvt_pk_bf16_f32 v49, v18, v19
    v_mfma_f32_32x32x16_bf16 v[32:47], a[116:119], v[88:91], 0
    s_mul_i32 s66, s66, 3072
    s_mov_b32 s67, 18874368
    v_exp_f32 v21, v21
    v_exp_f32 v22, v22
    v_cvt_pk_bf16_f32 v50, v20, v21
    v_exp_f32 v23, v23
    v_exp_f32 v24, v24
    v_cvt_pk_bf16_f32 v51, v22, v23
    v_mfma_f32_32x32x8_bf16 v[32:47], a[122:123], v[92:93], v[32:47]
    s_cmp_ge_u32 s83, 240
    s_cselect_b32 s67, 2130706432, s67
    v_add_u32 v238, s67, v1
    v_exp_f32 v25, v25
    v_exp_f32 v26, v26
    v_cvt_pk_bf16_f32 v52, v24, v25
    v_exp_f32 v27, v27
    v_exp_f32 v28, v28
    v_mfma_f32_32x32x16_bf16 v[56:71], a[124:127], v[48:51], v[56:71]
    v_add_u32 v239, s87, v1
    s_waitcnt vmcnt(6)
    v_exp_f32 v29, v29
    v_cvt_pk_bf16_f32 v53, v26, v27
    v_exp_f32 v30, v30
    v_exp_f32 v31, v31
    v_cvt_pk_bf16_f32 v54, v28, v29
    v_cvt_pk_bf16_f32 v55, v30, v31
    v_exp_f32 v32, v32
    v_exp_f32 v33, v33
    v_mfma_f32_32x32x16_bf16 v[56:71], a[128:131], v[52:55], v[56:71]
    ds_read_b64_tr_b16 v[160:161], v236 offset:0
    ds_read_b64_tr_b16 v[162:163], v236 offset:512
    ds_read_b64_tr_b16 v[164:165], v236 offset:32
    v_exp_f32 v34, v34
    v_cvt_pk_bf16_f32 v48, v32, v33
    v_exp_f32 v35, v35
    v_exp_f32 v36, v36
    v_cvt_pk_bf16_f32 v49, v34, v35
    v_mfma_f32_32x32x16_bf16 v[16:31], a[140:143], v[88:91], 0
    ds_read_b64_tr_b16 v[166:167], v236 offset:544
    ds_read_b64_tr_b16 v[168:169], v236 offset:64
    v_exp_f32 v37, v37
    v_exp_f32 v38, v38
    v_cvt_pk_bf16_f32 v50, v36, v37
    v_exp_f32 v39, v39
    v_exp_f32 v40, v40
    v_cvt_pk_bf16_f32 v51, v38, v39
    v_mfma_f32_32x32x8_bf16 v[16:31], a[148:149], v[92:93], v[16:31]
    ds_read_b64_tr_b16 v[170:171], v236 offset:576
    ds_read_b64_tr_b16 v[172:173], v236 offset:96
    v_exp_f32 v41, v41
    v_exp_f32 v42, v42
    v_cvt_pk_bf16_f32 v52, v40, v41
    v_exp_f32 v43, v43
    v_exp_f32 v44, v44
    v_mfma_f32_32x32x16_bf16 v[56:71], a[132:135], v[48:51], v[56:71]
    ds_read_b64_tr_b16 v[174:175], v236 offset:608
    ds_read_b64_tr_b16 v[176:177], v237 offset:4096
    v_exp_f32 v45, v45
    v_cvt_pk_bf16_f32 v53, v42, v43
    v_exp_f32 v46, v46
    v_exp_f32 v47, v47
    v_cvt_pk_bf16_f32 v54, v44, v45
    v_cvt_pk_bf16_f32 v55, v46, v47
    v_exp_f32 v16, v16
    v_exp_f32 v17, v17
    v_mfma_f32_32x32x16_bf16 v[56:71], a[136:139], v[52:55], v[56:71]
    ds_read_b64_tr_b16 v[178:179], v237 offset:6656
    ds_read_b64_tr_b16 v[180:181], v237 offset:4128
    ds_read_b64_tr_b16 v[182:183], v237 offset:6688
    v_exp_f32 v18, v18
    v_cvt_pk_bf16_f32 v48, v16, v17
    v_exp_f32 v19, v19
    v_exp_f32 v20, v20
    v_cvt_pk_bf16_f32 v49, v18, v19
    v_mfma_f32_32x32x16_bf16 v[32:47], a[144:147], v[88:91], 0
    ds_read_b64_tr_b16 v[184:185], v237 offset:4160
    ds_read_b64_tr_b16 v[186:187], v237 offset:6720
    v_exp_f32 v21, v21
    v_exp_f32 v22, v22
    v_cvt_pk_bf16_f32 v50, v20, v21
    v_exp_f32 v23, v23
    v_exp_f32 v24, v24
    v_cvt_pk_bf16_f32 v51, v22, v23
    v_mfma_f32_32x32x8_bf16 v[32:47], a[150:151], v[92:93], v[32:47]
    ds_read_b64_tr_b16 v[188:189], v237 offset:4192
    ds_read_b64_tr_b16 v[190:191], v237 offset:6752
    v_exp_f32 v25, v25
    v_exp_f32 v26, v26
    v_cvt_pk_bf16_f32 v52, v24, v25
    v_exp_f32 v27, v27
    v_exp_f32 v28, v28
    v_mfma_f32_32x32x16_bf16 v[56:71], a[152:155], v[48:51], v[56:71]
    ds_read_b64_tr_b16 v[192:193], v237 offset:4224
    ds_read_b64_tr_b16 v[194:195], v237 offset:6784
    v_exp_f32 v29, v29
    v_cvt_pk_bf16_f32 v53, v26, v27
    v_exp_f32 v30, v30
    v_exp_f32 v31, v31
    v_cvt_pk_bf16_f32 v54, v28, v29
    v_cvt_pk_bf16_f32 v55, v30, v31
    v_exp_f32 v32, v32
    v_exp_f32 v33, v33
    v_mfma_f32_32x32x16_bf16 v[56:71], a[156:159], v[52:55], v[56:71]
    s_add_u32 s28, s25, 0
    s_mul_i32 s29, s28, 21846
    s_lshr_b32 s29, s29, 16
    v_exp_f32 v34, v34
    v_cvt_pk_bf16_f32 v48, v32, v33
    v_exp_f32 v35, v35
    v_exp_f32 v36, v36
    v_cvt_pk_bf16_f32 v49, v34, v35
    v_mfma_f32_32x32x16_bf16 v[16:31], a[168:171], v[88:91], 0
    s_mul_i32 s30, s29, 3
    s_sub_u32 s30, s28, s30
    v_exp_f32 v37, v37
    v_exp_f32 v38, v38
    v_cvt_pk_bf16_f32 v50, v36, v37
    v_exp_f32 v39, v39
    v_exp_f32 v40, v40
    v_cvt_pk_bf16_f32 v51, v38, v39
    v_mfma_f32_32x32x8_bf16 v[16:31], a[176:177], v[92:93], v[16:31]
    s_mul_i32 s29, s29, 122880
    s_lshl_b32 s30, s30, 10
    v_exp_f32 v41, v41
    v_exp_f32 v42, v42
    v_cvt_pk_bf16_f32 v52, v40, v41
    v_exp_f32 v43, v43
    v_exp_f32 v44, v44
    v_mfma_f32_32x32x16_bf16 v[56:71], a[160:163], v[48:51], v[56:71]
    s_add_u32 s29, s29, s30
    s_add_u32 s29, s29, s66
    v_exp_f32 v45, v45
    v_cvt_pk_bf16_f32 v53, v42, v43
    v_exp_f32 v46, v46
    v_exp_f32 v47, v47
    v_cvt_pk_bf16_f32 v54, v44, v45
    v_cvt_pk_bf16_f32 v55, v46, v47
    v_exp_f32 v16, v16
    v_exp_f32 v17, v17
    v_mfma_f32_32x32x16_bf16 v[56:71], a[164:167], v[52:55], v[56:71]
    s_waitcnt lgkmcnt(15)
    buffer_store_dwordx4 v[160:163], v238, s[32:35], s29 offen sc1
    s_add_u32 s28, s25, 1
    s_mul_i32 s29, s28, 21846
    v_exp_f32 v18, v18
    v_cvt_pk_bf16_f32 v48, v16, v17
    v_exp_f32 v19, v19
    v_exp_f32 v20, v20
    v_cvt_pk_bf16_f32 v49, v18, v19
    v_mfma_f32_32x32x16_bf16 v[32:47], a[172:175], v[88:91], 0
    s_lshr_b32 s29, s29, 16
    s_mul_i32 s30, s29, 3
    v_exp_f32 v21, v21
    v_exp_f32 v22, v22
    v_cvt_pk_bf16_f32 v50, v20, v21
    v_exp_f32 v23, v23
    v_exp_f32 v24, v24
    v_cvt_pk_bf16_f32 v51, v22, v23
    v_mfma_f32_32x32x8_bf16 v[32:47], a[178:179], v[92:93], v[32:47]
    s_sub_u32 s30, s28, s30
    s_mul_i32 s29, s29, 122880
    v_exp_f32 v25, v25
    v_exp_f32 v26, v26
    v_cvt_pk_bf16_f32 v52, v24, v25
    v_exp_f32 v27, v27
    v_exp_f32 v28, v28
    v_mfma_f32_32x32x16_bf16 v[56:71], a[180:183], v[48:51], v[56:71]
    s_lshl_b32 s30, s30, 10
    s_add_u32 s29, s29, s30
    v_exp_f32 v29, v29
    v_cvt_pk_bf16_f32 v53, v26, v27
    v_exp_f32 v30, v30
    v_exp_f32 v31, v31
    v_cvt_pk_bf16_f32 v54, v28, v29
    v_cvt_pk_bf16_f32 v55, v30, v31
    v_exp_f32 v32, v32
    v_exp_f32 v33, v33
    v_mfma_f32_32x32x16_bf16 v[56:71], a[184:187], v[52:55], v[56:71]
    s_add_u32 s29, s29, s66
    s_waitcnt lgkmcnt(14)
    buffer_store_dwordx4 v[164:167], v238, s[32:35], s29 offen sc1
    s_add_u32 s28, s25, 2
    v_exp_f32 v34, v34
    v_cvt_pk_bf16_f32 v48, v32, v33
    v_exp_f32 v35, v35
    v_exp_f32 v36, v36
    v_cvt_pk_bf16_f32 v49, v34, v35
    v_mfma_f32_32x32x16_bf16 v[16:31], a[196:199], v[88:91], 0
    s_mul_i32 s29, s28, 21846
    s_lshr_b32 s29, s29, 16
    v_exp_f32 v37, v37
    v_exp_f32 v38, v38
    v_cvt_pk_bf16_f32 v50, v36, v37
    v_exp_f32 v39, v39
    v_exp_f32 v40, v40
    v_cvt_pk_bf16_f32 v51, v38, v39
    v_mfma_f32_32x32x8_bf16 v[16:31], a[204:205], v[92:93], v[16:31]
    s_mul_i32 s30, s29, 3
    s_sub_u32 s30, s28, s30
    v_exp_f32 v41, v41
    v_exp_f32 v42, v42
    v_cvt_pk_bf16_f32 v52, v40, v41
    v_exp_f32 v43, v43
    v_exp_f32 v44, v44
    v_mfma_f32_32x32x16_bf16 v[56:71], a[188:191], v[48:51], v[56:71]
    s_mul_i32 s29, s29, 122880
    s_lshl_b32 s30, s30, 10
    v_exp_f32 v45, v45
    v_cvt_pk_bf16_f32 v53, v42, v43
    v_exp_f32 v46, v46
    v_exp_f32 v47, v47
    v_cvt_pk_bf16_f32 v54, v44, v45
    v_cvt_pk_bf16_f32 v55, v46, v47
    v_exp_f32 v16, v16
    v_exp_f32 v17, v17
    v_mfma_f32_32x32x16_bf16 v[56:71], a[192:195], v[52:55], v[56:71]
    s_add_u32 s29, s29, s30
    s_add_u32 s29, s29, s66
    s_waitcnt lgkmcnt(12)
    buffer_store_dwordx4 v[168:171], v238, s[32:35], s29 offen sc1
    v_exp_f32 v18, v18
    v_cvt_pk_bf16_f32 v48, v16, v17
    v_exp_f32 v19, v19
    v_exp_f32 v20, v20
    v_cvt_pk_bf16_f32 v49, v18, v19
    v_mfma_f32_32x32x16_bf16 v[32:47], a[200:203], v[88:91], 0
    s_add_u32 s28, s25, 3
    s_mul_i32 s29, s28, 21846
    v_exp_f32 v21, v21
    v_exp_f32 v22, v22
    v_cvt_pk_bf16_f32 v50, v20, v21
    v_exp_f32 v23, v23
    v_exp_f32 v24, v24
    v_cvt_pk_bf16_f32 v51, v22, v23
    v_mfma_f32_32x32x8_bf16 v[32:47], a[206:207], v[92:93], v[32:47]
    s_lshr_b32 s29, s29, 16
    s_mul_i32 s30, s29, 3
    v_exp_f32 v25, v25
    v_exp_f32 v26, v26
    v_cvt_pk_bf16_f32 v52, v24, v25
    v_exp_f32 v27, v27
    v_exp_f32 v28, v28
    v_mfma_f32_32x32x16_bf16 v[56:71], a[208:211], v[48:51], v[56:71]
    s_sub_u32 s30, s28, s30
    s_mul_i32 s29, s29, 122880
    v_exp_f32 v29, v29
    v_cvt_pk_bf16_f32 v53, v26, v27
    v_exp_f32 v30, v30
    v_exp_f32 v31, v31
    v_cvt_pk_bf16_f32 v54, v28, v29
    v_cvt_pk_bf16_f32 v55, v30, v31
    v_exp_f32 v32, v32
    v_exp_f32 v33, v33
    v_mfma_f32_32x32x16_bf16 v[56:71], a[212:215], v[52:55], v[56:71]
    s_lshl_b32 s30, s30, 10
    s_add_u32 s29, s29, s30
    s_add_u32 s29, s29, s66
    v_exp_f32 v34, v34
    v_cvt_pk_bf16_f32 v48, v32, v33
    v_exp_f32 v35, v35
    v_exp_f32 v36, v36
    v_cvt_pk_bf16_f32 v49, v34, v35
    v_mfma_f32_32x32x16_bf16 v[16:31], a[0:3], v[96:99], 0
    s_waitcnt lgkmcnt(10)
    buffer_store_dwordx4 v[172:175], v238, s[32:35], s29 offen sc1
    s_waitcnt lgkmcnt(8)
    buffer_store_dwordx4 v[176:179], v239, s[32:35], 0 offen offset:0 sc1
    v_exp_f32 v37, v37
    v_exp_f32 v38, v38
    v_cvt_pk_bf16_f32 v50, v36, v37
    v_exp_f32 v39, v39
    v_exp_f32 v40, v40
    v_cvt_pk_bf16_f32 v51, v38, v39
    v_mfma_f32_32x32x8_bf16 v[16:31], a[8:9], v[100:101], v[16:31]
    s_waitcnt lgkmcnt(6)
    buffer_store_dwordx4 v[180:183], v239, s[32:35], 0 offen offset:1024 sc1
    s_waitcnt lgkmcnt(4)
    buffer_store_dwordx4 v[184:187], v239, s[32:35], 0 offen offset:2048 sc1
    v_exp_f32 v41, v41
    v_exp_f32 v42, v42
    v_cvt_pk_bf16_f32 v52, v40, v41
    v_exp_f32 v43, v43
    v_exp_f32 v44, v44
    v_mfma_f32_32x32x16_bf16 v[56:71], a[216:219], v[48:51], v[56:71]
    s_waitcnt lgkmcnt(2)
    buffer_store_dwordx4 v[188:191], v239, s[32:35], 0 offen offset:3072 sc1
    s_waitcnt lgkmcnt(0)
    s_mov_b32 s89, 4096
    buffer_store_dwordx4 v[192:195], v239, s[32:35], s89 offen offset:0 sc1
    v_exp_f32 v45, v45
    v_cvt_pk_bf16_f32 v53, v42, v43
    v_exp_f32 v46, v46
    v_exp_f32 v47, v47
    v_cvt_pk_bf16_f32 v54, v44, v45
    v_cvt_pk_bf16_f32 v55, v46, v47
    v_exp_f32 v16, v16
    v_exp_f32 v17, v17
    v_mfma_f32_32x32x16_bf16 v[56:71], a[220:223], v[52:55], v[56:71]
    s_lshl_b32 s22, s80, 1
    s_add_u32 s22, s22, 4
    v_exp_f32 v18, v18
    v_cvt_pk_bf16_f32 v48, v16, v17
    v_exp_f32 v19, v19
    v_exp_f32 v20, v20
    v_cvt_pk_bf16_f32 v49, v18, v19
    v_mfma_f32_32x32x16_bf16 v[32:47], a[4:7], v[96:99], 0
    s_and_b32 s22, s22, 7
    s_mul_i32 s23, s22, 1280
    v_exp_f32 v21, v21
    v_exp_f32 v22, v22
    v_cvt_pk_bf16_f32 v50, v20, v21
    v_exp_f32 v23, v23
    v_exp_f32 v24, v24
    v_cvt_pk_bf16_f32 v51, v22, v23
    v_mfma_f32_32x32x8_bf16 v[32:47], a[10:11], v[100:101], v[32:47]
    v_add_u32 v8, s23, v2
    v_add_u32 v9, s23, v3
    s_mul_i32 s23, s22, 3072
    v_exp_f32 v25, v25
    v_exp_f32 v26, v26
    v_cvt_pk_bf16_f32 v52, v24, v25
    v_exp_f32 v27, v27
    v_exp_f32 v28, v28
    v_mfma_f32_32x32x16_bf16 v[72:87], a[12:15], v[48:51], v[72:87]
    v_add_u32 v10, s23, v1
    s_add_u32 s22, s22, 6
    v_exp_f32 v29, v29
    v_cvt_pk_bf16_f32 v53, v26, v27
    v_exp_f32 v30, v30
    v_exp_f32 v31, v31
    v_cvt_pk_bf16_f32 v54, v28, v29
    v_cvt_pk_bf16_f32 v55, v30, v31
    v_exp_f32 v32, v32
    v_exp_f32 v33, v33
    v_mfma_f32_32x32x16_bf16 v[72:87], a[16:19], v[52:55], v[72:87]
    s_and_b32 s22, s22, 7
    s_mul_i32 s23, s22, 3072
    v_add_u32 v4, s23, v1
    v_exp_f32 v34, v34
    v_cvt_pk_bf16_f32 v48, v32, v33
    v_exp_f32 v35, v35
    v_exp_f32 v36, v36
    v_cvt_pk_bf16_f32 v49, v34, v35
    v_mfma_f32_32x32x16_bf16 v[16:31], a[28:31], v[96:99], 0
    ds_write_b128 v4, v[56:59] offset:0
    v_exp_f32 v37, v37
    v_exp_f32 v38, v38
    v_cvt_pk_bf16_f32 v50, v36, v37
    v_exp_f32 v39, v39
    v_exp_f32 v40, v40
    v_cvt_pk_bf16_f32 v51, v38, v39
    v_mfma_f32_32x32x8_bf16 v[16:31], a[36:37], v[100:101], v[16:31]
    ds_write_b128 v4, v[60:63] offset:1024
    v_exp_f32 v41, v41
    v_exp_f32 v42, v42
    v_cvt_pk_bf16_f32 v52, v40, v41
    v_exp_f32 v43, v43
    v_exp_f32 v44, v44
    v_mfma_f32_32x32x16_bf16 v[72:87], a[20:23], v[48:51], v[72:87]
    ds_write_b128 v4, v[64:67] offset:2048
    v_exp_f32 v45, v45
    v_cvt_pk_bf16_f32 v53, v42, v43
    v_exp_f32 v46, v46
    v_exp_f32 v47, v47
    v_cvt_pk_bf16_f32 v54, v44, v45
    v_cvt_pk_bf16_f32 v55, v46, v47
    v_exp_f32 v16, v16
    v_exp_f32 v17, v17
    v_mfma_f32_32x32x16_bf16 v[72:87], a[24:27], v[52:55], v[72:87]
    ds_read_b128 v[88:91], v8
    ds_read_b64 v[92:93], v9
    v_exp_f32 v18, v18
    v_cvt_pk_bf16_f32 v48, v16, v17
    v_exp_f32 v19, v19
    v_exp_f32 v20, v20
    v_cvt_pk_bf16_f32 v49, v18, v19
    v_mfma_f32_32x32x16_bf16 v[32:47], a[32:35], v[96:99], 0
    v_exp_f32 v21, v21
    v_exp_f32 v22, v22
    v_cvt_pk_bf16_f32 v50, v20, v21
    v_exp_f32 v23, v23
    v_exp_f32 v24, v24
    v_cvt_pk_bf16_f32 v51, v22, v23
    v_mfma_f32_32x32x8_bf16 v[32:47], a[38:39], v[100:101], v[32:47]
    s_waitcnt vmcnt(9)
    v_lshlrev_b32 v138, 16, v108
    v_and_b32 v139, 0xffff0000, v108
    v_exp_f32 v25, v25
    v_exp_f32 v26, v26
    v_cvt_pk_bf16_f32 v52, v24, v25
    v_exp_f32 v27, v27
    v_exp_f32 v28, v28
    v_mfma_f32_32x32x16_bf16 v[72:87], a[40:43], v[48:51], v[72:87]
    v_mul_f32 v142, v138, v128
    v_mul_f32 v143, v139, v128
    v_lshlrev_b32 v140, 16, v109
    v_and_b32 v141, 0xffff0000, v109
    v_exp_f32 v29, v29
    v_cvt_pk_bf16_f32 v53, v26, v27
    v_exp_f32 v30, v30
    v_exp_f32 v31, v31
    v_cvt_pk_bf16_f32 v54, v28, v29
    v_cvt_pk_bf16_f32 v55, v30, v31
    v_exp_f32 v32, v32
    v_exp_f32 v33, v33
    v_mfma_f32_32x32x16_bf16 v[72:87], a[44:47], v[52:55], v[72:87]
    s_waitcnt lgkmcnt(0)
    s_barrier
    v_mul_f32 v144, v140, v128
    v_mul_f32 v145, v141, v128
    v_lshlrev_b32 v138, 16, v110
    v_and_b32 v139, 0xffff0000, v110
    v_exp_f32 v34, v34
    v_cvt_pk_bf16_f32 v48, v32, v33
    v_exp_f32 v35, v35
    v_exp_f32 v36, v36
    v_cvt_pk_bf16_f32 v49, v34, v35
    v_mfma_f32_32x32x16_bf16 v[16:31], a[56:59], v[96:99], 0
    ds_read_b128 v[56:59], v10
    v_mul_f32 v146, v138, v128
    v_mul_f32 v147, v139, v128
    v_lshlrev_b32 v140, 16, v111
    v_and_b32 v141, 0xffff0000, v111
    v_exp_f32 v37, v37
    v_exp_f32 v38, v38
    v_cvt_pk_bf16_f32 v50, v36, v37
    v_exp_f32 v39, v39
    v_exp_f32 v40, v40
    v_cvt_pk_bf16_f32 v51, v38, v39
    v_mfma_f32_32x32x8_bf16 v[16:31], a[64:65], v[100:101], v[16:31]
    ds_read_b128 v[60:63], v10 offset:1024
    v_mul_f32 v148, v140, v128
    v_mul_f32 v149, v141, v128
    v_lshlrev_b32 v138, 16, v112
    v_and_b32 v139, 0xffff0000, v112
    v_exp_f32 v41, v41
    v_exp_f32 v42, v42
    v_cvt_pk_bf16_f32 v52, v40, v41
    v_exp_f32 v43, v43
    v_exp_f32 v44, v44
    v_mfma_f32_32x32x16_bf16 v[72:87], a[48:51], v[48:51], v[72:87]
    ds_read_b128 v[64:67], v10 offset:2048
    v_fmac_f32 v142, v138, v130
    v_fmac_f32 v143, v139, v130
    v_lshlrev_b32 v140, 16, v113
    v_and_b32 v141, 0xffff0000, v113
    v_exp_f32 v45, v45
    v_cvt_pk_bf16_f32 v53, v42, v43
    v_exp_f32 v46, v46
    v_exp_f32 v47, v47
    v_cvt_pk_bf16_f32 v54, v44, v45
    v_cvt_pk_bf16_f32 v55, v46, v47
    v_exp_f32 v16, v16
    v_exp_f32 v17, v17
    v_mfma_f32_32x32x16_bf16 v[72:87], a[52:55], v[52:55], v[72:87]
    v_fmac_f32 v144, v140, v130
    v_fmac_f32 v145, v141, v130
    v_lshlrev_b32 v138, 16, v114
    v_and_b32 v139, 0xffff0000, v114
    v_exp_f32 v18, v18
    v_cvt_pk_bf16_f32 v48, v16, v17
    v_exp_f32 v19, v19
    v_exp_f32 v20, v20
    v_cvt_pk_bf16_f32 v49, v18, v19
    v_mfma_f32_32x32x16_bf16 v[32:47], a[60:63], v[96:99], 0
    v_fmac_f32 v146, v138, v130
    v_fmac_f32 v147, v139, v130
    v_lshlrev_b32 v140, 16, v115
    v_and_b32 v141, 0xffff0000, v115
    v_exp_f32 v21, v21
    v_exp_f32 v22, v22
    v_cvt_pk_bf16_f32 v50, v20, v21
    v_exp_f32 v23, v23
    v_exp_f32 v24, v24
    v_cvt_pk_bf16_f32 v51, v22, v23
    v_mfma_f32_32x32x8_bf16 v[32:47], a[66:67], v[100:101], v[32:47]
    v_fmac_f32 v148, v140, v130
    v_fmac_f32 v149, v141, v130
    v_lshlrev_b32 v138, 16, v116
    v_and_b32 v139, 0xffff0000, v116
    v_exp_f32 v25, v25
    v_exp_f32 v26, v26
    v_cvt_pk_bf16_f32 v52, v24, v25
    v_exp_f32 v27, v27
    v_exp_f32 v28, v28
    v_mfma_f32_32x32x16_bf16 v[72:87], a[68:71], v[48:51], v[72:87]
    v_fmac_f32 v142, v138, v132
    v_fmac_f32 v143, v139, v132
    v_exp_f32 v29, v29
    v_cvt_pk_bf16_f32 v53, v26, v27
    v_exp_f32 v30, v30
    v_exp_f32 v31, v31
    v_cvt_pk_bf16_f32 v54, v28, v29
    v_cvt_pk_bf16_f32 v55, v30, v31
    v_exp_f32 v32, v32
    v_exp_f32 v33, v33
    v_mfma_f32_32x32x16_bf16 v[72:87], a[72:75], v[52:55], v[72:87]
    v_lshlrev_b32 v140, 16, v117
    v_and_b32 v141, 0xffff0000, v117
    v_fmac_f32 v144, v140, v132
    v_fmac_f32 v145, v141, v132
    v_exp_f32 v34, v34
    v_cvt_pk_bf16_f32 v48, v32, v33
    v_exp_f32 v35, v35
    v_exp_f32 v36, v36
    v_cvt_pk_bf16_f32 v49, v34, v35
    v_mfma_f32_32x32x16_bf16 v[16:31], a[84:87], v[96:99], 0
    v_lshlrev_b32 v138, 16, v118
    v_and_b32 v139, 0xffff0000, v118
    v_fmac_f32 v146, v138, v132
    v_fmac_f32 v147, v139, v132
    v_exp_f32 v37, v37
    v_exp_f32 v38, v38
    v_cvt_pk_bf16_f32 v50, v36, v37
    v_exp_f32 v39, v39
    v_exp_f32 v40, v40
    v_cvt_pk_bf16_f32 v51, v38, v39
    v_mfma_f32_32x32x8_bf16 v[16:31], a[92:93], v[100:101], v[16:31]
    v_lshlrev_b32 v140, 16, v119
    v_and_b32 v141, 0xffff0000, v119
    v_fmac_f32 v148, v140, v132
    v_fmac_f32 v149, v141, v132
    v_exp_f32 v41, v41
    v_exp_f32 v42, v42
    v_cvt_pk_bf16_f32 v52, v40, v41
    v_exp_f32 v43, v43
    v_exp_f32 v44, v44
    v_mfma_f32_32x32x16_bf16 v[72:87], a[76:79], v[48:51], v[72:87]
    v_lshlrev_b32 v138, 16, v120
    v_and_b32 v139, 0xffff0000, v120
    v_fmac_f32 v142, v138, v134
    v_fmac_f32 v143, v139, v134
    v_exp_f32 v45, v45
    v_cvt_pk_bf16_f32 v53, v42, v43
    v_exp_f32 v46, v46
    v_exp_f32 v47, v47
    v_cvt_pk_bf16_f32 v54, v44, v45
    v_cvt_pk_bf16_f32 v55, v46, v47
    v_exp_f32 v16, v16
    v_exp_f32 v17, v17
    v_mfma_f32_32x32x16_bf16 v[72:87], a[80:83], v[52:55], v[72:87]
    v_lshlrev_b32 v140, 16, v121
    v_and_b32 v141, 0xffff0000, v121
    v_fmac_f32 v144, v140, v134
    v_fmac_f32 v145, v141, v134
    v_exp_f32 v18, v18
    v_cvt_pk_bf16_f32 v48, v16, v17
    v_exp_f32 v19, v19
    v_exp_f32 v20, v20
    v_cvt_pk_bf16_f32 v49, v18, v19
    v_mfma_f32_32x32x16_bf16 v[32:47], a[88:91], v[96:99], 0
    v_lshlrev_b32 v138, 16, v122
    v_and_b32 v139, 0xffff0000, v122
    v_fmac_f32 v146, v138, v134
    v_fmac_f32 v147, v139, v134
    v_exp_f32 v21, v21
    v_exp_f32 v22, v22
    v_cvt_pk_bf16_f32 v50, v20, v21
    v_exp_f32 v23, v23
    v_exp_f32 v24, v24
    v_cvt_pk_bf16_f32 v51, v22, v23
    v_mfma_f32_32x32x8_bf16 v[32:47], a[94:95], v[100:101], v[32:47]
    v_lshlrev_b32 v140, 16, v123
    v_and_b32 v141, 0xffff0000, v123
    v_fmac_f32 v148, v140, v134
    v_fmac_f32 v149, v141, v134
    v_exp_f32 v25, v25
    v_exp_f32 v26, v26
    v_cvt_pk_bf16_f32 v52, v24, v25
    v_exp_f32 v27, v27
    v_exp_f32 v28, v28
    v_mfma_f32_32x32x16_bf16 v[72:87], a[96:99], v[48:51], v[72:87]
    v_lshlrev_b32 v138, 16, v124
    v_and_b32 v139, 0xffff0000, v124
    v_fmac_f32 v142, v138, v136
    v_fmac_f32 v143, v139, v136
    v_exp_f32 v29, v29
    v_cvt_pk_bf16_f32 v53, v26, v27
    v_exp_f32 v30, v30
    v_exp_f32 v31, v31
    v_cvt_pk_bf16_f32 v54, v28, v29
    v_cvt_pk_bf16_f32 v55, v30, v31
    v_exp_f32 v32, v32
    v_exp_f32 v33, v33
    v_mfma_f32_32x32x16_bf16 v[72:87], a[100:103], v[52:55], v[72:87]
    v_lshlrev_b32 v140, 16, v125
    v_and_b32 v141, 0xffff0000, v125
    v_exp_f32 v34, v34
    v_cvt_pk_bf16_f32 v48, v32, v33
    v_exp_f32 v35, v35
    v_exp_f32 v36, v36
    v_cvt_pk_bf16_f32 v49, v34, v35
    v_mfma_f32_32x32x16_bf16 v[16:31], a[112:115], v[96:99], 0
    v_fmac_f32 v144, v140, v136
    v_fmac_f32 v145, v141, v136
    v_lshlrev_b32 v138, 16, v126
    v_and_b32 v139, 0xffff0000, v126
    v_exp_f32 v37, v37
    v_exp_f32 v38, v38
    v_cvt_pk_bf16_f32 v50, v36, v37
    v_exp_f32 v39, v39
    v_exp_f32 v40, v40
    v_cvt_pk_bf16_f32 v51, v38, v39
    v_mfma_f32_32x32x8_bf16 v[16:31], a[120:121], v[100:101], v[16:31]
    v_fmac_f32 v146, v138, v136
    v_fmac_f32 v147, v139, v136
    v_lshlrev_b32 v140, 16, v127
    v_and_b32 v141, 0xffff0000, v127
    v_exp_f32 v41, v41
    v_exp_f32 v42, v42
    v_cvt_pk_bf16_f32 v52, v40, v41
    v_exp_f32 v43, v43
    v_exp_f32 v44, v44
    v_mfma_f32_32x32x16_bf16 v[72:87], a[104:107], v[48:51], v[72:87]
    v_fmac_f32 v148, v140, v136
    v_fmac_f32 v149, v141, v136
    v_and_b32 v150, 7, v0
    v_lshlrev_b32 v150, 5, v150
    v_exp_f32 v45, v45
    v_cvt_pk_bf16_f32 v53, v42, v43
    v_exp_f32 v46, v46
    v_exp_f32 v47, v47
    v_cvt_pk_bf16_f32 v54, v44, v45
    v_cvt_pk_bf16_f32 v55, v46, v47
    v_exp_f32 v16, v16
    v_exp_f32 v17, v17
    v_mfma_f32_32x32x16_bf16 v[72:87], a[108:111], v[52:55], v[72:87]
    v_lshrrev_b32 v151, 4, v0
    v_lshl_add_u32 v150, v151, 3, v150
    v_permlane32_swap_b32 v142, v146
    v_exp_f32 v18, v18
    v_cvt_pk_bf16_f32 v48, v16, v17
    v_exp_f32 v19, v19
    v_exp_f32 v20, v20
    v_cvt_pk_bf16_f32 v49, v18, v19
    v_mfma_f32_32x32x16_bf16 v[32:47], a[116:119], v[96:99], 0
    v_permlane32_swap_b32 v143, v147
    v_permlane32_swap_b32 v144, v148
    v_exp_f32 v21, v21
    v_exp_f32 v22, v22
    v_cvt_pk_bf16_f32 v50, v20, v21
    v_exp_f32 v23, v23
    v_exp_f32 v24, v24
    v_cvt_pk_bf16_f32 v51, v22, v23
    v_mfma_f32_32x32x8_bf16 v[32:47], a[122:123], v[100:101], v[32:47]
    v_permlane32_swap_b32 v145, v149
    s_lshl_b32 s66, s80, 8
    v_exp_f32 v25, v25
    v_exp_f32 v26, v26
    v_cvt_pk_bf16_f32 v52, v24, v25
    v_exp_f32 v27, v27
    v_exp_f32 v28, v28
    v_mfma_f32_32x32x16_bf16 v[72:87], a[124:127], v[48:51], v[72:87]
    s_add_u32 s66, s66, 157440
    v_add_u32 v150, s66, v150
    v_exp_f32 v29, v29
    v_cvt_pk_bf16_f32 v53, v26, v27
    v_exp_f32 v30, v30
    v_exp_f32 v31, v31
    v_cvt_pk_bf16_f32 v54, v28, v29
    v_cvt_pk_bf16_f32 v55, v30, v31
    v_exp_f32 v32, v32
    v_exp_f32 v33, v33
    v_mfma_f32_32x32x16_bf16 v[72:87], a[128:131], v[52:55], v[72:87]
    v_add_f32 v142, v142, v146
    v_add_f32 v143, v143, v147
    v_exp_f32 v34, v34
    v_cvt_pk_bf16_f32 v48, v32, v33
    v_exp_f32 v35, v35
    v_exp_f32 v36, v36
    v_cvt_pk_bf16_f32 v49, v34, v35
    v_mfma_f32_32x32x16_bf16 v[16:31], a[140:143], v[96:99], 0
    v_add_f32 v144, v144, v148
    v_exp_f32 v37, v37
    v_exp_f32 v38, v38
    v_cvt_pk_bf16_f32 v50, v36, v37
    v_exp_f32 v39, v39
    v_exp_f32 v40, v40
    v_cvt_pk_bf16_f32 v51, v38, v39
    v_mfma_f32_32x32x8_bf16 v[16:31], a[148:149], v[100:101], v[16:31]
    v_add_f32 v145, v145, v149
    v_lshlrev_b32 v151, 2, v0
    v_add_u32 v151, 157440, v151
    v_exp_f32 v41, v41
    v_exp_f32 v42, v42
    v_cvt_pk_bf16_f32 v52, v40, v41
    v_exp_f32 v43, v43
    v_exp_f32 v44, v44
    v_mfma_f32_32x32x16_bf16 v[72:87], a[132:135], v[48:51], v[72:87]
    v_permlane16_swap_b32 v142, v144
    v_permlane16_swap_b32 v143, v145
    v_exp_f32 v45, v45
    v_cvt_pk_bf16_f32 v53, v42, v43
    v_exp_f32 v46, v46
    v_exp_f32 v47, v47
    v_cvt_pk_bf16_f32 v54, v44, v45
    v_cvt_pk_bf16_f32 v55, v46, v47
    v_exp_f32 v16, v16
    v_exp_f32 v17, v17
    v_mfma_f32_32x32x16_bf16 v[72:87], a[136:139], v[52:55], v[72:87]
    s_mul_i32 s3, s64, 30720
    s_lshl_b32 s2, s65, 9
    v_exp_f32 v18, v18
    v_cvt_pk_bf16_f32 v48, v16, v17
    v_exp_f32 v19, v19
    v_exp_f32 v20, v20
    v_cvt_pk_bf16_f32 v49, v18, v19
    v_mfma_f32_32x32x16_bf16 v[32:47], a[144:147], v[96:99], 0
    v_add_f32 v142, v142, v144
    v_add_f32 v143, v143, v145
    v_exp_f32 v21, v21
    v_exp_f32 v22, v22
    v_cvt_pk_bf16_f32 v50, v20, v21
    v_exp_f32 v23, v23
    v_exp_f32 v24, v24
    v_cvt_pk_bf16_f32 v51, v22, v23
    v_mfma_f32_32x32x8_bf16 v[32:47], a[150:151], v[100:101], v[32:47]
    s_add_u32 s3, s3, s2
    s_mov_b32 s2, 2130706432
    v_exp_f32 v25, v25
    v_exp_f32 v26, v26
    v_cvt_pk_bf16_f32 v52, v24, v25
    v_exp_f32 v27, v27
    v_exp_f32 v28, v28
    v_mfma_f32_32x32x16_bf16 v[72:87], a[152:155], v[48:51], v[72:87]
    s_cmp_eq_u32 s80, 0
    s_cselect_b32 s2, 65536, s2
    s_add_u32 s3, s3, s2
    v_exp_f32 v29, v29
    v_cvt_pk_bf16_f32 v53, v26, v27
    v_exp_f32 v30, v30
    v_exp_f32 v31, v31
    v_cvt_pk_bf16_f32 v54, v28, v29
    v_cvt_pk_bf16_f32 v55, v30, v31
    v_exp_f32 v32, v32
    v_exp_f32 v33, v33
    v_mfma_f32_32x32x16_bf16 v[72:87], a[156:159], v[52:55], v[72:87]
    v_add_f32_dpp v142, v142, v142 row_ror:8 row_mask:0xf bank_mask:0xf
    v_add_f32_dpp v143, v143, v143 row_ror:8 row_mask:0xf bank_mask:0xf
    v_exp_f32 v34, v34
    v_cvt_pk_bf16_f32 v48, v32, v33
    v_exp_f32 v35, v35
    v_exp_f32 v36, v36
    v_cvt_pk_bf16_f32 v49, v34, v35
    v_mfma_f32_32x32x16_bf16 v[16:31], a[168:171], v[96:99], 0
    ds_write_b64 v150, v[142:143]
    v_lshl_add_u32 v152, v0, 3, s3
    v_exp_f32 v37, v37
    v_exp_f32 v38, v38
    v_cvt_pk_bf16_f32 v50, v36, v37
    v_exp_f32 v39, v39
    v_exp_f32 v40, v40
    v_cvt_pk_bf16_f32 v51, v38, v39
    v_mfma_f32_32x32x8_bf16 v[16:31], a[176:177], v[100:101], v[16:31]
    v_mov_b32 v147, s84
    v_exp_f32 v41, v41
    v_exp_f32 v42, v42
    v_cvt_pk_bf16_f32 v52, v40, v41
    v_exp_f32 v43, v43
    v_exp_f32 v44, v44
    v_mfma_f32_32x32x16_bf16 v[72:87], a[160:163], v[48:51], v[72:87]
    v_exp_f32 v45, v45
    v_cvt_pk_bf16_f32 v53, v42, v43
    v_exp_f32 v46, v46
    v_exp_f32 v47, v47
    v_cvt_pk_bf16_f32 v54, v44, v45
    v_cvt_pk_bf16_f32 v55, v46, v47
    v_exp_f32 v16, v16
    v_exp_f32 v17, v17
    v_mfma_f32_32x32x16_bf16 v[72:87], a[164:167], v[52:55], v[72:87]
    v_exp_f32 v18, v18
    v_cvt_pk_bf16_f32 v48, v16, v17
    v_exp_f32 v19, v19
    v_exp_f32 v20, v20
    v_cvt_pk_bf16_f32 v49, v18, v19
    v_mfma_f32_32x32x16_bf16 v[32:47], a[172:175], v[96:99], 0
    v_exp_f32 v21, v21
    v_exp_f32 v22, v22
    v_cvt_pk_bf16_f32 v50, v20, v21
    v_exp_f32 v23, v23
    v_exp_f32 v24, v24
    v_cvt_pk_bf16_f32 v51, v22, v23
    v_mfma_f32_32x32x8_bf16 v[32:47], a[178:179], v[100:101], v[32:47]
    v_exp_f32 v25, v25
    v_exp_f32 v26, v26
    v_cvt_pk_bf16_f32 v52, v24, v25
    v_exp_f32 v27, v27
    v_exp_f32 v28, v28
    v_mfma_f32_32x32x16_bf16 v[72:87], a[180:183], v[48:51], v[72:87]
    s_waitcnt lgkmcnt(0)
    s_waitcnt vmcnt(0)
    v_exp_f32 v29, v29
    v_cvt_pk_bf16_f32 v53, v26, v27
    v_exp_f32 v30, v30
    v_exp_f32 v31, v31
    v_cvt_pk_bf16_f32 v54, v28, v29
    v_cvt_pk_bf16_f32 v55, v30, v31
    v_exp_f32 v32, v32
    v_exp_f32 v33, v33
    v_mfma_f32_32x32x16_bf16 v[72:87], a[184:187], v[52:55], v[72:87]
    s_barrier
    ds_read_b32 v142, v151 offset:0
    v_exp_f32 v34, v34
    v_cvt_pk_bf16_f32 v48, v32, v33
    v_exp_f32 v35, v35
    v_exp_f32 v36, v36
    v_cvt_pk_bf16_f32 v49, v34, v35
    v_mfma_f32_32x32x16_bf16 v[16:31], a[196:199], v[96:99], 0
    ds_read_b32 v143, v151 offset:256
    ds_read_b32 v144, v151 offset:512
    v_exp_f32 v37, v37
    v_exp_f32 v38, v38
    v_cvt_pk_bf16_f32 v50, v36, v37
    v_exp_f32 v39, v39
    v_exp_f32 v40, v40
    v_cvt_pk_bf16_f32 v51, v38, v39
    v_mfma_f32_32x32x8_bf16 v[16:31], a[204:205], v[100:101], v[16:31]
    ds_read_b32 v145, v151 offset:768
    v_exp_f32 v41, v41
    v_exp_f32 v42, v42
    v_cvt_pk_bf16_f32 v52, v40, v41
    v_exp_f32 v43, v43
    v_exp_f32 v44, v44
    v_mfma_f32_32x32x16_bf16 v[72:87], a[188:191], v[48:51], v[72:87]
    v_exp_f32 v45, v45
    v_cvt_pk_bf16_f32 v53, v42, v43
    v_exp_f32 v46, v46
    v_exp_f32 v47, v47
    v_cvt_pk_bf16_f32 v54, v44, v45
    v_cvt_pk_bf16_f32 v55, v46, v47
    v_exp_f32 v16, v16
    v_exp_f32 v17, v17
    v_mfma_f32_32x32x16_bf16 v[72:87], a[192:195], v[52:55], v[72:87]
    v_exp_f32 v18, v18
    v_cvt_pk_bf16_f32 v48, v16, v17
    v_exp_f32 v19, v19
    v_exp_f32 v20, v20
    v_cvt_pk_bf16_f32 v49, v18, v19
    v_mfma_f32_32x32x16_bf16 v[32:47], a[200:203], v[96:99], 0
    v_exp_f32 v21, v21
    v_exp_f32 v22, v22
    v_cvt_pk_bf16_f32 v50, v20, v21
    v_exp_f32 v23, v23
    v_exp_f32 v24, v24
    v_cvt_pk_bf16_f32 v51, v22, v23
    v_mfma_f32_32x32x8_bf16 v[32:47], a[206:207], v[100:101], v[32:47]
    s_waitcnt lgkmcnt(0)
    v_exp_f32 v25, v25
    v_exp_f32 v26, v26
    v_cvt_pk_bf16_f32 v52, v24, v25
    v_exp_f32 v27, v27
    v_exp_f32 v28, v28
    v_mfma_f32_32x32x16_bf16 v[72:87], a[208:211], v[48:51], v[72:87]
    v_add_f32 v142, v142, v143
    v_add_f32 v144, v144, v145
    v_add_f32 v146, v142, v144
    v_exp_f32 v29, v29
    v_cvt_pk_bf16_f32 v53, v26, v27
    v_exp_f32 v30, v30
    v_exp_f32 v31, v31
    v_cvt_pk_bf16_f32 v54, v28, v29
    v_cvt_pk_bf16_f32 v55, v30, v31
    v_exp_f32 v32, v32
    v_exp_f32 v33, v33
    v_mfma_f32_32x32x16_bf16 v[72:87], a[212:215], v[52:55], v[72:87]
    buffer_store_dwordx2 v[146:147], v152, s[32:35], 0 offen offset:0 sc1
    s_lshl_b32 s3, s83, 7
    v_exp_f32 v34, v34
    v_cvt_pk_bf16_f32 v48, v32, v33
    v_exp_f32 v35, v35
    v_exp_f32 v36, v36
    v_cvt_pk_bf16_f32 v49, v34, v35
    v_mfma_f32_32x32x16_bf16 v[16:31], a[0:3], v[88:91], 0
    s_add_u32 s3, s3, 1015808
    s_cmp_eq_u32 s80, 0
    s_cselect_b32 s3, s3, 2130706432
    v_exp_f32 v37, v37
    v_exp_f32 v38, v38
    v_cvt_pk_bf16_f32 v50, v36, v37
    v_exp_f32 v39, v39
    v_exp_f32 v40, v40
    v_cvt_pk_bf16_f32 v51, v38, v39
    v_mfma_f32_32x32x8_bf16 v[16:31], a[8:9], v[92:93], v[16:31]
    v_mov_b32 v14, s3
    v_mov_b32 v15, s84
    v_exp_f32 v41, v41
    v_exp_f32 v42, v42
    v_cvt_pk_bf16_f32 v52, v40, v41
    v_exp_f32 v43, v43
    v_exp_f32 v44, v44
    v_mfma_f32_32x32x16_bf16 v[72:87], a[216:219], v[48:51], v[72:87]
    s_mov_b64 exec, 1
    buffer_store_dword v15, v14, s[32:35], 0 offen sc1
    s_mov_b64 exec, -1
    v_exp_f32 v45, v45
    v_cvt_pk_bf16_f32 v53, v42, v43
    v_exp_f32 v46, v46
    v_exp_f32 v47, v47
    v_cvt_pk_bf16_f32 v54, v44, v45
    v_cvt_pk_bf16_f32 v55, v46, v47
    v_exp_f32 v16, v16
    v_exp_f32 v17, v17
    v_mfma_f32_32x32x16_bf16 v[72:87], a[220:223], v[52:55], v[72:87]
    s_lshl_b32 s22, s80, 1
    s_add_u32 s22, s22, 5
    v_exp_f32 v18, v18
    v_cvt_pk_bf16_f32 v48, v16, v17
    v_exp_f32 v19, v19
    v_exp_f32 v20, v20
    v_cvt_pk_bf16_f32 v49, v18, v19
    v_mfma_f32_32x32x16_bf16 v[32:47], a[4:7], v[88:91], 0
    s_and_b32 s22, s22, 7
    s_mul_i32 s23, s22, 1280
    v_exp_f32 v21, v21
    v_exp_f32 v22, v22
    v_cvt_pk_bf16_f32 v50, v20, v21
    v_exp_f32 v23, v23
    v_exp_f32 v24, v24
    v_cvt_pk_bf16_f32 v51, v22, v23
    v_mfma_f32_32x32x8_bf16 v[32:47], a[10:11], v[92:93], v[32:47]
    v_add_u32 v8, s23, v2
    v_add_u32 v9, s23, v3
    s_mul_i32 s23, s22, 3072
    v_exp_f32 v25, v25
    v_exp_f32 v26, v26
    v_cvt_pk_bf16_f32 v52, v24, v25
    v_exp_f32 v27, v27
    v_exp_f32 v28, v28
    v_mfma_f32_32x32x16_bf16 v[56:71], a[12:15], v[48:51], v[56:71]
    v_add_u32 v10, s23, v1
    s_add_u32 s22, s22, 6
    v_exp_f32 v29, v29
    v_cvt_pk_bf16_f32 v53, v26, v27
    v_exp_f32 v30, v30
    v_exp_f32 v31, v31
    v_cvt_pk_bf16_f32 v54, v28, v29
    v_cvt_pk_bf16_f32 v55, v30, v31
    v_exp_f32 v32, v32
    v_exp_f32 v33, v33
    v_mfma_f32_32x32x16_bf16 v[56:71], a[16:19], v[52:55], v[56:71]
    s_and_b32 s22, s22, 7
    s_mul_i32 s23, s22, 3072
    v_add_u32 v4, s23, v1
    v_exp_f32 v34, v34
    v_cvt_pk_bf16_f32 v48, v32, v33
    v_exp_f32 v35, v35
    v_exp_f32 v36, v36
    v_cvt_pk_bf16_f32 v49, v34, v35
    v_mfma_f32_32x32x16_bf16 v[16:31], a[28:31], v[88:91], 0
    ds_write_b128 v4, v[72:75] offset:0
    v_exp_f32 v37, v37
    v_exp_f32 v38, v38
    v_cvt_pk_bf16_f32 v50, v36, v37
    v_exp_f32 v39, v39
    v_exp_f32 v40, v40
    v_cvt_pk_bf16_f32 v51, v38, v39
    v_mfma_f32_32x32x8_bf16 v[16:31], a[36:37], v[92:93], v[16:31]
    ds_write_b128 v4, v[76:79] offset:1024
    v_exp_f32 v41, v41
    v_exp_f32 v42, v42
    v_cvt_pk_bf16_f32 v52, v40, v41
    v_exp_f32 v43, v43
    v_exp_f32 v44, v44
    v_mfma_f32_32x32x16_bf16 v[56:71], a[20:23], v[48:51], v[56:71]
    ds_write_b128 v4, v[80:83] offset:2048
    v_exp_f32 v45, v45
    v_cvt_pk_bf16_f32 v53, v42, v43
    v_exp_f32 v46, v46
    v_exp_f32 v47, v47
    v_cvt_pk_bf16_f32 v54, v44, v45
    v_cvt_pk_bf16_f32 v55, v46, v47
    v_exp_f32 v16, v16
    v_exp_f32 v17, v17
    v_mfma_f32_32x32x16_bf16 v[56:71], a[24:27], v[52:55], v[56:71]
    ds_read_b128 v[96:99], v8
    ds_read_b64 v[100:101], v9
    s_mul_i32 s3, s82, 102400
    s_add_u32 s3, s3, 25165824
    v_exp_f32 v18, v18
    v_cvt_pk_bf16_f32 v48, v16, v17
    v_exp_f32 v19, v19
    v_exp_f32 v20, v20
    v_cvt_pk_bf16_f32 v49, v18, v19
    v_mfma_f32_32x32x16_bf16 v[32:47], a[32:35], v[88:91], 0
    v_add_u32 v13, s3, v1
    s_mul_i32 s98, s80, 25600
    v_exp_f32 v21, v21
    v_exp_f32 v22, v22
    v_cvt_pk_bf16_f32 v50, v20, v21
    v_exp_f32 v23, v23
    v_exp_f32 v24, v24
    v_cvt_pk_bf16_f32 v51, v22, v23
    v_mfma_f32_32x32x8_bf16 v[32:47], a[38:39], v[92:93], v[32:47]
    s_add_u32 s98, s98, 24576
    s_cmp_eq_u32 s80, 3
    s_cselect_b32 s98, 112640, s98
    v_exp_f32 v25, v25
    v_exp_f32 v26, v26
    v_cvt_pk_bf16_f32 v52, v24, v25
    v_exp_f32 v27, v27
    v_exp_f32 v28, v28
    v_mfma_f32_32x32x16_bf16 v[56:71], a[40:43], v[48:51], v[56:71]
    s_mul_i32 s3, s80, 5
    s_add_u32 s3, s3, 0
    v_exp_f32 v29, v29
    v_cvt_pk_bf16_f32 v53, v26, v27
    v_exp_f32 v30, v30
    v_exp_f32 v31, v31
    v_cvt_pk_bf16_f32 v54, v28, v29
    v_cvt_pk_bf16_f32 v55, v30, v31
    v_exp_f32 v32, v32
    v_exp_f32 v33, v33
    v_mfma_f32_32x32x16_bf16 v[56:71], a[44:47], v[52:55], v[56:71]
    s_waitcnt lgkmcnt(0)
    s_barrier
    s_lshl_b32 s2, s82, 1
    s_add_u32 s2, s2, s3
    v_exp_f32 v34, v34
    v_cvt_pk_bf16_f32 v48, v32, v33
    v_exp_f32 v35, v35
    v_exp_f32 v36, v36
    v_cvt_pk_bf16_f32 v49, v34, v35
    v_mfma_f32_32x32x16_bf16 v[16:31], a[56:59], v[88:91], 0
    ds_read_b128 v[72:75], v10
    s_and_b32 s2, s2, 7
    s_and_b32 s66, s3, 8
    v_exp_f32 v37, v37
    v_exp_f32 v38, v38
    v_cvt_pk_bf16_f32 v50, v36, v37
    v_exp_f32 v39, v39
    v_exp_f32 v40, v40
    v_cvt_pk_bf16_f32 v51, v38, v39
    v_mfma_f32_32x32x8_bf16 v[16:31], a[64:65], v[92:93], v[16:31]
    ds_read_b128 v[76:79], v10 offset:1024
    s_add_u32 s2, s2, s66
    s_cmp_ge_u32 s3, 16
    s_cselect_b32 s2, s3, s2
    v_exp_f32 v41, v41
    v_exp_f32 v42, v42
    v_cvt_pk_bf16_f32 v52, v40, v41
    v_exp_f32 v43, v43
    v_exp_f32 v44, v44
    v_mfma_f32_32x32x16_bf16 v[56:71], a[48:51], v[48:51], v[56:71]
    ds_read_b128 v[80:83], v10 offset:2048
    s_mul_i32 s40, s2, 5120
    s_mul_i32 s3, s80, 5
    v_exp_f32 v45, v45
    v_cvt_pk_bf16_f32 v53, v42, v43
    v_exp_f32 v46, v46
    v_exp_f32 v47, v47
    v_cvt_pk_bf16_f32 v54, v44, v45
    v_cvt_pk_bf16_f32 v55, v46, v47
    v_exp_f32 v16, v16
    v_exp_f32 v17, v17
    v_mfma_f32_32x32x16_bf16 v[56:71], a[52:55], v[52:55], v[56:71]
    s_add_u32 s3, s3, 1
    s_lshl_b32 s2, s82, 1
    v_exp_f32 v18, v18
    v_cvt_pk_bf16_f32 v48, v16, v17
    v_exp_f32 v19, v19
    v_exp_f32 v20, v20
    v_cvt_pk_bf16_f32 v49, v18, v19
    v_mfma_f32_32x32x16_bf16 v[32:47], a[60:63], v[88:91], 0
    s_add_u32 s2, s2, s3
    s_and_b32 s2, s2, 7
    v_exp_f32 v21, v21
    v_exp_f32 v22, v22
    v_cvt_pk_bf16_f32 v50, v20, v21
    v_exp_f32 v23, v23
    v_exp_f32 v24, v24
    v_cvt_pk_bf16_f32 v51, v22, v23
    v_mfma_f32_32x32x8_bf16 v[32:47], a[66:67], v[92:93], v[32:47]
    s_and_b32 s66, s3, 8
    s_add_u32 s2, s2, s66
    v_exp_f32 v25, v25
    v_exp_f32 v26, v26
    v_cvt_pk_bf16_f32 v52, v24, v25
    v_exp_f32 v27, v27
    v_exp_f32 v28, v28
    v_mfma_f32_32x32x16_bf16 v[56:71], a[68:71], v[48:51], v[56:71]
    s_cmp_ge_u32 s3, 16
    s_cselect_b32 s2, s3, s2
    s_mul_i32 s41, s2, 5120
    v_exp_f32 v29, v29
    v_cvt_pk_bf16_f32 v53, v26, v27
    v_exp_f32 v30, v30
    v_exp_f32 v31, v31
    v_cvt_pk_bf16_f32 v54, v28, v29
    v_cvt_pk_bf16_f32 v55, v30, v31
    v_exp_f32 v32, v32
    v_exp_f32 v33, v33
    v_mfma_f32_32x32x16_bf16 v[56:71], a[72:75], v[52:55], v[56:71]
    s_mul_i32 s3, s80, 5
    s_add_u32 s3, s3, 2
    v_exp_f32 v34, v34
    v_cvt_pk_bf16_f32 v48, v32, v33
    v_exp_f32 v35, v35
    v_exp_f32 v36, v36
    v_cvt_pk_bf16_f32 v49, v34, v35
    v_mfma_f32_32x32x16_bf16 v[16:31], a[84:87], v[88:91], 0
    s_lshl_b32 s2, s82, 1
    s_add_u32 s2, s2, s3
    v_exp_f32 v37, v37
    v_exp_f32 v38, v38
    v_cvt_pk_bf16_f32 v50, v36, v37
    v_exp_f32 v39, v39
    v_exp_f32 v40, v40
    v_cvt_pk_bf16_f32 v51, v38, v39
    v_mfma_f32_32x32x8_bf16 v[16:31], a[92:93], v[92:93], v[16:31]
    s_and_b32 s2, s2, 7
    s_and_b32 s66, s3, 8
    v_exp_f32 v41, v41
    v_exp_f32 v42, v42
    v_cvt_pk_bf16_f32 v52, v40, v41
    v_exp_f32 v43, v43
    v_exp_f32 v44, v44
    v_mfma_f32_32x32x16_bf16 v[56:71], a[76:79], v[48:51], v[56:71]
    s_add_u32 s2, s2, s66
    s_cmp_ge_u32 s3, 16
    s_cselect_b32 s2, s3, s2
    v_exp_f32 v45, v45
    v_cvt_pk_bf16_f32 v53, v42, v43
    v_exp_f32 v46, v46
    v_exp_f32 v47, v47
    v_cvt_pk_bf16_f32 v54, v44, v45
    v_cvt_pk_bf16_f32 v55, v46, v47
    v_exp_f32 v16, v16
    v_exp_f32 v17, v17
    v_mfma_f32_32x32x16_bf16 v[56:71], a[80:83], v[52:55], v[56:71]
    s_mul_i32 s42, s2, 5120
    s_mul_i32 s3, s80, 5
    v_exp_f32 v18, v18
    v_cvt_pk_bf16_f32 v48, v16, v17
    v_exp_f32 v19, v19
    v_exp_f32 v20, v20
    v_cvt_pk_bf16_f32 v49, v18, v19
    v_mfma_f32_32x32x16_bf16 v[32:47], a[88:91], v[88:91], 0
    s_add_u32 s3, s3, 3
    s_lshl_b32 s2, s82, 1
    v_exp_f32 v21, v21
    v_exp_f32 v22, v22
    v_cvt_pk_bf16_f32 v50, v20, v21
    v_exp_f32 v23, v23
    v_exp_f32 v24, v24
    v_cvt_pk_bf16_f32 v51, v22, v23
    v_mfma_f32_32x32x8_bf16 v[32:47], a[94:95], v[92:93], v[32:47]
    s_add_u32 s2, s2, s3
    s_and_b32 s2, s2, 7
    v_exp_f32 v25, v25
    v_exp_f32 v26, v26
    v_cvt_pk_bf16_f32 v52, v24, v25
    v_exp_f32 v27, v27
    v_exp_f32 v28, v28
    v_mfma_f32_32x32x16_bf16 v[56:71], a[96:99], v[48:51], v[56:71]
    s_and_b32 s66, s3, 8
    s_add_u32 s2, s2, s66
    v_exp_f32 v29, v29
    v_cvt_pk_bf16_f32 v53, v26, v27
    v_exp_f32 v30, v30
    v_exp_f32 v31, v31
    v_cvt_pk_bf16_f32 v54, v28, v29
    v_cvt_pk_bf16_f32 v55, v30, v31
    v_exp_f32 v32, v32
    v_exp_f32 v33, v33
    v_mfma_f32_32x32x16_bf16 v[56:71], a[100:103], v[52:55], v[56:71]
    s_cmp_ge_u32 s3, 16
    s_cselect_b32 s2, s3, s2
    s_mul_i32 s43, s2, 5120
    v_exp_f32 v34, v34
    v_cvt_pk_bf16_f32 v48, v32, v33
    v_exp_f32 v35, v35
    v_exp_f32 v36, v36
    v_cvt_pk_bf16_f32 v49, v34, v35
    v_mfma_f32_32x32x16_bf16 v[16:31], a[112:115], v[88:91], 0
    s_mul_i32 s3, s80, 5
    s_add_u32 s3, s3, 4
    v_exp_f32 v37, v37
    v_exp_f32 v38, v38
    v_cvt_pk_bf16_f32 v50, v36, v37
    v_exp_f32 v39, v39
    v_exp_f32 v40, v40
    v_cvt_pk_bf16_f32 v51, v38, v39
    v_mfma_f32_32x32x8_bf16 v[16:31], a[120:121], v[92:93], v[16:31]
    s_lshl_b32 s2, s82, 1
    s_add_u32 s2, s2, s3
    v_exp_f32 v41, v41
    v_exp_f32 v42, v42
    v_cvt_pk_bf16_f32 v52, v40, v41
    v_exp_f32 v43, v43
    v_exp_f32 v44, v44
    v_mfma_f32_32x32x16_bf16 v[56:71], a[104:107], v[48:51], v[56:71]
    s_and_b32 s2, s2, 7
    s_and_b32 s66, s3, 8
    v_exp_f32 v45, v45
    v_cvt_pk_bf16_f32 v53, v42, v43
    v_exp_f32 v46, v46
    v_exp_f32 v47, v47
    v_cvt_pk_bf16_f32 v54, v44, v45
    v_cvt_pk_bf16_f32 v55, v46, v47
    v_exp_f32 v16, v16
    v_exp_f32 v17, v17
    v_mfma_f32_32x32x16_bf16 v[56:71], a[108:111], v[52:55], v[56:71]
    s_add_u32 s2, s2, s66
    s_cmp_ge_u32 s3, 16
    s_cselect_b32 s2, s3, s2
    v_exp_f32 v18, v18
    v_cvt_pk_bf16_f32 v48, v16, v17
    v_exp_f32 v19, v19
    v_exp_f32 v20, v20
    v_cvt_pk_bf16_f32 v49, v18, v19
    v_mfma_f32_32x32x16_bf16 v[32:47], a[116:119], v[88:91], 0
    s_mul_i32 s44, s2, 5120
    v_exp_f32 v21, v21
    v_exp_f32 v22, v22
    v_cvt_pk_bf16_f32 v50, v20, v21
    v_exp_f32 v23, v23
    v_exp_f32 v24, v24
    v_cvt_pk_bf16_f32 v51, v22, v23
    v_mfma_f32_32x32x8_bf16 v[32:47], a[122:123], v[92:93], v[32:47]
    v_exp_f32 v25, v25
    v_exp_f32 v26, v26
    v_cvt_pk_bf16_f32 v52, v24, v25
    v_exp_f32 v27, v27
    v_exp_f32 v28, v28
    v_mfma_f32_32x32x16_bf16 v[56:71], a[124:127], v[48:51], v[56:71]
    v_exp_f32 v29, v29
    v_cvt_pk_bf16_f32 v53, v26, v27
    v_exp_f32 v30, v30
    v_exp_f32 v31, v31
    v_cvt_pk_bf16_f32 v54, v28, v29
    v_cvt_pk_bf16_f32 v55, v30, v31
    v_exp_f32 v32, v32
    v_exp_f32 v33, v33
    v_mfma_f32_32x32x16_bf16 v[56:71], a[128:131], v[52:55], v[56:71]
    v_accvgpr_read_b32 v124, a244
    v_accvgpr_read_b32 v125, a245
    v_exp_f32 v34, v34
    v_cvt_pk_bf16_f32 v48, v32, v33
    v_exp_f32 v35, v35
    v_exp_f32 v36, v36
    v_cvt_pk_bf16_f32 v49, v34, v35
    v_mfma_f32_32x32x16_bf16 v[16:31], a[140:143], v[88:91], 0
    v_accvgpr_read_b32 v126, a246
    v_exp_f32 v37, v37
    v_exp_f32 v38, v38
    v_cvt_pk_bf16_f32 v50, v36, v37
    v_exp_f32 v39, v39
    v_exp_f32 v40, v40
    v_cvt_pk_bf16_f32 v51, v38, v39
    v_mfma_f32_32x32x8_bf16 v[16:31], a[148:149], v[92:93], v[16:31]
    buffer_load_dwordx4 v[108:111], v124, s[32:35], 0 offen offset:0 sc1
    v_exp_f32 v41, v41
    v_exp_f32 v42, v42
    v_cvt_pk_bf16_f32 v52, v40, v41
    v_exp_f32 v43, v43
    v_exp_f32 v44, v44
    v_mfma_f32_32x32x16_bf16 v[56:71], a[132:135], v[48:51], v[56:71]
    s_mov_b32 s89, 30720
    buffer_load_dwordx4 v[112:115], v124, s[32:35], s89 offen offset:0 sc1
    v_exp_f32 v45, v45
    v_cvt_pk_bf16_f32 v53, v42, v43
    v_exp_f32 v46, v46
    v_exp_f32 v47, v47
    v_cvt_pk_bf16_f32 v54, v44, v45
    v_cvt_pk_bf16_f32 v55, v46, v47
    v_exp_f32 v16, v16
    v_exp_f32 v17, v17
    v_mfma_f32_32x32x16_bf16 v[56:71], a[136:139], v[52:55], v[56:71]
    s_mov_b32 s89, 61440
    buffer_load_dwordx4 v[116:119], v124, s[32:35], s89 offen offset:0 sc1
    v_exp_f32 v18, v18
    v_cvt_pk_bf16_f32 v48, v16, v17
    v_exp_f32 v19, v19
    v_exp_f32 v20, v20
    v_cvt_pk_bf16_f32 v49, v18, v19
    v_mfma_f32_32x32x16_bf16 v[32:47], a[144:147], v[88:91], 0
    s_mov_b32 s89, 92160
    buffer_load_dwordx4 v[120:123], v124, s[32:35], s89 offen offset:0 sc1
    v_exp_f32 v21, v21
    v_exp_f32 v22, v22
    v_cvt_pk_bf16_f32 v50, v20, v21
    v_exp_f32 v23, v23
    v_exp_f32 v24, v24
    v_cvt_pk_bf16_f32 v51, v22, v23
    v_mfma_f32_32x32x8_bf16 v[32:47], a[150:151], v[92:93], v[32:47]
    v_exp_f32 v25, v25
    v_exp_f32 v26, v26
    v_cvt_pk_bf16_f32 v52, v24, v25
    v_exp_f32 v27, v27
    v_exp_f32 v28, v28
    v_mfma_f32_32x32x16_bf16 v[56:71], a[152:155], v[48:51], v[56:71]
    v_accvgpr_read_b32 v205, a230
    v_exp_f32 v29, v29
    v_cvt_pk_bf16_f32 v53, v26, v27
    v_exp_f32 v30, v30
    v_exp_f32 v31, v31
    v_cvt_pk_bf16_f32 v54, v28, v29
    v_cvt_pk_bf16_f32 v55, v30, v31
    v_exp_f32 v32, v32
    v_exp_f32 v33, v33
    v_mfma_f32_32x32x16_bf16 v[56:71], a[156:159], v[52:55], v[56:71]
    v_add_u32 v205, 1015808, v205
    v_exp_f32 v34, v34
    v_cvt_pk_bf16_f32 v48, v32, v33
    v_exp_f32 v35, v35
    v_exp_f32 v36, v36
    v_cvt_pk_bf16_f32 v49, v34, v35
    v_mfma_f32_32x32x16_bf16 v[16:31], a[168:171], v[88:91], 0
    buffer_load_dword v204, v205, s[32:35], 0 offen sc1
    v_exp_f32 v37, v37
    v_exp_f32 v38, v38
    v_cvt_pk_bf16_f32 v50, v36, v37
    v_exp_f32 v39, v39
    v_exp_f32 v40, v40
    v_cvt_pk_bf16_f32 v51, v38, v39
    v_mfma_f32_32x32x8_bf16 v[16:31], a[176:177], v[92:93], v[16:31]
    v_exp_f32 v41, v41
    v_exp_f32 v42, v42
    v_cvt_pk_bf16_f32 v52, v40, v41
    v_exp_f32 v43, v43
    v_exp_f32 v44, v44
    v_mfma_f32_32x32x16_bf16 v[56:71], a[160:163], v[48:51], v[56:71]
    v_exp_f32 v45, v45
    v_cvt_pk_bf16_f32 v53, v42, v43
    v_exp_f32 v46, v46
    v_exp_f32 v47, v47
    v_cvt_pk_bf16_f32 v54, v44, v45
    v_cvt_pk_bf16_f32 v55, v46, v47
    v_exp_f32 v16, v16
    v_exp_f32 v17, v17
    v_mfma_f32_32x32x16_bf16 v[56:71], a[164:167], v[52:55], v[56:71]
    s_lshl_b32 s20, s82, 2
    v_exp_f32 v18, v18
    v_cvt_pk_bf16_f32 v48, v16, v17
    v_exp_f32 v19, v19
    v_exp_f32 v20, v20
    v_cvt_pk_bf16_f32 v49, v18, v19
    v_mfma_f32_32x32x16_bf16 v[32:47], a[172:175], v[88:91], 0
    s_add_u32 s20, s20, s80
    v_exp_f32 v21, v21
    v_exp_f32 v22, v22
    v_cvt_pk_bf16_f32 v50, v20, v21
    v_exp_f32 v23, v23
    v_exp_f32 v24, v24
    v_cvt_pk_bf16_f32 v51, v22, v23
    v_mfma_f32_32x32x8_bf16 v[32:47], a[178:179], v[92:93], v[32:47]
    s_mul_i32 s20, s20, 122880
    v_exp_f32 v25, v25
    v_exp_f32 v26, v26
    v_cvt_pk_bf16_f32 v52, v24, v25
    v_exp_f32 v27, v27
    v_exp_f32 v28, v28
    v_mfma_f32_32x32x16_bf16 v[56:71], a[180:183], v[48:51], v[56:71]
    s_and_b32 s21, s81, 3
    v_exp_f32 v29, v29
    v_cvt_pk_bf16_f32 v53, v26, v27
    v_exp_f32 v30, v30
    v_exp_f32 v31, v31
    v_cvt_pk_bf16_f32 v54, v28, v29
    v_cvt_pk_bf16_f32 v55, v30, v31
    v_exp_f32 v32, v32
    v_exp_f32 v33, v33
    v_mfma_f32_32x32x16_bf16 v[56:71], a[184:187], v[52:55], v[56:71]
    s_mul_i32 s21, s21, 12288
    v_exp_f32 v34, v34
    v_cvt_pk_bf16_f32 v48, v32, v33
    v_exp_f32 v35, v35
    v_exp_f32 v36, v36
    v_cvt_pk_bf16_f32 v49, v34, v35
    v_mfma_f32_32x32x16_bf16 v[16:31], a[196:199], v[88:91], 0
    s_add_u32 s20, s20, s21
    v_exp_f32 v37, v37
    v_exp_f32 v38, v38
    v_cvt_pk_bf16_f32 v50, v36, v37
    v_exp_f32 v39, v39
    v_exp_f32 v40, v40
    v_cvt_pk_bf16_f32 v51, v38, v39
    v_mfma_f32_32x32x8_bf16 v[16:31], a[204:205], v[92:93], v[16:31]
    s_add_u32 s20, s20, 18874368
    v_exp_f32 v41, v41
    v_exp_f32 v42, v42
    v_cvt_pk_bf16_f32 v52, v40, v41
    v_exp_f32 v43, v43
    v_exp_f32 v44, v44
    v_mfma_f32_32x32x16_bf16 v[56:71], a[188:191], v[48:51], v[56:71]
    v_lshl_add_u32 v245, v0, 7, s20
    v_exp_f32 v45, v45
    v_cvt_pk_bf16_f32 v53, v42, v43
    v_exp_f32 v46, v46
    v_exp_f32 v47, v47
    v_cvt_pk_bf16_f32 v54, v44, v45
    v_cvt_pk_bf16_f32 v55, v46, v47
    v_exp_f32 v16, v16
    v_exp_f32 v17, v17
    v_mfma_f32_32x32x16_bf16 v[56:71], a[192:195], v[52:55], v[56:71]
    v_accvgpr_write_b32 a229, v245
    v_exp_f32 v18, v18
    v_cvt_pk_bf16_f32 v48, v16, v17
    v_exp_f32 v19, v19
    v_exp_f32 v20, v20
    v_cvt_pk_bf16_f32 v49, v18, v19
    v_mfma_f32_32x32x16_bf16 v[32:47], a[200:203], v[88:91], 0
    v_exp_f32 v21, v21
    v_exp_f32 v22, v22
    v_cvt_pk_bf16_f32 v50, v20, v21
    v_exp_f32 v23, v23
    v_exp_f32 v24, v24
    v_cvt_pk_bf16_f32 v51, v22, v23
    v_mfma_f32_32x32x8_bf16 v[32:47], a[206:207], v[92:93], v[32:47]
    v_exp_f32 v25, v25
    v_exp_f32 v26, v26
    v_cvt_pk_bf16_f32 v52, v24, v25
    v_exp_f32 v27, v27
    v_exp_f32 v28, v28
    v_mfma_f32_32x32x16_bf16 v[56:71], a[208:211], v[48:51], v[56:71]
    v_exp_f32 v29, v29
    v_cvt_pk_bf16_f32 v53, v26, v27
    v_exp_f32 v30, v30
    v_exp_f32 v31, v31
    v_cvt_pk_bf16_f32 v54, v28, v29
    v_cvt_pk_bf16_f32 v55, v30, v31
    v_exp_f32 v32, v32
    v_exp_f32 v33, v33
    v_mfma_f32_32x32x16_bf16 v[56:71], a[212:215], v[52:55], v[56:71]
    s_waitcnt vmcnt(0)
    v_cmp_ne_u32 vcc, s84, v204
    s_cbranch_vccz L_ptok_24
    s_mov_b32 s88, 400000
L_poll_25:
    buffer_load_dword v204, v205, s[32:35], 0 offen sc1
    s_sub_u32 s88, s88, 1
    s_cbranch_scc1 L_end
    s_waitcnt vmcnt(0)
    v_cmp_ne_u32 vcc, s84, v204
    s_cbranch_vccnz L_poll_25
L_ptok_24:
    v_exp_f32 v34, v34
    v_cvt_pk_bf16_f32 v48, v32, v33
    v_exp_f32 v35, v35
    v_exp_f32 v36, v36
    v_cvt_pk_bf16_f32 v49, v34, v35
    s_waitcnt lgkmcnt(0)
    v_mfma_f32_32x32x16_bf16 v[16:31], a[0:3], v[96:99], 0
    v_exp_f32 v37, v37
    v_exp_f32 v38, v38
    v_cvt_pk_bf16_f32 v50, v36, v37
    v_exp_f32 v39, v39
    v_exp_f32 v40, v40
    v_cvt_pk_bf16_f32 v51, v38, v39
    v_mfma_f32_32x32x8_bf16 v[16:31], a[8:9], v[100:101], v[16:31]
    v_exp_f32 v41, v41
    v_exp_f32 v42, v42
    v_cvt_pk_bf16_f32 v52, v40, v41
    v_exp_f32 v43, v43
    v_exp_f32 v44, v44
    v_mfma_f32_32x32x16_bf16 v[56:71], a[216:219], v[48:51], v[56:71]
    v_exp_f32 v45, v45
    v_cvt_pk_bf16_f32 v53, v42, v43
    v_exp_f32 v46, v46
    v_exp_f32 v47, v47
    v_cvt_pk_bf16_f32 v54, v44, v45
    v_cvt_pk_bf16_f32 v55, v46, v47
    v_exp_f32 v16, v16
    v_exp_f32 v17, v17
    v_mfma_f32_32x32x16_bf16 v[56:71], a[220:223], v[52:55], v[56:71]
    s_lshl_b32 s22, s80, 1
    s_add_u32 s22, s22, 6
    v_accvgpr_read_b32 v12, a229
    v_exp_f32 v18, v18
    v_cvt_pk_bf16_f32 v48, v16, v17
    v_exp_f32 v19, v19
    v_exp_f32 v20, v20
    v_cvt_pk_bf16_f32 v49, v18, v19
    v_mfma_f32_32x32x16_bf16 v[32:47], a[4:7], v[96:99], 0
    s_and_b32 s22, s22, 7
    s_mul_i32 s23, s22, 1280
    s_mov_b64 exec, 0xffff
    buffer_load_dword v244, v12, s[32:35], 0 offen offset:0 sc1
    s_mov_b64 exec, -1
    v_exp_f32 v21, v21
    v_exp_f32 v22, v22
    v_cvt_pk_bf16_f32 v50, v20, v21
    v_exp_f32 v23, v23
    v_exp_f32 v24, v24
    v_cvt_pk_bf16_f32 v51, v22, v23
    v_mfma_f32_32x32x8_bf16 v[32:47], a[10:11], v[100:101], v[32:47]
    v_add_u32 v8, s23, v2
    v_add_u32 v9, s23, v3
    s_mul_i32 s23, s22, 3072
    v_exp_f32 v25, v25
    v_exp_f32 v26, v26
    v_cvt_pk_bf16_f32 v52, v24, v25
    v_exp_f32 v27, v27
    v_exp_f32 v28, v28
    v_mfma_f32_32x32x16_bf16 v[72:87], a[12:15], v[48:51], v[72:87]
    v_add_u32 v10, s23, v1
    s_add_u32 s22, s22, 6
    v_exp_f32 v29, v29
    v_cvt_pk_bf16_f32 v53, v26, v27
    v_exp_f32 v30, v30
    v_exp_f32 v31, v31
    v_cvt_pk_bf16_f32 v54, v28, v29
    v_cvt_pk_bf16_f32 v55, v30, v31
    v_exp_f32 v32, v32
    v_exp_f32 v33, v33
    v_mfma_f32_32x32x16_bf16 v[72:87], a[16:19], v[52:55], v[72:87]
    s_and_b32 s22, s22, 7
    s_mul_i32 s23, s22, 3072
    v_add_u32 v4, s23, v1
    s_mov_b32 s88, 400000
L_modchk_27:
    v_min_u32 v150, v109, v111
    v_max_u32 v151, v109, v111
    v_min3_u32 v150, v150, v113, v115
    v_max3_u32 v151, v151, v113, v115
    v_min3_u32 v150, v150, v117, v119
    v_max3_u32 v151, v151, v117, v119
    v_min3_u32 v150, v150, v121, v123
    v_max3_u32 v151, v151, v121, v123
    v_cmp_ne_u32 vcc, s84, v150
    v_cmp_ne_u32 s[96:97], s84, v151
    s_or_b64 vcc, vcc, s[96:97]
    s_cbranch_vccz L_modok_28
    s_sub_u32 s88, s88, 1
    s_cbranch_scc1 L_end
    buffer_load_dwordx4 v[108:111], v124, s[32:35], 0 offen offset:0 sc1
    s_mov_b32 s89, 30720
    buffer_load_dwordx4 v[112:115], v124, s[32:35], s89 offen offset:0 sc1
    s_mov_b32 s89, 61440
    buffer_load_dwordx4 v[116:119], v124, s[32:35], s89 offen offset:0 sc1
    s_mov_b32 s89, 92160
    buffer_load_dwordx4 v[120:123], v124, s[32:35], s89 offen offset:0 sc1
    s_waitcnt vmcnt(0)
    s_branch L_modchk_27
L_modok_28:
    v_add_f32 v108, v108, v112
    v_add_f32 v110, v110, v114
    v_exp_f32 v34, v34
    v_cvt_pk_bf16_f32 v48, v32, v33
    v_exp_f32 v35, v35
    v_exp_f32 v36, v36
    v_cvt_pk_bf16_f32 v49, v34, v35
    v_mfma_f32_32x32x16_bf16 v[16:31], a[28:31], v[96:99], 0
    ds_write_b128 v4, v[56:59] offset:0
    v_add_f32 v116, v116, v120
    v_add_f32 v118, v118, v122
    v_add_f32 v108, v108, v116
    v_add_f32 v110, v110, v118
    v_exp_f32 v37, v37
    v_exp_f32 v38, v38
    v_cvt_pk_bf16_f32 v50, v36, v37
    v_exp_f32 v39, v39
    v_exp_f32 v40, v40
    v_cvt_pk_bf16_f32 v51, v38, v39
    v_mfma_f32_32x32x8_bf16 v[16:31], a[36:37], v[100:101], v[16:31]
    ds_write_b128 v4, v[60:63] offset:1024
    v_cvt_pk_bf16_f32 v112, v108, v110
    v_lshlrev_b32 v108, 16, v112
    v_and_b32 v109, 0xffff0000, v112
    v_exp_f32 v41, v41
    v_exp_f32 v42, v42
    v_cvt_pk_bf16_f32 v52, v40, v41
    v_exp_f32 v43, v43
    v_exp_f32 v44, v44
    v_mfma_f32_32x32x16_bf16 v[72:87], a[20:23], v[48:51], v[72:87]
    ds_write_b128 v4, v[64:67] offset:2048
    v_add_f32 v108, v126, v108
    v_add_f32 v109, v126, v109
    v_exp_f32 v45, v45
    v_cvt_pk_bf16_f32 v53, v42, v43
    v_exp_f32 v46, v46
    v_exp_f32 v47, v47
    v_cvt_pk_bf16_f32 v54, v44, v45
    v_cvt_pk_bf16_f32 v55, v46, v47
    v_exp_f32 v16, v16
    v_exp_f32 v17, v17
    v_mfma_f32_32x32x16_bf16 v[72:87], a[24:27], v[52:55], v[72:87]
    ds_read_b128 v[88:91], v8
    ds_read_b64 v[92:93], v9
    v_cvt_pk_bf16_f32 v112, v108, v109
    v_lshlrev_b32 v108, 16, v112
    v_and_b32 v109, 0xffff0000, v112
    v_exp_f32 v18, v18
    v_cvt_pk_bf16_f32 v48, v16, v17
    v_exp_f32 v19, v19
    v_exp_f32 v20, v20
    v_cvt_pk_bf16_f32 v49, v18, v19
    v_mfma_f32_32x32x16_bf16 v[32:47], a[32:35], v[96:99], 0
    ds_write_b64 v125, v[108:109]
    v_accvgpr_read_b32 v236, a255
    v_exp_f32 v21, v21
    v_exp_f32 v22, v22
    v_cvt_pk_bf16_f32 v50, v20, v21
    v_exp_f32 v23, v23
    v_exp_f32 v24, v24
    v_cvt_pk_bf16_f32 v51, v22, v23
    v_mfma_f32_32x32x8_bf16 v[32:47], a[38:39], v[100:101], v[32:47]
    v_and_b32 v150, 27, v0
    v_cmp_eq_u32 s[94:95], 0, v150
    v_exp_f32 v25, v25
    v_exp_f32 v26, v26
    v_cvt_pk_bf16_f32 v52, v24, v25
    v_exp_f32 v27, v27
    v_exp_f32 v28, v28
    v_mfma_f32_32x32x16_bf16 v[72:87], a[40:43], v[48:51], v[72:87]
    s_lshl_b32 s67, s80, 10
    v_exp_f32 v29, v29
    v_cvt_pk_bf16_f32 v53, v26, v27
    v_exp_f32 v30, v30
    v_exp_f32 v31, v31
    v_cvt_pk_bf16_f32 v54, v28, v29
    v_cvt_pk_bf16_f32 v55, v30, v31
    v_exp_f32 v32, v32
    v_exp_f32 v33, v33
    v_mfma_f32_32x32x16_bf16 v[72:87], a[44:47], v[52:55], v[72:87]
    s_waitcnt lgkmcnt(0)
    s_barrier
    s_add_u32 s67, s67, 149504
    v_lshl_add_u32 v237, v0, 2, s67
    v_exp_f32 v34, v34
    v_cvt_pk_bf16_f32 v48, v32, v33
    v_exp_f32 v35, v35
    v_exp_f32 v36, v36
    v_cvt_pk_bf16_f32 v49, v34, v35
    v_mfma_f32_32x32x16_bf16 v[16:31], a[56:59], v[96:99], 0
    ds_read_b128 v[56:59], v10
    v_exp_f32 v37, v37
    v_exp_f32 v38, v38
    v_cvt_pk_bf16_f32 v50, v36, v37
    v_exp_f32 v39, v39
    v_exp_f32 v40, v40
    v_cvt_pk_bf16_f32 v51, v38, v39
    v_mfma_f32_32x32x8_bf16 v[16:31], a[64:65], v[100:101], v[16:31]
    ds_read_b128 v[60:63], v10 offset:1024
    v_exp_f32 v41, v41
    v_exp_f32 v42, v42
    v_cvt_pk_bf16_f32 v52, v40, v41
    v_exp_f32 v43, v43
    v_exp_f32 v44, v44
    v_mfma_f32_32x32x16_bf16 v[72:87], a[48:51], v[48:51], v[72:87]
    ds_read_b128 v[64:67], v10 offset:2048
    v_exp_f32 v45, v45
    v_cvt_pk_bf16_f32 v53, v42, v43
    v_exp_f32 v46, v46
    v_exp_f32 v47, v47
    v_cvt_pk_bf16_f32 v54, v44, v45
    v_cvt_pk_bf16_f32 v55, v46, v47
    v_exp_f32 v16, v16
    v_exp_f32 v17, v17
    v_mfma_f32_32x32x16_bf16 v[72:87], a[52:55], v[52:55], v[72:87]
    v_exp_f32 v18, v18
    v_cvt_pk_bf16_f32 v48, v16, v17
    v_exp_f32 v19, v19
    v_exp_f32 v20, v20
    v_cvt_pk_bf16_f32 v49, v18, v19
    v_mfma_f32_32x32x16_bf16 v[32:47], a[60:63], v[96:99], 0
    s_waitcnt lgkmcnt(0)
    s_barrier
    v_exp_f32 v21, v21
    v_exp_f32 v22, v22
    v_cvt_pk_bf16_f32 v50, v20, v21
    v_exp_f32 v23, v23
    v_exp_f32 v24, v24
    v_cvt_pk_bf16_f32 v51, v22, v23
    v_mfma_f32_32x32x8_bf16 v[32:47], a[66:67], v[100:101], v[32:47]
    ds_read_b128 v[196:199], v236
    ds_read_b128 v[200:203], v236 offset:16
    v_exp_f32 v25, v25
    v_exp_f32 v26, v26
    v_cvt_pk_bf16_f32 v52, v24, v25
    v_exp_f32 v27, v27
    v_exp_f32 v28, v28
    v_mfma_f32_32x32x16_bf16 v[72:87], a[68:71], v[48:51], v[72:87]
    s_lshl_b32 s67, s80, 8
    v_exp_f32 v29, v29
    v_cvt_pk_bf16_f32 v53, v26, v27
    v_exp_f32 v30, v30
    v_exp_f32 v31, v31
    v_cvt_pk_bf16_f32 v54, v28, v29
    v_cvt_pk_bf16_f32 v55, v30, v31
    v_exp_f32 v32, v32
    v_exp_f32 v33, v33
    v_mfma_f32_32x32x16_bf16 v[72:87], a[72:75], v[52:55], v[72:87]
    s_add_u32 s67, s67, 149504
    v_lshl_add_u32 v238, v0, 2, s67
    v_exp_f32 v34, v34
    v_cvt_pk_bf16_f32 v48, v32, v33
    v_exp_f32 v35, v35
    v_exp_f32 v36, v36
    v_cvt_pk_bf16_f32 v49, v34, v35
    v_mfma_f32_32x32x16_bf16 v[16:31], a[84:87], v[96:99], 0
    s_mul_i32 s66, s86, 24576
    s_add_u32 s2, s25, s80
    v_exp_f32 v37, v37
    v_exp_f32 v38, v38
    v_cvt_pk_bf16_f32 v50, v36, v37
    v_exp_f32 v39, v39
    v_exp_f32 v40, v40
    v_cvt_pk_bf16_f32 v51, v38, v39
    v_mfma_f32_32x32x8_bf16 v[16:31], a[92:93], v[100:101], v[16:31]
    s_lshl_b32 s2, s2, 8
    s_add_u32 s66, s66, s2
    v_exp_f32 v41, v41
    v_exp_f32 v42, v42
    v_cvt_pk_bf16_f32 v52, v40, v41
    v_exp_f32 v43, v43
    v_exp_f32 v44, v44
    v_mfma_f32_32x32x16_bf16 v[72:87], a[76:79], v[48:51], v[72:87]
    s_add_u32 s66, s66, 262144
    v_exp_f32 v45, v45
    v_cvt_pk_bf16_f32 v53, v42, v43
    v_exp_f32 v46, v46
    v_exp_f32 v47, v47
    v_cvt_pk_bf16_f32 v54, v44, v45
    v_cvt_pk_bf16_f32 v55, v46, v47
    v_exp_f32 v16, v16
    v_exp_f32 v17, v17
    v_mfma_f32_32x32x16_bf16 v[72:87], a[80:83], v[52:55], v[72:87]
    v_lshl_add_u32 v239, v0, 2, s66
    v_exp_f32 v18, v18
    v_cvt_pk_bf16_f32 v48, v16, v17
    v_exp_f32 v19, v19
    v_exp_f32 v20, v20
    v_cvt_pk_bf16_f32 v49, v18, v19
    v_mfma_f32_32x32x16_bf16 v[32:47], a[88:91], v[96:99], 0
    v_exp_f32 v21, v21
    v_exp_f32 v22, v22
    v_cvt_pk_bf16_f32 v50, v20, v21
    v_exp_f32 v23, v23
    v_exp_f32 v24, v24
    v_cvt_pk_bf16_f32 v51, v22, v23
    v_mfma_f32_32x32x8_bf16 v[32:47], a[94:95], v[100:101], v[32:47]
    v_exp_f32 v25, v25
    v_exp_f32 v26, v26
    v_cvt_pk_bf16_f32 v52, v24, v25
    v_exp_f32 v27, v27
    v_exp_f32 v28, v28
    v_mfma_f32_32x32x16_bf16 v[72:87], a[96:99], v[48:51], v[72:87]
    v_exp_f32 v29, v29
    v_cvt_pk_bf16_f32 v53, v26, v27
    v_exp_f32 v30, v30
    v_exp_f32 v31, v31
    v_cvt_pk_bf16_f32 v54, v28, v29
    v_cvt_pk_bf16_f32 v55, v30, v31
    v_exp_f32 v32, v32
    v_exp_f32 v33, v33
    v_mfma_f32_32x32x16_bf16 v[72:87], a[100:103], v[52:55], v[72:87]
    s_waitcnt lgkmcnt(0)
    v_exp_f32 v34, v34
    v_cvt_pk_bf16_f32 v48, v32, v33
    v_exp_f32 v35, v35
    v_exp_f32 v36, v36
    v_cvt_pk_bf16_f32 v49, v34, v35
    v_mfma_f32_32x32x16_bf16 v[16:31], a[112:115], v[96:99], 0
    v_cvt_pk_bf16_f32 v196, v196, v197
    v_cvt_pk_bf16_f32 v197, v198, v199
    v_exp_f32 v37, v37
    v_exp_f32 v38, v38
    v_cvt_pk_bf16_f32 v50, v36, v37
    v_exp_f32 v39, v39
    v_exp_f32 v40, v40
    v_cvt_pk_bf16_f32 v51, v38, v39
    v_mfma_f32_32x32x8_bf16 v[16:31], a[120:121], v[100:101], v[16:31]
    v_cvt_pk_bf16_f32 v198, v200, v201
    v_cvt_pk_bf16_f32 v199, v202, v203
    v_accvgpr_read_b32 v12, a229
    v_exp_f32 v41, v41
    v_exp_f32 v42, v42
    v_cvt_pk_bf16_f32 v52, v40, v41
    v_exp_f32 v43, v43
    v_exp_f32 v44, v44
    v_mfma_f32_32x32x16_bf16 v[72:87], a[104:107], v[48:51], v[72:87]
    v_cndmask_b32 v196, 0, v196, s[94:95]
    s_mov_b64 exec, 0xffff
    buffer_load_dword v244, v12, s[32:35], 0 offen offset:2048 sc1
    s_mov_b64 exec, -1
    v_exp_f32 v45, v45
    v_cvt_pk_bf16_f32 v53, v42, v43
    v_exp_f32 v46, v46
    v_exp_f32 v47, v47
    v_cvt_pk_bf16_f32 v54, v44, v45
    v_cvt_pk_bf16_f32 v55, v46, v47
    v_exp_f32 v16, v16
    v_exp_f32 v17, v17
    v_mfma_f32_32x32x16_bf16 v[72:87], a[108:111], v[52:55], v[72:87]
    v_cndmask_b32 v197, 0, v197, s[94:95]
    v_cndmask_b32 v198, 0, v198, s[94:95]
    v_exp_f32 v18, v18
    v_cvt_pk_bf16_f32 v48, v16, v17
    v_exp_f32 v19, v19
    v_exp_f32 v20, v20
    v_cvt_pk_bf16_f32 v49, v18, v19
    v_mfma_f32_32x32x16_bf16 v[32:47], a[116:119], v[96:99], 0
    v_cndmask_b32 v199, 0, v199, s[94:95]
    s_nop 1
    v_mfma_f32_32x32x16_bf16 v[204:219], v[196:199], v[160:163], 0
    v_exp_f32 v21, v21
    v_exp_f32 v22, v22
    v_cvt_pk_bf16_f32 v50, v20, v21
    v_exp_f32 v23, v23
    v_exp_f32 v24, v24
    v_cvt_pk_bf16_f32 v51, v22, v23
    v_mfma_f32_32x32x8_bf16 v[32:47], a[122:123], v[100:101], v[32:47]
    v_mfma_f32_32x32x16_bf16 v[220:235], v[196:199], v[164:167], 0
    s_nop 3
    ds_write_b32 v237, v204 offset:0
    v_exp_f32 v25, v25
    v_exp_f32 v26, v26
    v_cvt_pk_bf16_f32 v52, v24, v25
    v_exp_f32 v27, v27
    v_exp_f32 v28, v28
    v_mfma_f32_32x32x16_bf16 v[72:87], a[124:127], v[48:51], v[72:87]
    v_mfma_f32_32x32x16_bf16 v[204:219], v[196:199], v[168:171], 0
    v_exp_f32 v29, v29
    v_cvt_pk_bf16_f32 v53, v26, v27
    v_exp_f32 v30, v30
    v_exp_f32 v31, v31
    v_cvt_pk_bf16_f32 v54, v28, v29
    v_cvt_pk_bf16_f32 v55, v30, v31
    v_exp_f32 v32, v32
    v_exp_f32 v33, v33
    v_mfma_f32_32x32x16_bf16 v[72:87], a[128:131], v[52:55], v[72:87]
    ds_write_b32 v237, v220 offset:256
    v_mfma_f32_32x32x16_bf16 v[220:235], v[196:199], v[172:175], 0
    v_exp_f32 v34, v34
    v_cvt_pk_bf16_f32 v48, v32, v33
    v_exp_f32 v35, v35
    v_exp_f32 v36, v36
    v_cvt_pk_bf16_f32 v49, v34, v35
    v_mfma_f32_32x32x16_bf16 v[16:31], a[140:143], v[96:99], 0
    ds_write_b32 v237, v204 offset:512
    v_exp_f32 v37, v37
    v_exp_f32 v38, v38
    v_cvt_pk_bf16_f32 v50, v36, v37
    v_exp_f32 v39, v39
    v_exp_f32 v40, v40
    v_cvt_pk_bf16_f32 v51, v38, v39
    v_mfma_f32_32x32x8_bf16 v[16:31], a[148:149], v[100:101], v[16:31]
    v_exp_f32 v41, v41
    v_exp_f32 v42, v42
    v_cvt_pk_bf16_f32 v52, v40, v41
    v_exp_f32 v43, v43
    v_exp_f32 v44, v44
    v_mfma_f32_32x32x16_bf16 v[72:87], a[132:135], v[48:51], v[72:87]
    v_exp_f32 v45, v45
    v_cvt_pk_bf16_f32 v53, v42, v43
    v_exp_f32 v46, v46
    v_exp_f32 v47, v47
    v_cvt_pk_bf16_f32 v54, v44, v45
    v_cvt_pk_bf16_f32 v55, v46, v47
    v_exp_f32 v16, v16
    v_exp_f32 v17, v17
    v_mfma_f32_32x32x16_bf16 v[72:87], a[136:139], v[52:55], v[72:87]
    v_exp_f32 v18, v18
    v_cvt_pk_bf16_f32 v48, v16, v17
    v_exp_f32 v19, v19
    v_exp_f32 v20, v20
    v_cvt_pk_bf16_f32 v49, v18, v19
    v_mfma_f32_32x32x16_bf16 v[32:47], a[144:147], v[96:99], 0
    ds_write_b32 v237, v220 offset:768
    v_exp_f32 v21, v21
    v_exp_f32 v22, v22
    v_cvt_pk_bf16_f32 v50, v20, v21
    v_exp_f32 v23, v23
    v_exp_f32 v24, v24
    v_cvt_pk_bf16_f32 v51, v22, v23
    v_mfma_f32_32x32x8_bf16 v[32:47], a[150:151], v[100:101], v[32:47]
    v_exp_f32 v25, v25
    v_exp_f32 v26, v26
    v_cvt_pk_bf16_f32 v52, v24, v25
    v_exp_f32 v27, v27
    v_exp_f32 v28, v28
    v_mfma_f32_32x32x16_bf16 v[72:87], a[152:155], v[48:51], v[72:87]
    v_exp_f32 v29, v29
    v_cvt_pk_bf16_f32 v53, v26, v27
    v_exp_f32 v30, v30
    v_exp_f32 v31, v31
    v_cvt_pk_bf16_f32 v54, v28, v29
    v_cvt_pk_bf16_f32 v55, v30, v31
    v_exp_f32 v32, v32
    v_exp_f32 v33, v33
    v_mfma_f32_32x32x16_bf16 v[72:87], a[156:159], v[52:55], v[72:87]
    v_exp_f32 v34, v34
    v_cvt_pk_bf16_f32 v48, v32, v33
    v_exp_f32 v35, v35
    v_exp_f32 v36, v36
    v_cvt_pk_bf16_f32 v49, v34, v35
    v_mfma_f32_32x32x16_bf16 v[16:31], a[168:171], v[96:99], 0
    v_exp_f32 v37, v37
    v_exp_f32 v38, v38
    v_cvt_pk_bf16_f32 v50, v36, v37
    v_exp_f32 v39, v39
    v_exp_f32 v40, v40
    v_cvt_pk_bf16_f32 v51, v38, v39
    v_mfma_f32_32x32x8_bf16 v[16:31], a[176:177], v[100:101], v[16:31]
    s_waitcnt lgkmcnt(0)
    s_barrier
    v_exp_f32 v41, v41
    v_exp_f32 v42, v42
    v_cvt_pk_bf16_f32 v52, v40, v41
    v_exp_f32 v43, v43
    v_exp_f32 v44, v44
    v_mfma_f32_32x32x16_bf16 v[72:87], a[160:163], v[48:51], v[72:87]
    ds_read_b32 v108, v238 offset:0
    v_exp_f32 v45, v45
    v_cvt_pk_bf16_f32 v53, v42, v43
    v_exp_f32 v46, v46
    v_exp_f32 v47, v47
    v_cvt_pk_bf16_f32 v54, v44, v45
    v_cvt_pk_bf16_f32 v55, v46, v47
    v_exp_f32 v16, v16
    v_exp_f32 v17, v17
    v_mfma_f32_32x32x16_bf16 v[72:87], a[164:167], v[52:55], v[72:87]
    ds_read_b32 v109, v238 offset:1024
    ds_read_b32 v110, v238 offset:2048
    v_exp_f32 v18, v18
    v_cvt_pk_bf16_f32 v48, v16, v17
    v_exp_f32 v19, v19
    v_exp_f32 v20, v20
    v_cvt_pk_bf16_f32 v49, v18, v19
    v_mfma_f32_32x32x16_bf16 v[32:47], a[172:175], v[96:99], 0
    ds_read_b32 v111, v238 offset:3072
    v_exp_f32 v21, v21
    v_exp_f32 v22, v22
    v_cvt_pk_bf16_f32 v50, v20, v21
    v_exp_f32 v23, v23
    v_exp_f32 v24, v24
    v_cvt_pk_bf16_f32 v51, v22, v23
    v_mfma_f32_32x32x8_bf16 v[32:47], a[178:179], v[100:101], v[32:47]
    v_exp_f32 v25, v25
    v_exp_f32 v26, v26
    v_cvt_pk_bf16_f32 v52, v24, v25
    v_exp_f32 v27, v27
    v_exp_f32 v28, v28
    v_mfma_f32_32x32x16_bf16 v[72:87], a[180:183], v[48:51], v[72:87]
    v_exp_f32 v29, v29
    v_cvt_pk_bf16_f32 v53, v26, v27
    v_exp_f32 v30, v30
    v_exp_f32 v31, v31
    v_cvt_pk_bf16_f32 v54, v28, v29
    v_cvt_pk_bf16_f32 v55, v30, v31
    v_exp_f32 v32, v32
    v_exp_f32 v33, v33
    v_mfma_f32_32x32x16_bf16 v[72:87], a[184:187], v[52:55], v[72:87]
    v_exp_f32 v34, v34
    v_cvt_pk_bf16_f32 v48, v32, v33
    v_exp_f32 v35, v35
    v_exp_f32 v36, v36
    v_cvt_pk_bf16_f32 v49, v34, v35
    v_mfma_f32_32x32x16_bf16 v[16:31], a[196:199], v[96:99], 0
    s_waitcnt lgkmcnt(0)
    v_exp_f32 v37, v37
    v_exp_f32 v38, v38
    v_cvt_pk_bf16_f32 v50, v36, v37
    v_exp_f32 v39, v39
    v_exp_f32 v40, v40
    v_cvt_pk_bf16_f32 v51, v38, v39
    v_mfma_f32_32x32x8_bf16 v[16:31], a[204:205], v[100:101], v[16:31]
    v_add_f32 v108, v108, v109
    v_add_f32 v110, v110, v111
    v_add_f32 v108, v108, v110
    v_exp_f32 v41, v41
    v_exp_f32 v42, v42
    v_cvt_pk_bf16_f32 v52, v40, v41
    v_exp_f32 v43, v43
    v_exp_f32 v44, v44
    v_mfma_f32_32x32x16_bf16 v[72:87], a[188:191], v[48:51], v[72:87]
    buffer_store_dword v108, v239, s[32:35], 0 offen offset:0 sc1
    v_exp_f32 v45, v45
    v_cvt_pk_bf16_f32 v53, v42, v43
    v_exp_f32 v46, v46
    v_exp_f32 v47, v47
    v_cvt_pk_bf16_f32 v54, v44, v45
    v_cvt_pk_bf16_f32 v55, v46, v47
    v_exp_f32 v16, v16
    v_exp_f32 v17, v17
    v_mfma_f32_32x32x16_bf16 v[72:87], a[192:195], v[52:55], v[72:87]
    v_exp_f32 v18, v18
    v_cvt_pk_bf16_f32 v48, v16, v17
    v_exp_f32 v19, v19
    v_exp_f32 v20, v20
    v_cvt_pk_bf16_f32 v49, v18, v19
    v_mfma_f32_32x32x16_bf16 v[32:47], a[200:203], v[96:99], 0
    v_exp_f32 v21, v21
    v_exp_f32 v22, v22
    v_cvt_pk_bf16_f32 v50, v20, v21
    v_exp_f32 v23, v23
    v_exp_f32 v24, v24
    v_cvt_pk_bf16_f32 v51, v22, v23
    v_mfma_f32_32x32x8_bf16 v[32:47], a[206:207], v[100:101], v[32:47]
    v_accvgpr_read_b32 v12, a229
    v_exp_f32 v25, v25
    v_exp_f32 v26, v26
    v_cvt_pk_bf16_f32 v52, v24, v25
    v_exp_f32 v27, v27
    v_exp_f32 v28, v28
    v_mfma_f32_32x32x16_bf16 v[72:87], a[208:211], v[48:51], v[72:87]
    s_mov_b64 exec, 0xffff
    s_mov_b32 s89, 4096
    buffer_load_dword v244, v12, s[32:35], s89 offen offset:0 sc1
    s_mov_b64 exec, -1
    v_exp_f32 v29, v29
    v_cvt_pk_bf16_f32 v53, v26, v27
    v_exp_f32 v30, v30
    v_exp_f32 v31, v31
    v_cvt_pk_bf16_f32 v54, v28, v29
    v_cvt_pk_bf16_f32 v55, v30, v31
    v_exp_f32 v32, v32
    v_exp_f32 v33, v33
    v_mfma_f32_32x32x16_bf16 v[72:87], a[212:215], v[52:55], v[72:87]
    v_exp_f32 v34, v34
    v_cvt_pk_bf16_f32 v48, v32, v33
    v_exp_f32 v35, v35
    v_exp_f32 v36, v36
    v_cvt_pk_bf16_f32 v49, v34, v35
    v_mfma_f32_32x32x16_bf16 v[16:31], a[0:3], v[88:91], 0
    v_exp_f32 v37, v37
    v_exp_f32 v38, v38
    v_cvt_pk_bf16_f32 v50, v36, v37
    v_exp_f32 v39, v39
    v_exp_f32 v40, v40
    v_cvt_pk_bf16_f32 v51, v38, v39
    v_mfma_f32_32x32x8_bf16 v[16:31], a[8:9], v[92:93], v[16:31]
    v_exp_f32 v41, v41
    v_exp_f32 v42, v42
    v_cvt_pk_bf16_f32 v52, v40, v41
    v_exp_f32 v43, v43
    v_exp_f32 v44, v44
    v_mfma_f32_32x32x16_bf16 v[72:87], a[216:219], v[48:51], v[72:87]
    v_exp_f32 v45, v45
    v_cvt_pk_bf16_f32 v53, v42, v43
    v_exp_f32 v46, v46
    v_exp_f32 v47, v47
    v_cvt_pk_bf16_f32 v54, v44, v45
    v_cvt_pk_bf16_f32 v55, v46, v47
    v_exp_f32 v16, v16
    v_exp_f32 v17, v17
    v_mfma_f32_32x32x16_bf16 v[72:87], a[220:223], v[52:55], v[72:87]
    s_lshl_b32 s22, s80, 1
    s_add_u32 s22, s22, 7
    v_accvgpr_read_b32 v154, a252
    v_exp_f32 v18, v18
    v_cvt_pk_bf16_f32 v48, v16, v17
    v_exp_f32 v19, v19
    v_exp_f32 v20, v20
    v_cvt_pk_bf16_f32 v49, v18, v19
    v_mfma_f32_32x32x16_bf16 v[32:47], a[4:7], v[88:91], 0
    s_and_b32 s22, s22, 7
    s_mul_i32 s23, s22, 1280
    buffer_load_dwordx2 v[246:247], v154, s[36:39], 0 offen offset:0
    v_exp_f32 v21, v21
    v_exp_f32 v22, v22
    v_cvt_pk_bf16_f32 v50, v20, v21
    v_exp_f32 v23, v23
    v_exp_f32 v24, v24
    v_cvt_pk_bf16_f32 v51, v22, v23
    v_mfma_f32_32x32x8_bf16 v[32:47], a[10:11], v[92:93], v[32:47]
    v_add_u32 v8, s23, v2
    v_add_u32 v9, s23, v3
    s_mul_i32 s23, s22, 3072
    v_exp_f32 v25, v25
    v_exp_f32 v26, v26
    v_cvt_pk_bf16_f32 v52, v24, v25
    v_exp_f32 v27, v27
    v_exp_f32 v28, v28
    v_mfma_f32_32x32x16_bf16 v[56:71], a[12:15], v[48:51], v[56:71]
    v_add_u32 v10, s23, v1
    s_add_u32 s22, s22, 6
    buffer_load_dwordx2 v[248:249], v154, s[36:39], 0 offen offset:32
    v_exp_f32 v29, v29
    v_cvt_pk_bf16_f32 v53, v26, v27
    v_exp_f32 v30, v30
    v_exp_f32 v31, v31
    v_cvt_pk_bf16_f32 v54, v28, v29
    v_cvt_pk_bf16_f32 v55, v30, v31
    v_exp_f32 v32, v32
    v_exp_f32 v33, v33
    v_mfma_f32_32x32x16_bf16 v[56:71], a[16:19], v[52:55], v[56:71]
    s_and_b32 s22, s22, 7
    s_mul_i32 s23, s22, 3072
    v_add_u32 v4, s23, v1
    v_exp_f32 v34, v34
    v_cvt_pk_bf16_f32 v48, v32, v33
    v_exp_f32 v35, v35
    v_exp_f32 v36, v36
    v_cvt_pk_bf16_f32 v49, v34, v35
    v_mfma_f32_32x32x16_bf16 v[16:31], a[28:31], v[88:91], 0
    ds_write_b128 v4, v[72:75] offset:0
    buffer_load_dwordx2 v[250:251], v154, s[36:39], 0 offen offset:64
    v_exp_f32 v37, v37
    v_exp_f32 v38, v38
    v_cvt_pk_bf16_f32 v50, v36, v37
    v_exp_f32 v39, v39
    v_exp_f32 v40, v40
    v_cvt_pk_bf16_f32 v51, v38, v39
    v_mfma_f32_32x32x8_bf16 v[16:31], a[36:37], v[92:93], v[16:31]
    ds_write_b128 v4, v[76:79] offset:1024
    buffer_load_dwordx2 v[252:253], v154, s[36:39], 0 offen offset:96
    v_exp_f32 v41, v41
    v_exp_f32 v42, v42
    v_cvt_pk_bf16_f32 v52, v40, v41
    v_exp_f32 v43, v43
    v_exp_f32 v44, v44
    v_mfma_f32_32x32x16_bf16 v[56:71], a[20:23], v[48:51], v[56:71]
    ds_write_b128 v4, v[80:83] offset:2048
    v_exp_f32 v45, v45
    v_cvt_pk_bf16_f32 v53, v42, v43
    v_exp_f32 v46, v46
    v_exp_f32 v47, v47
    v_cvt_pk_bf16_f32 v54, v44, v45
    v_cvt_pk_bf16_f32 v55, v46, v47
    v_exp_f32 v16, v16
    v_exp_f32 v17, v17
    v_mfma_f32_32x32x16_bf16 v[56:71], a[24:27], v[52:55], v[56:71]
    ds_read_b128 v[96:99], v8
    ds_read_b64 v[100:101], v9
    buffer_load_dwordx2 v[254:255], v154, s[36:39], 0 offen offset:128
    v_exp_f32 v18, v18
    v_cvt_pk_bf16_f32 v48, v16, v17
    v_exp_f32 v19, v19
    v_exp_f32 v20, v20
    v_cvt_pk_bf16_f32 v49, v18, v19
    v_mfma_f32_32x32x16_bf16 v[32:47], a[32:35], v[88:91], 0
    v_exp_f32 v21, v21
    v_exp_f32 v22, v22
    v_cvt_pk_bf16_f32 v50, v20, v21
    v_exp_f32 v23, v23
    v_exp_f32 v24, v24
    v_cvt_pk_bf16_f32 v51, v22, v23
    v_mfma_f32_32x32x8_bf16 v[32:47], a[38:39], v[92:93], v[32:47]
    v_exp_f32 v25, v25
    v_exp_f32 v26, v26
    v_cvt_pk_bf16_f32 v52, v24, v25
    v_exp_f32 v27, v27
    v_exp_f32 v28, v28
    v_mfma_f32_32x32x16_bf16 v[56:71], a[40:43], v[48:51], v[56:71]
    v_exp_f32 v29, v29
    v_cvt_pk_bf16_f32 v53, v26, v27
    v_exp_f32 v30, v30
    v_exp_f32 v31, v31
    v_cvt_pk_bf16_f32 v54, v28, v29
    v_cvt_pk_bf16_f32 v55, v30, v31
    v_exp_f32 v32, v32
    v_exp_f32 v33, v33
    v_mfma_f32_32x32x16_bf16 v[56:71], a[44:47], v[52:55], v[56:71]
    s_waitcnt vmcnt(6)
    s_waitcnt lgkmcnt(0)
    s_barrier
    v_exp_f32 v34, v34
    v_cvt_pk_bf16_f32 v48, v32, v33
    v_exp_f32 v35, v35
    v_exp_f32 v36, v36
    v_cvt_pk_bf16_f32 v49, v34, v35
    v_mfma_f32_32x32x16_bf16 v[16:31], a[56:59], v[88:91], 0
    ds_read_b128 v[72:75], v10
    s_lshl_b32 s3, s83, 7
    v_exp_f32 v37, v37
    v_exp_f32 v38, v38
    v_cvt_pk_bf16_f32 v50, v36, v37
    v_exp_f32 v39, v39
    v_exp_f32 v40, v40
    v_cvt_pk_bf16_f32 v51, v38, v39
    v_mfma_f32_32x32x8_bf16 v[16:31], a[64:65], v[92:93], v[16:31]
    ds_read_b128 v[76:79], v10 offset:1024
    s_add_u32 s3, s3, 32768
    v_exp_f32 v41, v41
    v_exp_f32 v42, v42
    v_cvt_pk_bf16_f32 v52, v40, v41
    v_exp_f32 v43, v43
    v_exp_f32 v44, v44
    v_mfma_f32_32x32x16_bf16 v[56:71], a[48:51], v[48:51], v[56:71]
    ds_read_b128 v[80:83], v10 offset:2048
    s_cmp_eq_u32 s80, 0
    s_cselect_b32 s3, s3, 2130706432
    v_exp_f32 v45, v45
    v_cvt_pk_bf16_f32 v53, v42, v43
    v_exp_f32 v46, v46
    v_exp_f32 v47, v47
    v_cvt_pk_bf16_f32 v54, v44, v45
    v_cvt_pk_bf16_f32 v55, v46, v47
    v_exp_f32 v16, v16
    v_exp_f32 v17, v17
    v_mfma_f32_32x32x16_bf16 v[56:71], a[52:55], v[52:55], v[56:71]
    v_mov_b32 v14, s3
    v_exp_f32 v18, v18
    v_cvt_pk_bf16_f32 v48, v16, v17
    v_exp_f32 v19, v19
    v_exp_f32 v20, v20
    v_cvt_pk_bf16_f32 v49, v18, v19
    v_mfma_f32_32x32x16_bf16 v[32:47], a[60:63], v[88:91], 0
    v_mov_b32 v15, s84
    v_exp_f32 v21, v21
    v_exp_f32 v22, v22
    v_cvt_pk_bf16_f32 v50, v20, v21
    v_exp_f32 v23, v23
    v_exp_f32 v24, v24
    v_cvt_pk_bf16_f32 v51, v22, v23
    v_mfma_f32_32x32x8_bf16 v[32:47], a[66:67], v[92:93], v[32:47]
    s_mov_b64 exec, 1
    buffer_store_dword v15, v14, s[32:35], 0 offen sc1
    s_mov_b64 exec, -1
    v_exp_f32 v25, v25
    v_exp_f32 v26, v26
    v_cvt_pk_bf16_f32 v52, v24, v25
    v_exp_f32 v27, v27
    v_exp_f32 v28, v28
    v_mfma_f32_32x32x16_bf16 v[56:71], a[68:71], v[48:51], v[56:71]
    v_exp_f32 v29, v29
    v_cvt_pk_bf16_f32 v53, v26, v27
    v_exp_f32 v30, v30
    v_exp_f32 v31, v31
    v_cvt_pk_bf16_f32 v54, v28, v29
    v_cvt_pk_bf16_f32 v55, v30, v31
    v_exp_f32 v32, v32
    v_exp_f32 v33, v33
    v_mfma_f32_32x32x16_bf16 v[56:71], a[72:75], v[52:55], v[56:71]
    s_add_u32 s27, s40, 0
    s_add_u32 m0, s98, 0
    s_nop 0
    buffer_load_dwordx4 v13, s[32:35], s27 offen sc1 lds
    v_exp_f32 v34, v34
    v_cvt_pk_bf16_f32 v48, v32, v33
    v_exp_f32 v35, v35
    v_exp_f32 v36, v36
    v_cvt_pk_bf16_f32 v49, v34, v35
    v_mfma_f32_32x32x16_bf16 v[16:31], a[84:87], v[88:91], 0
    v_exp_f32 v37, v37
    v_exp_f32 v38, v38
    v_cvt_pk_bf16_f32 v50, v36, v37
    v_exp_f32 v39, v39
    v_exp_f32 v40, v40
    v_cvt_pk_bf16_f32 v51, v38, v39
    v_mfma_f32_32x32x8_bf16 v[16:31], a[92:93], v[92:93], v[16:31]
    v_accvgpr_read_b32 v12, a229
    v_exp_f32 v41, v41
    v_exp_f32 v42, v42
    v_cvt_pk_bf16_f32 v52, v40, v41
    v_exp_f32 v43, v43
    v_exp_f32 v44, v44
    v_mfma_f32_32x32x16_bf16 v[56:71], a[76:79], v[48:51], v[56:71]
    s_mov_b64 exec, 0xffff
    buffer_load_dword v244, v12, s[32:35], s89 offen offset:2048 sc1
    s_mov_b64 exec, -1
    v_exp_f32 v45, v45
    v_cvt_pk_bf16_f32 v53, v42, v43
    v_exp_f32 v46, v46
    v_exp_f32 v47, v47
    v_cvt_pk_bf16_f32 v54, v44, v45
    v_cvt_pk_bf16_f32 v55, v46, v47
    v_exp_f32 v16, v16
    v_exp_f32 v17, v17
    v_mfma_f32_32x32x16_bf16 v[56:71], a[80:83], v[52:55], v[56:71]
    s_add_u32 s27, s40, 1024
    s_add_u32 m0, s98, 1024
    s_nop 0
    buffer_load_dwordx4 v13, s[32:35], s27 offen sc1 lds
    v_exp_f32 v18, v18
    v_cvt_pk_bf16_f32 v48, v16, v17
    v_exp_f32 v19, v19
    v_exp_f32 v20, v20
    v_cvt_pk_bf16_f32 v49, v18, v19
    v_mfma_f32_32x32x16_bf16 v[32:47], a[88:91], v[88:91], 0
    v_exp_f32 v21, v21
    v_exp_f32 v22, v22
    v_cvt_pk_bf16_f32 v50, v20, v21
    v_exp_f32 v23, v23
    v_exp_f32 v24, v24
    v_cvt_pk_bf16_f32 v51, v22, v23
    v_mfma_f32_32x32x8_bf16 v[32:47], a[94:95], v[92:93], v[32:47]
    v_exp_f32 v25, v25
    v_exp_f32 v26, v26
    v_cvt_pk_bf16_f32 v52, v24, v25
    v_exp_f32 v27, v27
    v_exp_f32 v28, v28
    v_mfma_f32_32x32x16_bf16 v[56:71], a[96:99], v[48:51], v[56:71]
    v_exp_f32 v29, v29
    v_cvt_pk_bf16_f32 v53, v26, v27
    v_exp_f32 v30, v30
    v_exp_f32 v31, v31
    v_cvt_pk_bf16_f32 v54, v28, v29
    v_cvt_pk_bf16_f32 v55, v30, v31
    v_exp_f32 v32, v32
    v_exp_f32 v33, v33
    v_mfma_f32_32x32x16_bf16 v[56:71], a[100:103], v[52:55], v[56:71]
    s_add_u32 s27, s40, 2048
    s_add_u32 m0, s98, 2048
    s_nop 0
    buffer_load_dwordx4 v13, s[32:35], s27 offen sc1 lds
    v_exp_f32 v34, v34
    v_cvt_pk_bf16_f32 v48, v32, v33
    v_exp_f32 v35, v35
    v_exp_f32 v36, v36
    v_cvt_pk_bf16_f32 v49, v34, v35
    v_mfma_f32_32x32x16_bf16 v[16:31], a[112:115], v[88:91], 0
    v_exp_f32 v37, v37
    v_exp_f32 v38, v38
    v_cvt_pk_bf16_f32 v50, v36, v37
    v_exp_f32 v39, v39
    v_exp_f32 v40, v40
    v_cvt_pk_bf16_f32 v51, v38, v39
    v_mfma_f32_32x32x8_bf16 v[16:31], a[120:121], v[92:93], v[16:31]
    s_add_u32 s30, s80, 3
    v_exp_f32 v41, v41
    v_exp_f32 v42, v42
    v_cvt_pk_bf16_f32 v52, v40, v41
    v_exp_f32 v43, v43
    v_exp_f32 v44, v44
    v_mfma_f32_32x32x16_bf16 v[56:71], a[104:107], v[48:51], v[56:71]
    s_and_b32 s30, s30, 3
    v_exp_f32 v45, v45
    v_cvt_pk_bf16_f32 v53, v42, v43
    v_exp_f32 v46, v46
    v_exp_f32 v47, v47
    v_cvt_pk_bf16_f32 v54, v44, v45
    v_cvt_pk_bf16_f32 v55, v46, v47
    v_exp_f32 v16, v16
    v_exp_f32 v17, v17
    v_mfma_f32_32x32x16_bf16 v[56:71], a[108:111], v[52:55], v[56:71]
    s_and_b32 s28, s30, 1
    v_exp_f32 v18, v18
    v_cvt_pk_bf16_f32 v48, v16, v17
    v_exp_f32 v19, v19
    v_exp_f32 v20, v20
    v_cvt_pk_bf16_f32 v49, v18, v19
    v_mfma_f32_32x32x16_bf16 v[32:47], a[116:119], v[88:91], 0
    s_add_u32 s27, s40, 3072
    s_add_u32 m0, s98, 3072
    s_nop 0
    buffer_load_dwordx4 v13, s[32:35], s27 offen sc1 lds
    s_lshr_b32 s29, s30, 1
    v_exp_f32 v21, v21
    v_exp_f32 v22, v22
    v_cvt_pk_bf16_f32 v50, v20, v21
    v_exp_f32 v23, v23
    v_exp_f32 v24, v24
    v_cvt_pk_bf16_f32 v51, v22, v23
    v_mfma_f32_32x32x8_bf16 v[32:47], a[122:123], v[92:93], v[32:47]
    s_mul_i32 s30, s30, 24576
    v_exp_f32 v25, v25
    v_exp_f32 v26, v26
    v_cvt_pk_bf16_f32 v52, v24, v25
    v_exp_f32 v27, v27
    v_exp_f32 v28, v28
    v_mfma_f32_32x32x16_bf16 v[56:71], a[124:127], v[48:51], v[56:71]
    v_add_u32 v5, s30, v1
    v_exp_f32 v29, v29
    v_cvt_pk_bf16_f32 v53, v26, v27
    v_exp_f32 v30, v30
    v_exp_f32 v31, v31
    v_cvt_pk_bf16_f32 v54, v28, v29
    v_cvt_pk_bf16_f32 v55, v30, v31
    v_exp_f32 v32, v32
    v_exp_f32 v33, v33
    v_mfma_f32_32x32x16_bf16 v[56:71], a[128:131], v[52:55], v[56:71]
    s_mul_i32 s30, s81, 81920
    v_exp_f32 v34, v34
    v_cvt_pk_bf16_f32 v48, v32, v33
    v_exp_f32 v35, v35
    v_exp_f32 v36, v36
    v_cvt_pk_bf16_f32 v49, v34, v35
    v_mfma_f32_32x32x16_bf16 v[16:31], a[140:143], v[88:91], 0
    s_add_u32 s27, s40, 4096
    s_add_u32 m0, s98, 4096
    s_nop 0
    buffer_load_dwordx4 v13, s[32:35], s27 offen sc1 lds
    s_mul_i32 s29, s29, 40960
    v_exp_f32 v37, v37
    v_exp_f32 v38, v38
    v_cvt_pk_bf16_f32 v50, v36, v37
    v_exp_f32 v39, v39
    v_exp_f32 v40, v40
    v_cvt_pk_bf16_f32 v51, v38, v39
    v_mfma_f32_32x32x8_bf16 v[16:31], a[148:149], v[92:93], v[16:31]
    s_add_u32 s30, s30, s29
    v_exp_f32 v41, v41
    v_exp_f32 v42, v42
    v_cvt_pk_bf16_f32 v52, v40, v41
    v_exp_f32 v43, v43
    v_exp_f32 v44, v44
    v_mfma_f32_32x32x16_bf16 v[56:71], a[132:135], v[48:51], v[56:71]
    s_add_u32 s30, s30, 1048576
    v_exp_f32 v45, v45
    v_cvt_pk_bf16_f32 v53, v42, v43
    v_exp_f32 v46, v46
    v_exp_f32 v47, v47
    v_cvt_pk_bf16_f32 v54, v44, v45
    v_cvt_pk_bf16_f32 v55, v46, v47
    v_exp_f32 v16, v16
    v_exp_f32 v17, v17
    v_mfma_f32_32x32x16_bf16 v[56:71], a[136:139], v[52:55], v[56:71]
    v_and_b32 v12, 15, v0
    v_exp_f32 v18, v18
    v_cvt_pk_bf16_f32 v48, v16, v17
    v_exp_f32 v19, v19
    v_exp_f32 v20, v20
    v_cvt_pk_bf16_f32 v49, v18, v19
    v_mfma_f32_32x32x16_bf16 v[32:47], a[144:147], v[88:91], 0
    v_lshlrev_b32 v12, 4, v12
    v_exp_f32 v21, v21
    v_exp_f32 v22, v22
    v_cvt_pk_bf16_f32 v50, v20, v21
    v_exp_f32 v23, v23
    v_exp_f32 v24, v24
    v_cvt_pk_bf16_f32 v51, v22, v23
    v_mfma_f32_32x32x8_bf16 v[32:47], a[150:151], v[92:93], v[32:47]
    s_add_u32 s27, s41, 0
    s_add_u32 m0, s98, 5120
    s_nop 0
    buffer_load_dwordx4 v13, s[32:35], s27 offen sc1 lds
    v_bfe_u32 v245, v0, 4, 1
    v_exp_f32 v25, v25
    v_exp_f32 v26, v26
    v_cvt_pk_bf16_f32 v52, v24, v25
    v_exp_f32 v27, v27
    v_exp_f32 v28, v28
    v_mfma_f32_32x32x16_bf16 v[56:71], a[152:155], v[48:51], v[56:71]
    v_mul_u32_u24 v245, 20480, v245
    v_exp_f32 v29, v29
    v_cvt_pk_bf16_f32 v53, v26, v27
    v_exp_f32 v30, v30
    v_exp_f32 v31, v31
    v_cvt_pk_bf16_f32 v54, v28, v29
    v_cvt_pk_bf16_f32 v55, v30, v31
    v_exp_f32 v32, v32
    v_exp_f32 v33, v33
    v_mfma_f32_32x32x16_bf16 v[56:71], a[156:159], v[52:55], v[56:71]
    v_add3_u32 v12, v12, v245, s30
    v_exp_f32 v34, v34
    v_cvt_pk_bf16_f32 v48, v32, v33
    v_exp_f32 v35, v35
    v_exp_f32 v36, v36
    v_cvt_pk_bf16_f32 v49, v34, v35
    v_mfma_f32_32x32x16_bf16 v[16:31], a[168:171], v[88:91], 0
    v_lshrrev_b32 v245, 5, v0
    v_exp_f32 v37, v37
    v_exp_f32 v38, v38
    v_cvt_pk_bf16_f32 v50, v36, v37
    v_exp_f32 v39, v39
    v_exp_f32 v40, v40
    v_cvt_pk_bf16_f32 v51, v38, v39
    v_mfma_f32_32x32x8_bf16 v[16:31], a[176:177], v[92:93], v[16:31]
    s_add_u32 s27, s41, 1024
    s_add_u32 m0, s98, 6144
    s_nop 0
    buffer_load_dwordx4 v13, s[32:35], s27 offen sc1 lds
    s_lshl_b32 s29, s82, 1
    v_exp_f32 v41, v41
    v_exp_f32 v42, v42
    v_cvt_pk_bf16_f32 v52, v40, v41
    v_exp_f32 v43, v43
    v_exp_f32 v44, v44
    v_mfma_f32_32x32x16_bf16 v[56:71], a[160:163], v[48:51], v[56:71]
    s_add_u32 s29, s29, s28
    v_exp_f32 v45, v45
    v_cvt_pk_bf16_f32 v53, v42, v43
    v_exp_f32 v46, v46
    v_exp_f32 v47, v47
    v_cvt_pk_bf16_f32 v54, v44, v45
    v_cvt_pk_bf16_f32 v55, v46, v47
    v_exp_f32 v16, v16
    v_exp_f32 v17, v17
    v_mfma_f32_32x32x16_bf16 v[56:71], a[164:167], v[52:55], v[56:71]
    s_lshl_b32 s29, s29, 9
    v_exp_f32 v18, v18
    v_cvt_pk_bf16_f32 v48, v16, v17
    v_exp_f32 v19, v19
    v_exp_f32 v20, v20
    v_cvt_pk_bf16_f32 v49, v18, v19
    v_mfma_f32_32x32x16_bf16 v[32:47], a[172:175], v[88:91], 0
    v_lshl_add_u32 v6, v245, 8, v12
    v_exp_f32 v21, v21
    v_exp_f32 v22, v22
    v_cvt_pk_bf16_f32 v50, v20, v21
    v_exp_f32 v23, v23
    v_exp_f32 v24, v24
    v_cvt_pk_bf16_f32 v51, v22, v23
    v_mfma_f32_32x32x8_bf16 v[32:47], a[178:179], v[92:93], v[32:47]
    s_add_u32 s27, s41, 2048
    s_add_u32 m0, s98, 7168
    s_nop 0
    buffer_load_dwordx4 v13, s[32:35], s27 offen sc1 lds
    v_add_u32 v6, s29, v6
    v_exp_f32 v25, v25
    v_exp_f32 v26, v26
    v_cvt_pk_bf16_f32 v52, v24, v25
    v_exp_f32 v27, v27
    v_exp_f32 v28, v28
    v_mfma_f32_32x32x16_bf16 v[56:71], a[180:183], v[48:51], v[56:71]
    s_lshl_b32 s29, s82, 1
    v_exp_f32 v29, v29
    v_cvt_pk_bf16_f32 v53, v26, v27
    v_exp_f32 v30, v30
    v_exp_f32 v31, v31
    v_cvt_pk_bf16_f32 v54, v28, v29
    v_cvt_pk_bf16_f32 v55, v30, v31
    v_exp_f32 v32, v32
    v_exp_f32 v33, v33
    v_mfma_f32_32x32x16_bf16 v[56:71], a[184:187], v[52:55], v[56:71]
    s_add_u32 s29, s29, s28
    v_exp_f32 v34, v34
    v_cvt_pk_bf16_f32 v48, v32, v33
    v_exp_f32 v35, v35
    v_exp_f32 v36, v36
    v_cvt_pk_bf16_f32 v49, v34, v35
    v_mfma_f32_32x32x16_bf16 v[16:31], a[196:199], v[88:91], 0
    s_lshl_b32 s29, s29, 8
    v_exp_f32 v37, v37
    v_exp_f32 v38, v38
    v_cvt_pk_bf16_f32 v50, v36, v37
    v_exp_f32 v39, v39
    v_exp_f32 v40, v40
    v_cvt_pk_bf16_f32 v51, v38, v39
    v_mfma_f32_32x32x8_bf16 v[16:31], a[204:205], v[92:93], v[16:31]
    s_add_u32 s29, s29, 16384
    v_exp_f32 v41, v41
    v_exp_f32 v42, v42
    v_cvt_pk_bf16_f32 v52, v40, v41
    v_exp_f32 v43, v43
    v_exp_f32 v44, v44
    v_mfma_f32_32x32x16_bf16 v[56:71], a[188:191], v[48:51], v[56:71]
    s_add_u32 s27, s41, 3072
    s_add_u32 m0, s98, 8192
    s_nop 0
    buffer_load_dwordx4 v13, s[32:35], s27 offen sc1 lds
    v_lshl_add_u32 v7, v245, 30, v12
    v_exp_f32 v45, v45
    v_cvt_pk_bf16_f32 v53, v42, v43
    v_exp_f32 v46, v46
    v_exp_f32 v47, v47
    v_cvt_pk_bf16_f32 v54, v44, v45
    v_cvt_pk_bf16_f32 v55, v46, v47
    v_exp_f32 v16, v16
    v_exp_f32 v17, v17
    v_mfma_f32_32x32x16_bf16 v[56:71], a[192:195], v[52:55], v[56:71]
    v_add_u32 v7, s29, v7
    v_exp_f32 v18, v18
    v_cvt_pk_bf16_f32 v48, v16, v17
    v_exp_f32 v19, v19
    v_exp_f32 v20, v20
    v_cvt_pk_bf16_f32 v49, v18, v19
    v_mfma_f32_32x32x16_bf16 v[32:47], a[200:203], v[88:91], 0
    s_lshl_b32 s29, s82, 2
    v_exp_f32 v21, v21
    v_exp_f32 v22, v22
    v_cvt_pk_bf16_f32 v50, v20, v21
    v_exp_f32 v23, v23
    v_exp_f32 v24, v24
    v_cvt_pk_bf16_f32 v51, v22, v23
    v_mfma_f32_32x32x8_bf16 v[32:47], a[206:207], v[92:93], v[32:47]
    s_add_u32 s29, s29, s80
    v_exp_f32 v25, v25
    v_exp_f32 v26, v26
    v_cvt_pk_bf16_f32 v52, v24, v25
    v_exp_f32 v27, v27
    v_exp_f32 v28, v28
    v_mfma_f32_32x32x16_bf16 v[56:71], a[208:211], v[48:51], v[56:71]
    s_add_u32 s27, s41, 4096
    s_add_u32 m0, s98, 9216
    s_nop 0
    buffer_load_dwordx4 v13, s[32:35], s27 offen sc1 lds
    s_mul_i32 s29, s29, 122880
    v_exp_f32 v29, v29
    v_cvt_pk_bf16_f32 v53, v26, v27
    v_exp_f32 v30, v30
    v_exp_f32 v31, v31
    v_cvt_pk_bf16_f32 v54, v28, v29
    v_cvt_pk_bf16_f32 v55, v30, v31
    v_exp_f32 v32, v32
    v_exp_f32 v33, v33
    v_mfma_f32_32x32x16_bf16 v[56:71], a[212:215], v[52:55], v[56:71]
    s_add_u32 s29, s29, 18874368
    v_exp_f32 v34, v34
    v_cvt_pk_bf16_f32 v48, v32, v33
    v_exp_f32 v35, v35
    v_exp_f32 v36, v36
    v_cvt_pk_bf16_f32 v49, v34, v35
    s_waitcnt lgkmcnt(0)
    v_mfma_f32_32x32x16_bf16 v[16:31], a[0:3], v[96:99], 0
    v_add_u32 v11, s29, v1
    v_exp_f32 v37, v37
    v_exp_f32 v38, v38
    v_cvt_pk_bf16_f32 v50, v36, v37
    v_exp_f32 v39, v39
    v_exp_f32 v40, v40
    v_cvt_pk_bf16_f32 v51, v38, v39
    v_mfma_f32_32x32x8_bf16 v[16:31], a[8:9], v[100:101], v[16:31]
    v_exp_f32 v41, v41
    v_exp_f32 v42, v42
    v_cvt_pk_bf16_f32 v52, v40, v41
    v_exp_f32 v43, v43
    v_exp_f32 v44, v44
    v_mfma_f32_32x32x16_bf16 v[56:71], a[216:219], v[48:51], v[56:71]
    v_exp_f32 v45, v45
    v_cvt_pk_bf16_f32 v53, v42, v43
    v_exp_f32 v46, v46
    v_exp_f32 v47, v47
    v_cvt_pk_bf16_f32 v54, v44, v45
    v_cvt_pk_bf16_f32 v55, v46, v47
    v_exp_f32 v16, v16
    v_exp_f32 v17, v17
    v_mfma_f32_32x32x16_bf16 v[56:71], a[220:223], v[52:55], v[56:71]
    s_lshl_b32 s22, s80, 1
    s_add_u32 s22, s22, 8
    v_accvgpr_read_b32 v12, a229
    s_add_u32 s27, s42, 0
    s_add_u32 m0, s98, 10240
    s_nop 0
    buffer_load_dwordx4 v13, s[32:35], s27 offen sc1 lds
    v_exp_f32 v18, v18
    v_cvt_pk_bf16_f32 v48, v16, v17
    v_exp_f32 v19, v19
    v_exp_f32 v20, v20
    v_cvt_pk_bf16_f32 v49, v18, v19
    v_mfma_f32_32x32x16_bf16 v[32:47], a[4:7], v[96:99], 0
    s_and_b32 s22, s22, 7
    s_mul_i32 s23, s22, 1280
    s_mov_b64 exec, 0xffff
    s_mov_b32 s89, 8192
    buffer_load_dword v244, v12, s[32:35], s89 offen offset:0 sc1
    s_mov_b64 exec, -1
    v_exp_f32 v21, v21
    v_exp_f32 v22, v22
    v_cvt_pk_bf16_f32 v50, v20, v21
    v_exp_f32 v23, v23
    v_exp_f32 v24, v24
    v_cvt_pk_bf16_f32 v51, v22, v23
    v_mfma_f32_32x32x8_bf16 v[32:47], a[10:11], v[100:101], v[32:47]
    v_add_u32 v8, s23, v2
    v_add_u32 v9, s23, v3
    s_mul_i32 s23, s22, 3072
    v_exp_f32 v25, v25
    v_exp_f32 v26, v26
    v_cvt_pk_bf16_f32 v52, v24, v25
    v_exp_f32 v27, v27
    v_exp_f32 v28, v28
    v_mfma_f32_32x32x16_bf16 v[72:87], a[12:15], v[48:51], v[72:87]
    v_add_u32 v10, s23, v1
    s_add_u32 s22, s22, 6
    s_add_u32 s27, s42, 1024
    s_add_u32 m0, s98, 11264
    s_nop 0
    buffer_load_dwordx4 v13, s[32:35], s27 offen sc1 lds
    v_exp_f32 v29, v29
    v_cvt_pk_bf16_f32 v53, v26, v27
    v_exp_f32 v30, v30
    v_exp_f32 v31, v31
    v_cvt_pk_bf16_f32 v54, v28, v29
    v_cvt_pk_bf16_f32 v55, v30, v31
    v_exp_f32 v32, v32
    v_exp_f32 v33, v33
    v_mfma_f32_32x32x16_bf16 v[72:87], a[16:19], v[52:55], v[72:87]
    s_and_b32 s22, s22, 7
    s_mul_i32 s23, s22, 3072
    v_add_u32 v4, s23, v1
    v_exp_f32 v34, v34
    v_cvt_pk_bf16_f32 v48, v32, v33
    v_exp_f32 v35, v35
    v_exp_f32 v36, v36
    v_cvt_pk_bf16_f32 v49, v34, v35
    v_mfma_f32_32x32x16_bf16 v[16:31], a[28:31], v[96:99], 0
    v_exp_f32 v37, v37
    v_exp_f32 v38, v38
    v_cvt_pk_bf16_f32 v50, v36, v37
    v_exp_f32 v39, v39
    v_exp_f32 v40, v40
    v_cvt_pk_bf16_f32 v51, v38, v39
    v_mfma_f32_32x32x8_bf16 v[16:31], a[36:37], v[100:101], v[16:31]
    s_add_u32 s27, s42, 2048
    s_add_u32 m0, s98, 12288
    s_nop 0
    buffer_load_dwordx4 v13, s[32:35], s27 offen sc1 lds
    v_exp_f32 v41, v41
    v_exp_f32 v42, v42
    v_cvt_pk_bf16_f32 v52, v40, v41
    v_exp_f32 v43, v43
    v_exp_f32 v44, v44
    v_mfma_f32_32x32x16_bf16 v[72:87], a[20:23], v[48:51], v[72:87]
    v_exp_f32 v45, v45
    v_cvt_pk_bf16_f32 v53, v42, v43
    v_exp_f32 v46, v46
    v_exp_f32 v47, v47
    v_cvt_pk_bf16_f32 v54, v44, v45
    v_cvt_pk_bf16_f32 v55, v46, v47
    v_exp_f32 v16, v16
    v_exp_f32 v17, v17
    v_mfma_f32_32x32x16_bf16 v[72:87], a[24:27], v[52:55], v[72:87]
    ds_read_b128 v[88:91], v8
    ds_read_b64 v[92:93], v9
    v_exp_f32 v18, v18
    v_cvt_pk_bf16_f32 v48, v16, v17
    v_exp_f32 v19, v19
    v_exp_f32 v20, v20
    v_cvt_pk_bf16_f32 v49, v18, v19
    v_mfma_f32_32x32x16_bf16 v[32:47], a[32:35], v[96:99], 0
    s_add_u32 s27, s42, 3072
    s_add_u32 m0, s98, 13312
    s_nop 0
    buffer_load_dwordx4 v13, s[32:35], s27 offen sc1 lds
    v_mov_b32 v222, v64
    v_exp_f32 v21, v21
    v_exp_f32 v22, v22
    v_cvt_pk_bf16_f32 v50, v20, v21
    v_exp_f32 v23, v23
    v_exp_f32 v24, v24
    v_cvt_pk_bf16_f32 v51, v22, v23
    v_mfma_f32_32x32x8_bf16 v[32:47], a[38:39], v[100:101], v[32:47]
    v_mov_b32 v216, v64
    v_exp_f32 v25, v25
    v_exp_f32 v26, v26
    v_cvt_pk_bf16_f32 v52, v24, v25
    v_exp_f32 v27, v27
    v_exp_f32 v28, v28
    v_mfma_f32_32x32x16_bf16 v[72:87], a[40:43], v[48:51], v[72:87]
    v_permlane32_swap_b32 v222, v216
    v_exp_f32 v29, v29
    v_cvt_pk_bf16_f32 v53, v26, v27
    v_exp_f32 v30, v30
    v_exp_f32 v31, v31
    v_cvt_pk_bf16_f32 v54, v28, v29
    v_cvt_pk_bf16_f32 v55, v30, v31
    v_exp_f32 v32, v32
    v_exp_f32 v33, v33
    v_mfma_f32_32x32x16_bf16 v[72:87], a[44:47], v[52:55], v[72:87]
    s_add_u32 s27, s42, 4096
    s_add_u32 m0, s98, 14336
    s_nop 0
    buffer_load_dwordx4 v13, s[32:35], s27 offen sc1 lds
    v_rcp_f32 v214, v216
    v_exp_f32 v34, v34
    v_cvt_pk_bf16_f32 v48, v32, v33
    v_exp_f32 v35, v35
    v_exp_f32 v36, v36
    v_cvt_pk_bf16_f32 v49, v34, v35
    v_mfma_f32_32x32x16_bf16 v[16:31], a[56:59], v[96:99], 0
    v_mul_f32 v204, v214, v56
    v_mul_f32 v205, v214, v57
    v_exp_f32 v37, v37
    v_exp_f32 v38, v38
    v_cvt_pk_bf16_f32 v50, v36, v37
    v_exp_f32 v39, v39
    v_exp_f32 v40, v40
    v_cvt_pk_bf16_f32 v51, v38, v39
    v_mfma_f32_32x32x8_bf16 v[16:31], a[64:65], v[100:101], v[16:31]
    v_mul_f32 v206, v214, v58
    v_mul_f32 v207, v214, v59
    v_exp_f32 v41, v41
    v_exp_f32 v42, v42
    v_cvt_pk_bf16_f32 v52, v40, v41
    v_exp_f32 v43, v43
    v_exp_f32 v44, v44
    v_mfma_f32_32x32x16_bf16 v[72:87], a[48:51], v[48:51], v[72:87]
    v_mul_f32 v208, v214, v60
    v_mul_f32 v209, v214, v61
    v_exp_f32 v45, v45
    v_cvt_pk_bf16_f32 v53, v42, v43
    v_exp_f32 v46, v46
    v_exp_f32 v47, v47
    v_cvt_pk_bf16_f32 v54, v44, v45
    v_cvt_pk_bf16_f32 v55, v46, v47
    v_exp_f32 v16, v16
    v_exp_f32 v17, v17
    v_mfma_f32_32x32x16_bf16 v[72:87], a[52:55], v[52:55], v[72:87]
    s_add_u32 s27, s43, 0
    s_add_u32 m0, s98, 15360
    s_nop 0
    buffer_load_dwordx4 v13, s[32:35], s27 offen sc1 lds
    v_mul_f32 v210, v214, v62
    v_mul_f32 v211, v214, v63
    v_exp_f32 v18, v18
    v_cvt_pk_bf16_f32 v48, v16, v17
    v_exp_f32 v19, v19
    v_exp_f32 v20, v20
    v_cvt_pk_bf16_f32 v49, v18, v19
    v_mfma_f32_32x32x16_bf16 v[32:47], a[60:63], v[96:99], 0
    v_cvt_pk_bf16_f32 v204, v204, v205
    v_exp_f32 v21, v21
    v_exp_f32 v22, v22
    v_cvt_pk_bf16_f32 v50, v20, v21
    v_exp_f32 v23, v23
    v_exp_f32 v24, v24
    v_cvt_pk_bf16_f32 v51, v22, v23
    v_mfma_f32_32x32x8_bf16 v[32:47], a[66:67], v[100:101], v[32:47]
    v_cvt_pk_bf16_f32 v205, v206, v207
    v_exp_f32 v25, v25
    v_exp_f32 v26, v26
    v_cvt_pk_bf16_f32 v52, v24, v25
    v_exp_f32 v27, v27
    v_exp_f32 v28, v28
    v_mfma_f32_32x32x16_bf16 v[72:87], a[68:71], v[48:51], v[72:87]
    s_add_u32 s27, s43, 1024
    s_add_u32 m0, s98, 16384
    s_nop 0
    buffer_load_dwordx4 v13, s[32:35], s27 offen sc1 lds
    v_cvt_pk_bf16_f32 v206, v208, v209
    v_exp_f32 v29, v29
    v_cvt_pk_bf16_f32 v53, v26, v27
    v_exp_f32 v30, v30
    v_exp_f32 v31, v31
    v_cvt_pk_bf16_f32 v54, v28, v29
    v_cvt_pk_bf16_f32 v55, v30, v31
    v_exp_f32 v32, v32
    v_exp_f32 v33, v33
    v_mfma_f32_32x32x16_bf16 v[72:87], a[72:75], v[52:55], v[72:87]
    v_cvt_pk_bf16_f32 v207, v210, v211
    v_exp_f32 v34, v34
    v_cvt_pk_bf16_f32 v48, v32, v33
    v_exp_f32 v35, v35
    v_exp_f32 v36, v36
    v_cvt_pk_bf16_f32 v49, v34, v35
    v_mfma_f32_32x32x16_bf16 v[16:31], a[84:87], v[96:99], 0
    buffer_store_dwordx4 v[204:207], v6, s[32:35], 0 offen offset:0 sc1
    v_exp_f32 v37, v37
    v_exp_f32 v38, v38
    v_cvt_pk_bf16_f32 v50, v36, v37
    v_exp_f32 v39, v39
    v_exp_f32 v40, v40
    v_cvt_pk_bf16_f32 v51, v38, v39
    v_mfma_f32_32x32x8_bf16 v[16:31], a[92:93], v[100:101], v[16:31]
    s_add_u32 s27, s43, 2048
    s_add_u32 m0, s98, 17408
    s_nop 0
    buffer_load_dwordx4 v13, s[32:35], s27 offen sc1 lds
    v_mul_f32 v208, v214, v64
    v_mul_f32 v209, v214, v65
    v_exp_f32 v41, v41
    v_exp_f32 v42, v42
    v_cvt_pk_bf16_f32 v52, v40, v41
    v_exp_f32 v43, v43
    v_exp_f32 v44, v44
    v_mfma_f32_32x32x16_bf16 v[72:87], a[76:79], v[48:51], v[72:87]
    v_mul_f32 v210, v214, v66
    v_mul_f32 v211, v214, v67
    v_exp_f32 v45, v45
    v_cvt_pk_bf16_f32 v53, v42, v43
    v_exp_f32 v46, v46
    v_exp_f32 v47, v47
    v_cvt_pk_bf16_f32 v54, v44, v45
    v_cvt_pk_bf16_f32 v55, v46, v47
    v_exp_f32 v16, v16
    v_exp_f32 v17, v17
    v_mfma_f32_32x32x16_bf16 v[72:87], a[80:83], v[52:55], v[72:87]
    v_cvt_pk_bf16_f32 v224, v208, v209
    v_exp_f32 v18, v18
    v_cvt_pk_bf16_f32 v48, v16, v17
    v_exp_f32 v19, v19
    v_exp_f32 v20, v20
    v_cvt_pk_bf16_f32 v49, v18, v19
    v_mfma_f32_32x32x16_bf16 v[32:47], a[88:91], v[96:99], 0
    s_add_u32 s27, s43, 3072
    s_add_u32 m0, s98, 18432
    s_nop 0
    buffer_load_dwordx4 v13, s[32:35], s27 offen sc1 lds
    v_cvt_pk_bf16_f32 v225, v210, v211
    v_exp_f32 v21, v21
    v_exp_f32 v22, v22
    v_cvt_pk_bf16_f32 v50, v20, v21
    v_exp_f32 v23, v23
    v_exp_f32 v24, v24
    v_cvt_pk_bf16_f32 v51, v22, v23
    v_mfma_f32_32x32x8_bf16 v[32:47], a[94:95], v[100:101], v[32:47]
    s_mov_b32 s20, 0x21800000
    v_exp_f32 v25, v25
    v_exp_f32 v26, v26
    v_cvt_pk_bf16_f32 v52, v24, v25
    v_exp_f32 v27, v27
    v_exp_f32 v28, v28
    v_mfma_f32_32x32x16_bf16 v[72:87], a[96:99], v[48:51], v[72:87]
    s_mov_b32 s21, 0x5d800000
    v_exp_f32 v29, v29
    v_cvt_pk_bf16_f32 v53, v26, v27
    v_exp_f32 v30, v30
    v_exp_f32 v31, v31
    v_cvt_pk_bf16_f32 v54, v28, v29
    v_cvt_pk_bf16_f32 v55, v30, v31
    v_exp_f32 v32, v32
    v_exp_f32 v33, v33
    v_mfma_f32_32x32x16_bf16 v[72:87], a[100:103], v[52:55], v[72:87]
    s_add_u32 s27, s43, 4096
    s_add_u32 m0, s98, 19456
    s_nop 0
    buffer_load_dwordx4 v13, s[32:35], s27 offen sc1 lds
    s_mov_b32 s22, 0x7b800000
    v_exp_f32 v34, v34
    v_cvt_pk_bf16_f32 v48, v32, v33
    v_exp_f32 v35, v35
    v_exp_f32 v36, v36
    v_cvt_pk_bf16_f32 v49, v34, v35
    v_mfma_f32_32x32x16_bf16 v[16:31], a[112:115], v[96:99], 0
    s_mov_b64 s[90:91], 0
    v_exp_f32 v37, v37
    v_exp_f32 v38, v38
    v_cvt_pk_bf16_f32 v50, v36, v37
    v_exp_f32 v39, v39
    v_exp_f32 v40, v40
    v_cvt_pk_bf16_f32 v51, v38, v39
    v_mfma_f32_32x32x8_bf16 v[16:31], a[120:121], v[100:101], v[16:31]
    v_accvgpr_read_b32 v12, a229
    v_add_f32 v222, |v56|, |v57|
    v_exp_f32 v41, v41
    v_exp_f32 v42, v42
    v_cvt_pk_bf16_f32 v52, v40, v41
    v_exp_f32 v43, v43
    v_exp_f32 v44, v44
    v_mfma_f32_32x32x16_bf16 v[72:87], a[104:107], v[48:51], v[72:87]
    s_mov_b64 exec, 0xffff
    buffer_load_dword v244, v12, s[32:35], s89 offen offset:2048 sc1
    s_mov_b64 exec, -1
    v_add_f32 v222, v222, |v58|
    v_exp_f32 v45, v45
    v_cvt_pk_bf16_f32 v53, v42, v43
    v_exp_f32 v46, v46
    v_exp_f32 v47, v47
    v_cvt_pk_bf16_f32 v54, v44, v45
    v_cvt_pk_bf16_f32 v55, v46, v47
    v_exp_f32 v16, v16
    v_exp_f32 v17, v17
    v_mfma_f32_32x32x16_bf16 v[72:87], a[108:111], v[52:55], v[72:87]
    s_add_u32 s27, s44, 0
    s_add_u32 m0, s98, 20480
    s_nop 0
    buffer_load_dwordx4 v13, s[32:35], s27 offen sc1 lds
    v_add_f32 v222, v222, |v59|
    v_exp_f32 v18, v18
    v_cvt_pk_bf16_f32 v48, v16, v17
    v_exp_f32 v19, v19
    v_exp_f32 v20, v20
    v_cvt_pk_bf16_f32 v49, v18, v19
    v_mfma_f32_32x32x16_bf16 v[32:47], a[116:119], v[96:99], 0
    v_add_f32 v222, v222, |v60|
    v_exp_f32 v21, v21
    v_exp_f32 v22, v22
    v_cvt_pk_bf16_f32 v50, v20, v21
    v_exp_f32 v23, v23
    v_exp_f32 v24, v24
    v_cvt_pk_bf16_f32 v51, v22, v23
    v_mfma_f32_32x32x8_bf16 v[32:47], a[122:123], v[100:101], v[32:47]
    v_add_f32 v222, v222, |v61|
    v_exp_f32 v25, v25
    v_exp_f32 v26, v26
    v_cvt_pk_bf16_f32 v52, v24, v25
    v_exp_f32 v27, v27
    v_exp_f32 v28, v28
    v_mfma_f32_32x32x16_bf16 v[72:87], a[124:127], v[48:51], v[72:87]
    s_add_u32 s27, s44, 1024
    s_add_u32 m0, s98, 21504
    s_nop 0
    buffer_load_dwordx4 v13, s[32:35], s27 offen sc1 lds
    v_add_f32 v222, v222, |v62|
    v_exp_f32 v29, v29
    v_cvt_pk_bf16_f32 v53, v26, v27
    v_exp_f32 v30, v30
    v_exp_f32 v31, v31
    v_cvt_pk_bf16_f32 v54, v28, v29
    v_cvt_pk_bf16_f32 v55, v30, v31
    v_exp_f32 v32, v32
    v_exp_f32 v33, v33
    v_mfma_f32_32x32x16_bf16 v[72:87], a[128:131], v[52:55], v[72:87]
    v_add_f32 v222, v222, |v63|
    v_exp_f32 v34, v34
    v_cvt_pk_bf16_f32 v48, v32, v33
    v_exp_f32 v35, v35
    v_exp_f32 v36, v36
    v_cvt_pk_bf16_f32 v49, v34, v35
    v_mfma_f32_32x32x16_bf16 v[16:31], a[140:143], v[96:99], 0
    v_add_f32 v222, v222, |v64|
    v_exp_f32 v37, v37
    v_exp_f32 v38, v38
    v_cvt_pk_bf16_f32 v50, v36, v37
    v_exp_f32 v39, v39
    v_exp_f32 v40, v40
    v_cvt_pk_bf16_f32 v51, v38, v39
    v_mfma_f32_32x32x8_bf16 v[16:31], a[148:149], v[100:101], v[16:31]
    s_add_u32 s27, s44, 2048
    s_add_u32 m0, s98, 22528
    s_nop 0
    buffer_load_dwordx4 v13, s[32:35], s27 offen sc1 lds
    v_add_f32 v222, v222, |v65|
    v_exp_f32 v41, v41
    v_exp_f32 v42, v42
    v_cvt_pk_bf16_f32 v52, v40, v41
    v_exp_f32 v43, v43
    v_exp_f32 v44, v44
    v_mfma_f32_32x32x16_bf16 v[72:87], a[132:135], v[48:51], v[72:87]
    v_add_f32 v222, v222, |v66|
    v_exp_f32 v45, v45
    v_cvt_pk_bf16_f32 v53, v42, v43
    v_exp_f32 v46, v46
    v_exp_f32 v47, v47
    v_cvt_pk_bf16_f32 v54, v44, v45
    v_cvt_pk_bf16_f32 v55, v46, v47
    v_exp_f32 v16, v16
    v_exp_f32 v17, v17
    v_mfma_f32_32x32x16_bf16 v[72:87], a[136:139], v[52:55], v[72:87]
    v_add_f32 v222, v222, |v67|
    v_exp_f32 v18, v18
    v_cvt_pk_bf16_f32 v48, v16, v17
    v_exp_f32 v19, v19
    v_exp_f32 v20, v20
    v_cvt_pk_bf16_f32 v49, v18, v19
    v_mfma_f32_32x32x16_bf16 v[32:47], a[144:147], v[96:99], 0
    s_add_u32 s27, s44, 3072
    s_add_u32 m0, s98, 23552
    s_nop 0
    buffer_load_dwordx4 v13, s[32:35], s27 offen sc1 lds
    v_cmp_nle_f32 vcc, s20, v216
    s_or_b64 s[90:91], s[90:91], vcc
    v_exp_f32 v21, v21
    v_exp_f32 v22, v22
    v_cvt_pk_bf16_f32 v50, v20, v21
    v_exp_f32 v23, v23
    v_exp_f32 v24, v24
    v_cvt_pk_bf16_f32 v51, v22, v23
    v_mfma_f32_32x32x8_bf16 v[32:47], a[150:151], v[100:101], v[32:47]
    v_cmp_nge_f32 vcc, s21, v216
    s_or_b64 s[90:91], s[90:91], vcc
    v_exp_f32 v25, v25
    v_exp_f32 v26, v26
    v_cvt_pk_bf16_f32 v52, v24, v25
    v_exp_f32 v27, v27
    v_exp_f32 v28, v28
    v_mfma_f32_32x32x16_bf16 v[72:87], a[152:155], v[48:51], v[72:87]
    v_cmp_ngt_f32 vcc, s22, v222
    s_or_b64 s[90:91], s[90:91], vcc
    v_exp_f32 v29, v29
    v_cvt_pk_bf16_f32 v53, v26, v27
    v_exp_f32 v30, v30
    v_exp_f32 v31, v31
    v_cvt_pk_bf16_f32 v54, v28, v29
    v_cvt_pk_bf16_f32 v55, v30, v31
    v_exp_f32 v32, v32
    v_exp_f32 v33, v33
    v_mfma_f32_32x32x16_bf16 v[72:87], a[156:159], v[52:55], v[72:87]
    s_add_u32 s27, s44, 4096
    s_add_u32 m0, s98, 24576
    s_nop 0
    buffer_load_dwordx4 v13, s[32:35], s27 offen sc1 lds
    v_exp_f32 v34, v34
    v_cvt_pk_bf16_f32 v48, v32, v33
    v_exp_f32 v35, v35
    v_exp_f32 v36, v36
    v_cvt_pk_bf16_f32 v49, v34, v35
    v_mfma_f32_32x32x16_bf16 v[16:31], a[168:171], v[96:99], 0
    v_exp_f32 v37, v37
    v_exp_f32 v38, v38
    v_cvt_pk_bf16_f32 v50, v36, v37
    v_exp_f32 v39, v39
    v_exp_f32 v40, v40
    v_cvt_pk_bf16_f32 v51, v38, v39
    v_mfma_f32_32x32x8_bf16 v[16:31], a[176:177], v[100:101], v[16:31]
    v_exp_f32 v41, v41
    v_exp_f32 v42, v42
    v_cvt_pk_bf16_f32 v52, v40, v41
    v_exp_f32 v43, v43
    v_exp_f32 v44, v44
    v_mfma_f32_32x32x16_bf16 v[72:87], a[160:163], v[48:51], v[72:87]
    v_exp_f32 v45, v45
    v_cvt_pk_bf16_f32 v53, v42, v43
    v_exp_f32 v46, v46
    v_exp_f32 v47, v47
    v_cvt_pk_bf16_f32 v54, v44, v45
    v_cvt_pk_bf16_f32 v55, v46, v47
    v_exp_f32 v16, v16
    v_exp_f32 v17, v17
    v_mfma_f32_32x32x16_bf16 v[72:87], a[164:167], v[52:55], v[72:87]
    v_exp_f32 v18, v18
    v_cvt_pk_bf16_f32 v48, v16, v17
    v_exp_f32 v19, v19
    v_exp_f32 v20, v20
    v_cvt_pk_bf16_f32 v49, v18, v19
    v_mfma_f32_32x32x16_bf16 v[32:47], a[172:175], v[96:99], 0
    v_exp_f32 v21, v21
    v_exp_f32 v22, v22
    v_cvt_pk_bf16_f32 v50, v20, v21
    v_exp_f32 v23, v23
    v_exp_f32 v24, v24
    v_cvt_pk_bf16_f32 v51, v22, v23
    v_mfma_f32_32x32x8_bf16 v[32:47], a[178:179], v[100:101], v[32:47]
    s_lshl_b32 s3, s81, 12
    v_exp_f32 v25, v25
    v_exp_f32 v26, v26
    v_cvt_pk_bf16_f32 v52, v24, v25
    v_exp_f32 v27, v27
    v_exp_f32 v28, v28
    v_mfma_f32_32x32x16_bf16 v[72:87], a[180:183], v[48:51], v[72:87]
    s_add_u32 s3, s3, 7733248
    v_exp_f32 v29, v29
    v_cvt_pk_bf16_f32 v53, v26, v27
    v_exp_f32 v30, v30
    v_exp_f32 v31, v31
    v_cvt_pk_bf16_f32 v54, v28, v29
    v_cvt_pk_bf16_f32 v55, v30, v31
    v_exp_f32 v32, v32
    v_exp_f32 v33, v33
    v_mfma_f32_32x32x16_bf16 v[72:87], a[184:187], v[52:55], v[72:87]
    s_lshl_b32 s2, s82, 9
    v_exp_f32 v34, v34
    v_cvt_pk_bf16_f32 v48, v32, v33
    v_exp_f32 v35, v35
    v_exp_f32 v36, v36
    v_cvt_pk_bf16_f32 v49, v34, v35
    v_mfma_f32_32x32x16_bf16 v[16:31], a[196:199], v[96:99], 0
    s_add_u32 s3, s3, s2
    v_exp_f32 v37, v37
    v_exp_f32 v38, v38
    v_cvt_pk_bf16_f32 v50, v36, v37
    v_exp_f32 v39, v39
    v_exp_f32 v40, v40
    v_cvt_pk_bf16_f32 v51, v38, v39
    v_mfma_f32_32x32x8_bf16 v[16:31], a[204:205], v[100:101], v[16:31]
    s_lshl_b32 s2, s80, 7
    v_exp_f32 v41, v41
    v_exp_f32 v42, v42
    v_cvt_pk_bf16_f32 v52, v40, v41
    v_exp_f32 v43, v43
    v_exp_f32 v44, v44
    v_mfma_f32_32x32x16_bf16 v[72:87], a[188:191], v[48:51], v[72:87]
    s_add_u32 s3, s3, s2
    v_exp_f32 v45, v45
    v_cvt_pk_bf16_f32 v53, v42, v43
    v_exp_f32 v46, v46
    v_exp_f32 v47, v47
    v_cvt_pk_bf16_f32 v54, v44, v45
    v_cvt_pk_bf16_f32 v55, v46, v47
    v_exp_f32 v16, v16
    v_exp_f32 v17, v17
    v_mfma_f32_32x32x16_bf16 v[72:87], a[192:195], v[52:55], v[72:87]
    v_mov_b32 v14, s3
    v_exp_f32 v18, v18
    v_cvt_pk_bf16_f32 v48, v16, v17
    v_exp_f32 v19, v19
    v_exp_f32 v20, v20
    v_cvt_pk_bf16_f32 v49, v18, v19
    v_mfma_f32_32x32x16_bf16 v[32:47], a[200:203], v[96:99], 0
    v_mov_b32 v15, s84
    v_exp_f32 v21, v21
    v_exp_f32 v22, v22
    v_cvt_pk_bf16_f32 v50, v20, v21
    v_exp_f32 v23, v23
    v_exp_f32 v24, v24
    v_cvt_pk_bf16_f32 v51, v22, v23
    v_mfma_f32_32x32x8_bf16 v[32:47], a[206:207], v[100:101], v[32:47]
    s_waitcnt vmcnt(9)
    s_mov_b32 s48, 0
    s_cmp_lg_u64 s[90:91], 0
    s_cbranch_scc1 L_noearly_29
    s_mov_b32 s48, 1
    s_mov_b64 exec, 1
    buffer_store_dword v15, v14, s[32:35], 0 offen sc1
    s_mov_b64 exec, -1
L_noearly_29:
    v_exp_f32 v25, v25
    v_exp_f32 v26, v26
    v_cvt_pk_bf16_f32 v52, v24, v25
    v_exp_f32 v27, v27
    v_exp_f32 v28, v28
    v_mfma_f32_32x32x16_bf16 v[72:87], a[208:211], v[48:51], v[72:87]
    v_exp_f32 v29, v29
    v_cvt_pk_bf16_f32 v53, v26, v27
    v_exp_f32 v30, v30
    v_exp_f32 v31, v31
    v_cvt_pk_bf16_f32 v54, v28, v29
    v_cvt_pk_bf16_f32 v55, v30, v31
    v_exp_f32 v32, v32
    v_exp_f32 v33, v33
    v_mfma_f32_32x32x16_bf16 v[72:87], a[212:215], v[52:55], v[72:87]
    v_exp_f32 v34, v34
    v_cvt_pk_bf16_f32 v48, v32, v33
    v_exp_f32 v35, v35
    v_exp_f32 v36, v36
    v_cvt_pk_bf16_f32 v49, v34, v35
    s_waitcnt lgkmcnt(0)
    v_mfma_f32_32x32x16_bf16 v[16:31], a[0:3], v[88:91], 0
    v_exp_f32 v37, v37
    v_exp_f32 v38, v38
    v_cvt_pk_bf16_f32 v50, v36, v37
    v_exp_f32 v39, v39
    v_exp_f32 v40, v40
    v_cvt_pk_bf16_f32 v51, v38, v39
    v_mfma_f32_32x32x8_bf16 v[16:31], a[8:9], v[92:93], v[16:31]
    v_exp_f32 v41, v41
    v_exp_f32 v42, v42
    v_cvt_pk_bf16_f32 v52, v40, v41
    v_exp_f32 v43, v43
    v_exp_f32 v44, v44
    v_mfma_f32_32x32x16_bf16 v[72:87], a[216:219], v[48:51], v[72:87]
    v_exp_f32 v45, v45
    v_cvt_pk_bf16_f32 v53, v42, v43
    v_exp_f32 v46, v46
    v_exp_f32 v47, v47
    v_cvt_pk_bf16_f32 v54, v44, v45
    v_cvt_pk_bf16_f32 v55, v46, v47
    s_nop 1
    v_mfma_f32_32x32x16_bf16 v[72:87], a[220:223], v[52:55], v[72:87]
    s_nop 11
    v_mov_b32 v222, v80
    v_mov_b32 v218, v80
    s_nop 1
    v_permlane32_swap_b32 v222, v218
    v_rcp_f32 v214, v218
    s_nop 0
    v_pk_mul_f32 v[204:205], v[72:73], v[214:215] op_sel_hi:[1,0]
    v_pk_mul_f32 v[206:207], v[74:75], v[214:215] op_sel_hi:[1,0]
    v_pk_mul_f32 v[208:209], v[76:77], v[214:215] op_sel_hi:[1,0]
    v_pk_mul_f32 v[210:211], v[78:79], v[214:215] op_sel_hi:[1,0]
    v_cvt_pk_bf16_f32 v204, v204, v205
    v_cvt_pk_bf16_f32 v205, v206, v207
    v_cvt_pk_bf16_f32 v206, v208, v209
    v_cvt_pk_bf16_f32 v207, v210, v211
    buffer_store_dwordx4 v[204:207], v6, s[32:35], s89 offen offset:0 sc1
    v_pk_mul_f32 v[208:209], v[80:81], v[214:215] op_sel_hi:[1,0]
    v_pk_mul_f32 v[210:211], v[82:83], v[214:215] op_sel_hi:[1,0]
    v_cvt_pk_bf16_f32 v226, v208, v209
    v_cvt_pk_bf16_f32 v227, v210, v211
    buffer_store_dwordx4 v[224:227], v7, s[32:35], 0 offen offset:0 sc1
    v_add_f32 v222, |v72|, |v73|
    v_add_f32 v222, v222, |v74|
    v_add_f32 v222, v222, |v75|
    v_add_f32 v222, v222, |v76|
    v_add_f32 v222, v222, |v77|
    v_add_f32 v222, v222, |v78|
    v_add_f32 v222, v222, |v79|
    v_add_f32 v222, v222, |v80|
    v_add_f32 v222, v222, |v81|
    v_add_f32 v222, v222, |v82|
    v_add_f32 v222, v222, |v83|
    v_cmp_nle_f32 vcc, s20, v218
    s_or_b64 s[90:91], s[90:91], vcc
    v_cmp_nge_f32 vcc, s21, v218
    s_or_b64 s[90:91], s[90:91], vcc
    v_cmp_ngt_f32 vcc, s22, v222
    s_or_b64 s[90:91], s[90:91], vcc
    s_waitcnt vmcnt(2)
    v_accvgpr_read_b32 v245, a230
    v_mov_b32 v13, 157376
    v_mov_b32 v14, 1
    s_cmp_eq_u64 s[90:91], 0
    s_cbranch_scc1 L_novote_30
    ds_write_b32 v13, v14
    s_waitcnt lgkmcnt(0)
L_novote_30:
    s_barrier
    ds_read_b32 v14, v13
    s_waitcnt lgkmcnt(0)
    v_cmp_ne_u32 vcc, 0, v14
    s_cbranch_vccnz L_slowpath_32
L_voteok_31:
    s_lshl_b32 s3, s81, 12
    s_add_u32 s3, s3, 8257536
    s_lshl_b32 s2, s82, 9
    s_lshl_b32 s66, s80, 7
    s_add_u32 s3, s3, s2
    s_add_u32 s3, s3, s66
    v_mov_b32 v8, s3
    s_lshl_b32 s3, s81, 12
    s_add_u32 s3, s3, 7733248
    s_and_b32 s2, s26, 2
    s_add_u32 s2, s2, 1
    v_and_b32 v7, 1, v0
    v_add_u32 v7, s2, v7
    v_and_b32 v7, 3, v7
    v_lshl_add_u32 v7, v7, 7, s3
    v_bfe_u32 v15, v0, 1, 3
    v_lshl_add_u32 v7, v15, 9, v7
    s_lshl_b32 s3, s82, 1
    s_add_u32 s3, s3, 0
    s_and_b32 s3, s3, 7
    s_lshl_b32 s40, s3, 10
    s_lshl_b32 s3, s82, 1
    s_add_u32 s3, s3, 1
    s_and_b32 s3, s3, 7
    s_lshl_b32 s41, s3, 10
    s_lshl_b32 s3, s82, 1
    s_add_u32 s3, s3, 2
    s_and_b32 s3, s3, 7
    s_lshl_b32 s42, s3, 10
    s_lshl_b32 s3, s82, 1
    s_add_u32 s3, s3, 3
    s_and_b32 s3, s3, 7
    s_lshl_b32 s43, s3, 10
    s_lshl_b32 s3, s82, 1
    s_add_u32 s3, s3, 4
    s_and_b32 s3, s3, 7
    s_lshl_b32 s44, s3, 10
    s_lshl_b32 s3, s82, 1
    s_add_u32 s3, s3, 5
    s_and_b32 s3, s3, 7
    s_lshl_b32 s45, s3, 10
    s_lshl_b32 s3, s82, 1
    s_add_u32 s3, s3, 6
    s_and_b32 s3, s3, 7
    s_lshl_b32 s46, s3, 10
    s_lshl_b32 s3, s82, 1
    s_add_u32 s3, s3, 7
    s_and_b32 s3, s3, 7
    s_lshl_b32 s47, s3, 10
    v_add_u32 v2, 24576, v1
    v_add_u32 v4, 63488, v1
    v_add_u32 v5, 112640, v1
    s_mul_i32 s66, s81, 81920
    s_mul_i32 s2, s26, 20480
    s_add_u32 s3, s66, s2
    s_add_u32 s3, s3, 1048576
    v_add_u32 v3, s3, v1
    v_add_u32 v6, 8192, v3
    v_add_u32 v12, 524288, v7
    s_mul_i32 s2, s82, 10240
    s_add_u32 s3, s66, s2
    s_lshr_b32 s2, s26, 1
    s_lshl_b32 s2, s2, 10
    s_add_u32 s3, s3, s2
    s_and_b32 s2, s26, 1
    s_lshl_b32 s2, s2, 8
    s_add_u32 s3, s3, s2
    s_add_u32 s3, s3, 4194304
    v_and_b32 v13, 15, v0
    v_lshl_add_u32 v9, v13, 4, s3
    v_lshrrev_b32 v14, 5, v0
    v_lshl_add_u32 v9, v14, 9, v9
    v_bfe_u32 v15, v0, 4, 1
    v_lshl_add_u32 v10, v15, 30, v9
    v_lshl_add_u32 v9, v15, 11, v9
    v_lshrrev_b32 v13, 4, v0
    v_lshlrev_b32 v13, 4, v13
    v_add_u32 v13, 155904, v13
    v_subrev_u32 v15, 524288, v8
    buffer_load_dwordx4 a[0:3], v11, s[32:35], 0 offen offset:0 sc1
    buffer_load_dwordx4 a[4:7], v11, s[32:35], 0 offen offset:1024 sc1
    buffer_load_dwordx4 a[8:11], v11, s[32:35], 0 offen offset:2048 sc1
    buffer_load_dwordx4 a[12:15], v11, s[32:35], 0 offen offset:3072 sc1
    s_mov_b32 s89, 4096
    buffer_load_dwordx4 a[16:19], v11, s[32:35], s89 offen offset:0 sc1
    buffer_load_dwordx4 a[20:23], v11, s[32:35], s89 offen offset:1024 sc1
    s_mov_b64 exec, 1
    s_waitcnt vmcnt(6)
    v_mov_b32 v14, s84
    buffer_store_dword v14, v8, s[32:35], 0 offen sc1
    s_cmp_lg_u32 s48, 0
    s_cbranch_scc1 L_hadearly_33
    buffer_store_dword v14, v15, s[32:35], 0 offen sc1
L_hadearly_33:
    s_mov_b64 exec, -1
    ds_read_b128 v[164:167], v13 offset:0
    ds_read_b128 v[168:171], v13 offset:64
    ds_read_b128 v[172:175], v13 offset:128
    ds_read_b128 v[176:179], v13 offset:192
    ds_read_b128 v[180:183], v13 offset:256
    ds_read_b128 v[184:187], v13 offset:320
    ds_read_b128 v[188:191], v13 offset:384
    ds_read_b128 v[192:195], v13 offset:448
    ds_read_b128 v[196:199], v13 offset:512
    ds_read_b128 v[200:203], v13 offset:576
    buffer_load_dwordx4 a[24:27], v11, s[32:35], s89 offen offset:2048 sc1
    buffer_load_dwordx4 a[28:31], v11, s[32:35], s89 offen offset:3072 sc1
    s_mov_b32 s89, 8192
    buffer_load_dwordx4 a[32:35], v11, s[32:35], s89 offen offset:0 sc1
    buffer_load_dwordx4 a[36:39], v11, s[32:35], s89 offen offset:1024 sc1
    buffer_load_dwordx4 a[40:43], v11, s[32:35], s89 offen offset:2048 sc1
    buffer_load_dwordx4 a[44:47], v11, s[32:35], s89 offen offset:3072 sc1
    s_mov_b32 s89, 12288
    buffer_load_dwordx4 a[48:51], v11, s[32:35], s89 offen offset:0 sc1
    buffer_load_dwordx4 a[52:55], v11, s[32:35], s89 offen offset:1024 sc1
    buffer_load_dwordx4 a[56:59], v11, s[32:35], s89 offen offset:2048 sc1
    s_mov_b32 s88, 400000
L_poll_34:
    s_mov_b64 exec, 0xffff
    buffer_load_dword v14, v7, s[32:35], 0 offen sc1
    s_sub_u32 s88, s88, 1
    s_cbranch_scc1 L_end
    s_waitcnt vmcnt(0)
    v_cmp_ne_u32 vcc, s84, v14
    s_cbranch_vccnz L_poll_34
    s_mov_b64 exec, -1
    buffer_load_dwordx4 v[16:19], v3, s[32:35], s40 offen sc1
    buffer_load_dwordx4 v[20:23], v3, s[32:35], s41 offen sc1
    buffer_load_dwordx4 v[24:27], v3, s[32:35], s42 offen sc1
    buffer_load_dwordx4 v[28:31], v3, s[32:35], s43 offen sc1
    buffer_load_dwordx4 v[32:35], v3, s[32:35], s44 offen sc1
    buffer_load_dwordx4 v[36:39], v3, s[32:35], s45 offen sc1
    buffer_load_dwordx4 v[40:43], v3, s[32:35], s46 offen sc1
    buffer_load_dwordx4 v[44:47], v3, s[32:35], s47 offen sc1
    s_mov_b64 exec, 0xffff
    buffer_load_dword v14, v12, s[32:35], 0 offen sc1
    s_mov_b64 exec, -1
    v_lshlrev_b32 v204, 16, v246
    v_and_b32 v205, 0xffff0000, v246
    v_lshlrev_b32 v206, 16, v247
    v_and_b32 v207, 0xffff0000, v247
    v_lshlrev_b32 v208, 16, v248
    v_and_b32 v209, 0xffff0000, v248
    v_lshlrev_b32 v210, 16, v249
    v_and_b32 v211, 0xffff0000, v249
    v_lshlrev_b32 v212, 16, v250
    v_and_b32 v213, 0xffff0000, v250
    v_lshlrev_b32 v214, 16, v251
    v_and_b32 v215, 0xffff0000, v251
    v_lshlrev_b32 v216, 16, v252
    v_and_b32 v217, 0xffff0000, v252
    v_lshlrev_b32 v218, 16, v253
    v_and_b32 v219, 0xffff0000, v253
    v_lshlrev_b32 v220, 16, v254
    v_and_b32 v221, 0xffff0000, v254
    v_lshlrev_b32 v222, 16, v255
    v_and_b32 v223, 0xffff0000, v255
    ds_read_b128 v[104:107], v2 offset:0
    ds_read_b128 v[108:111], v2 offset:1024
    ds_read_b128 v[112:115], v2 offset:2048
    ds_read_b128 v[116:119], v2 offset:3072
    ds_read_b128 v[120:123], v2 offset:4096
    ds_read_b128 v[124:127], v2 offset:5120
    ds_read_b128 v[128:131], v2 offset:6144
    ds_read_b128 v[132:135], v2 offset:7168
    ds_read_b128 v[136:139], v2 offset:8192
    ds_read_b128 v[140:143], v2 offset:9216
    s_waitcnt vmcnt(8)
    s_waitcnt lgkmcnt(7)
    v_mfma_f32_16x16x32_bf16 v[224:227], v[104:107], v[16:19], 0
    ds_read_b128 v[144:147], v2 offset:10240
    v_mfma_f32_16x16x32_bf16 v[228:231], v[108:111], v[16:19], 0
    ds_read_b128 v[148:151], v2 offset:11264
    v_mfma_f32_16x16x32_bf16 v[232:235], v[112:115], v[16:19], 0
    ds_read_b128 v[152:155], v2 offset:12288
    s_waitcnt lgkmcnt(8)
    v_mfma_f32_16x16x32_bf16 v[236:239], v[116:119], v[16:19], 0
    ds_read_b128 v[156:159], v2 offset:13312
    v_mfma_f32_16x16x32_bf16 v[240:243], v[120:123], v[16:19], 0
    ds_read_b128 v[160:163], v2 offset:14336
    s_waitcnt vmcnt(7)
    s_waitcnt lgkmcnt(7)
    v_mfma_f32_16x16x32_bf16 v[224:227], v[124:127], v[20:23], v[224:227]
    ds_read_b128 v[104:107], v2 offset:15360
    v_mfma_f32_16x16x32_bf16 v[228:231], v[128:131], v[20:23], v[228:231]
    ds_read_b128 v[108:111], v2 offset:16384
    v_mfma_f32_16x16x32_bf16 v[232:235], v[132:135], v[20:23], v[232:235]
    ds_read_b128 v[112:115], v2 offset:17408
    s_waitcnt vmcnt(0)
    s_mov_b64 exec, 0xffff
    v_cmp_ne_u32 vcc, s84, v14
    s_mov_b64 exec, -1
    s_cbranch_vccz L_ptok_36
    s_mov_b32 s88, 400000
L_poll_37:
    s_mov_b64 exec, 0xffff
    buffer_load_dword v14, v12, s[32:35], 0 offen sc1
    s_sub_u32 s88, s88, 1
    s_cbranch_scc1 L_end
    s_waitcnt vmcnt(0)
    v_cmp_ne_u32 vcc, s84, v14
    s_cbranch_vccnz L_poll_37
    s_mov_b64 exec, -1
L_ptok_36:
    buffer_load_dwordx4 v[48:51], v6, s[32:35], s40 offen sc1
    buffer_load_dwordx4 v[52:55], v6, s[32:35], s41 offen sc1
    s_waitcnt lgkmcnt(8)
    v_mfma_f32_16x16x32_bf16 v[236:239], v[136:139], v[20:23], v[236:239]
    ds_read_b128 v[116:119], v2 offset:18432
    v_mfma_f32_16x16x32_bf16 v[240:243], v[140:143], v[20:23], v[240:243]
    ds_read_b128 v[120:123], v2 offset:19456
    s_waitcnt lgkmcnt(7)
    v_mfma_f32_16x16x32_bf16 v[224:227], v[144:147], v[24:27], v[224:227]
    ds_read_b128 v[124:127], v2 offset:20480
    v_mfma_f32_16x16x32_bf16 v[228:231], v[148:151], v[24:27], v[228:231]
    ds_read_b128 v[128:131], v2 offset:21504
    v_mfma_f32_16x16x32_bf16 v[232:235], v[152:155], v[24:27], v[232:235]
    ds_read_b128 v[132:135], v2 offset:22528
    buffer_load_dwordx4 v[56:59], v6, s[32:35], s42 offen sc1
    buffer_load_dwordx4 v[60:63], v6, s[32:35], s43 offen sc1
    s_waitcnt lgkmcnt(8)
    v_mfma_f32_16x16x32_bf16 v[236:239], v[156:159], v[24:27], v[236:239]
    ds_read_b128 v[136:139], v2 offset:23552
    v_mfma_f32_16x16x32_bf16 v[240:243], v[160:163], v[24:27], v[240:243]
    ds_read_b128 v[140:143], v2 offset:24576
    s_waitcnt lgkmcnt(7)
    v_mfma_f32_16x16x32_bf16 v[224:227], v[104:107], v[28:31], v[224:227]
    ds_read_b128 v[144:147], v2 offset:25600
    v_mfma_f32_16x16x32_bf16 v[228:231], v[108:111], v[28:31], v[228:231]
    ds_read_b128 v[148:151], v2 offset:26624
    v_mfma_f32_16x16x32_bf16 v[232:235], v[112:115], v[28:31], v[232:235]
    ds_read_b128 v[152:155], v2 offset:27648
    buffer_load_dwordx4 v[64:67], v6, s[32:35], s44 offen sc1
    buffer_load_dwordx4 v[68:71], v6, s[32:35], s45 offen sc1
    s_waitcnt lgkmcnt(8)
    v_mfma_f32_16x16x32_bf16 v[236:239], v[116:119], v[28:31], v[236:239]
    ds_read_b128 v[156:159], v2 offset:28672
    v_mfma_f32_16x16x32_bf16 v[240:243], v[120:123], v[28:31], v[240:243]
    ds_read_b128 v[160:163], v2 offset:29696
    s_waitcnt lgkmcnt(7)
    v_mfma_f32_16x16x32_bf16 v[224:227], v[124:127], v[32:35], v[224:227]
    ds_read_b128 v[104:107], v2 offset:30720
    v_mfma_f32_16x16x32_bf16 v[228:231], v[128:131], v[32:35], v[228:231]
    ds_read_b128 v[108:111], v2 offset:31744
    v_mfma_f32_16x16x32_bf16 v[232:235], v[132:135], v[32:35], v[232:235]
    ds_read_b128 v[112:115], v2 offset:32768
    buffer_load_dwordx4 v[72:75], v6, s[32:35], s46 offen sc1
    buffer_load_dwordx4 v[76:79], v6, s[32:35], s47 offen sc1
    s_waitcnt lgkmcnt(8)
    v_mfma_f32_16x16x32_bf16 v[236:239], v[136:139], v[32:35], v[236:239]
    ds_read_b128 v[116:119], v2 offset:33792
    v_mfma_f32_16x16x32_bf16 v[240:243], v[140:143], v[32:35], v[240:243]
    ds_read_b128 v[120:123], v2 offset:34816
    s_waitcnt lgkmcnt(7)
    v_mfma_f32_16x16x32_bf16 v[224:227], v[144:147], v[36:39], v[224:227]
    ds_read_b128 v[124:127], v2 offset:35840
    v_mfma_f32_16x16x32_bf16 v[228:231], v[148:151], v[36:39], v[228:231]
    ds_read_b128 v[128:131], v2 offset:36864
    v_mfma_f32_16x16x32_bf16 v[232:235], v[152:155], v[36:39], v[232:235]
    ds_read_b128 v[132:135], v2 offset:37888
    s_mov_b32 s89, 16384
    buffer_load_dwordx4 v[80:83], v3, s[32:35], s89 offen offset:0 sc1
    buffer_load_dwordx4 v[84:87], v3, s[32:35], s89 offen offset:1024 sc1
    s_waitcnt lgkmcnt(8)
    v_mfma_f32_16x16x32_bf16 v[236:239], v[156:159], v[36:39], v[236:239]
    ds_read_b128 v[136:139], v4 offset:0
    v_mfma_f32_16x16x32_bf16 v[240:243], v[160:163], v[36:39], v[240:243]
    ds_read_b128 v[140:143], v4 offset:1024
    s_waitcnt lgkmcnt(7)
    v_mfma_f32_16x16x32_bf16 v[224:227], v[104:107], v[40:43], v[224:227]
    ds_read_b128 v[144:147], v4 offset:2048
    v_mfma_f32_16x16x32_bf16 v[228:231], v[108:111], v[40:43], v[228:231]
    ds_read_b128 v[148:151], v4 offset:3072
    v_mfma_f32_16x16x32_bf16 v[232:235], v[112:115], v[40:43], v[232:235]
    ds_read_b128 v[152:155], v4 offset:4096
    buffer_load_dwordx4 v[88:91], v3, s[32:35], s89 offen offset:2048 sc1
    buffer_load_dwordx4 v[92:95], v3, s[32:35], s89 offen offset:3072 sc1
    s_waitcnt lgkmcnt(8)
    v_mfma_f32_16x16x32_bf16 v[236:239], v[116:119], v[40:43], v[236:239]
    ds_read_b128 v[156:159], v4 offset:5120
    v_mfma_f32_16x16x32_bf16 v[240:243], v[120:123], v[40:43], v[240:243]
    ds_read_b128 v[160:163], v4 offset:6144
    s_waitcnt lgkmcnt(7)
    v_mfma_f32_16x16x32_bf16 v[224:227], v[124:127], v[44:47], v[224:227]
    ds_read_b128 v[104:107], v4 offset:7168
    v_mfma_f32_16x16x32_bf16 v[228:231], v[128:131], v[44:47], v[228:231]
    ds_read_b128 v[108:111], v4 offset:8192
    v_mfma_f32_16x16x32_bf16 v[232:235], v[132:135], v[44:47], v[232:235]
    ds_read_b128 v[112:115], v4 offset:9216
    s_mov_b32 s89, 15360
    buffer_load_dwordx4 a[60:63], v11, s[32:35], s89 offen offset:0 sc1
    s_waitcnt lgkmcnt(8)
    v_mfma_f32_16x16x32_bf16 v[236:239], v[136:139], v[44:47], v[236:239]
    ds_read_b128 v[116:119], v4 offset:10240
    v_mfma_f32_16x16x32_bf16 v[240:243], v[140:143], v[44:47], v[240:243]
    ds_read_b128 v[120:123], v4 offset:11264
    s_waitcnt vmcnt(12)
    s_waitcnt lgkmcnt(7)
    v_mfma_f32_16x16x32_bf16 v[224:227], v[144:147], v[48:51], v[224:227]
    ds_read_b128 v[124:127], v4 offset:12288
    v_mfma_f32_16x16x32_bf16 v[228:231], v[148:151], v[48:51], v[228:231]
    ds_read_b128 v[128:131], v4 offset:13312
    v_mfma_f32_16x16x32_bf16 v[232:235], v[152:155], v[48:51], v[232:235]
    ds_read_b128 v[132:135], v4 offset:14336
    buffer_load_dwordx4 a[64:67], v11, s[32:35], s89 offen offset:1024 sc1
    s_waitcnt lgkmcnt(8)
    v_mfma_f32_16x16x32_bf16 v[236:239], v[156:159], v[48:51], v[236:239]
    ds_read_b128 v[136:139], v4 offset:15360
    v_mfma_f32_16x16x32_bf16 v[240:243], v[160:163], v[48:51], v[240:243]
    ds_read_b128 v[140:143], v4 offset:16384
    s_waitcnt vmcnt(12)
    s_waitcnt lgkmcnt(7)
    v_mfma_f32_16x16x32_bf16 v[224:227], v[104:107], v[52:55], v[224:227]
    ds_read_b128 v[144:147], v4 offset:17408
    v_mfma_f32_16x16x32_bf16 v[228:231], v[108:111], v[52:55], v[228:231]
    ds_read_b128 v[148:151], v4 offset:18432
    v_mfma_f32_16x16x32_bf16 v[232:235], v[112:115], v[52:55], v[232:235]
    ds_read_b128 v[152:155], v4 offset:19456
    buffer_load_dwordx4 a[68:71], v11, s[32:35], s89 offen offset:2048 sc1
    s_waitcnt lgkmcnt(8)
    v_mfma_f32_16x16x32_bf16 v[236:239], v[116:119], v[52:55], v[236:239]
    ds_read_b128 v[156:159], v4 offset:20480
    v_mfma_f32_16x16x32_bf16 v[240:243], v[120:123], v[52:55], v[240:243]
    ds_read_b128 v[160:163], v4 offset:21504
    s_waitcnt vmcnt(12)
    s_waitcnt lgkmcnt(7)
    v_mfma_f32_16x16x32_bf16 v[224:227], v[124:127], v[56:59], v[224:227]
    ds_read_b128 v[104:107], v4 offset:22528
    v_mfma_f32_16x16x32_bf16 v[228:231], v[128:131], v[56:59], v[228:231]
    ds_read_b128 v[108:111], v4 offset:23552
    v_mfma_f32_16x16x32_bf16 v[232:235], v[132:135], v[56:59], v[232:235]
    ds_read_b128 v[112:115], v4 offset:24576
    buffer_load_dwordx4 a[72:75], v11, s[32:35], s89 offen offset:3072 sc1
    s_waitcnt lgkmcnt(8)
    v_mfma_f32_16x16x32_bf16 v[236:239], v[136:139], v[56:59], v[236:239]
    ds_read_b128 v[116:119], v4 offset:25600
    v_mfma_f32_16x16x32_bf16 v[240:243], v[140:143], v[56:59], v[240:243]
    ds_read_b128 v[120:123], v4 offset:26624
    s_waitcnt vmcnt(12)
    s_waitcnt lgkmcnt(7)
    v_mfma_f32_16x16x32_bf16 v[224:227], v[144:147], v[60:63], v[224:227]
    ds_read_b128 v[124:127], v4 offset:27648
    v_mfma_f32_16x16x32_bf16 v[228:231], v[148:151], v[60:63], v[228:231]
    ds_read_b128 v[128:131], v4 offset:28672
    v_mfma_f32_16x16x32_bf16 v[232:235], v[152:155], v[60:63], v[232:235]
    ds_read_b128 v[132:135], v4 offset:29696
    s_mov_b32 s89, 19456
    buffer_load_dwordx4 a[76:79], v11, s[32:35], s89 offen offset:0 sc1
    s_waitcnt lgkmcnt(8)
    v_mfma_f32_16x16x32_bf16 v[236:239], v[156:159], v[60:63], v[236:239]
    ds_read_b128 v[136:139], v4 offset:30720
    v_mfma_f32_16x16x32_bf16 v[240:243], v[160:163], v[60:63], v[240:243]
    ds_read_b128 v[140:143], v4 offset:31744
    s_waitcnt vmcnt(12)
    s_waitcnt lgkmcnt(7)
    v_mfma_f32_16x16x32_bf16 v[224:227], v[104:107], v[64:67], v[224:227]
    ds_read_b128 v[144:147], v4 offset:32768
    v_mfma_f32_16x16x32_bf16 v[228:231], v[108:111], v[64:67], v[228:231]
    ds_read_b128 v[148:151], v4 offset:33792
    v_mfma_f32_16x16x32_bf16 v[232:235], v[112:115], v[64:67], v[232:235]
    ds_read_b128 v[152:155], v4 offset:34816
    buffer_load_dwordx4 a[80:83], v11, s[32:35], s89 offen offset:1024 sc1
    s_waitcnt lgkmcnt(8)
    v_mfma_f32_16x16x32_bf16 v[236:239], v[116:119], v[64:67], v[236:239]
    ds_read_b128 v[156:159], v4 offset:35840
    v_mfma_f32_16x16x32_bf16 v[240:243], v[120:123], v[64:67], v[240:243]
    ds_read_b128 v[160:163], v4 offset:36864
    s_waitcnt vmcnt(12)
    s_waitcnt lgkmcnt(7)
    v_mfma_f32_16x16x32_bf16 v[224:227], v[124:127], v[68:71], v[224:227]
    ds_read_b128 v[104:107], v5 offset:0
    v_mfma_f32_16x16x32_bf16 v[228:231], v[128:131], v[68:71], v[228:231]
    ds_read_b128 v[108:111], v5 offset:1024
    v_mfma_f32_16x16x32_bf16 v[232:235], v[132:135], v[68:71], v[232:235]
    ds_read_b128 v[112:115], v5 offset:2048
    buffer_load_dwordx4 a[84:87], v11, s[32:35], s89 offen offset:2048 sc1
    s_waitcnt lgkmcnt(8)
    v_mfma_f32_16x16x32_bf16 v[236:239], v[136:139], v[68:71], v[236:239]
    ds_read_b128 v[116:119], v5 offset:3072
    v_mfma_f32_16x16x32_bf16 v[240:243], v[140:143], v[68:71], v[240:243]
    ds_read_b128 v[120:123], v5 offset:4096
    s_waitcnt vmcnt(12)
    s_waitcnt lgkmcnt(7)
    v_mfma_f32_16x16x32_bf16 v[224:227], v[144:147], v[72:75], v[224:227]
    ds_read_b128 v[124:127], v5 offset:5120
    v_mfma_f32_16x16x32_bf16 v[228:231], v[148:151], v[72:75], v[228:231]
    ds_read_b128 v[128:131], v5 offset:6144
    v_mfma_f32_16x16x32_bf16 v[232:235], v[152:155], v[72:75], v[232:235]
    ds_read_b128 v[132:135], v5 offset:7168
    buffer_load_dwordx4 a[88:91], v11, s[32:35], s89 offen offset:3072 sc1
    s_waitcnt lgkmcnt(8)
    v_mfma_f32_16x16x32_bf16 v[236:239], v[156:159], v[72:75], v[236:239]
    ds_read_b128 v[136:139], v5 offset:8192
    v_mfma_f32_16x16x32_bf16 v[240:243], v[160:163], v[72:75], v[240:243]
    ds_read_b128 v[140:143], v5 offset:9216
    s_waitcnt vmcnt(12)
    s_waitcnt lgkmcnt(7)
    v_mfma_f32_16x16x32_bf16 v[224:227], v[104:107], v[76:79], v[224:227]
    ds_read_b128 v[144:147], v5 offset:10240
    v_mfma_f32_16x16x32_bf16 v[228:231], v[108:111], v[76:79], v[228:231]
    ds_read_b128 v[148:151], v5 offset:11264
    v_mfma_f32_16x16x32_bf16 v[232:235], v[112:115], v[76:79], v[232:235]
    ds_read_b128 v[152:155], v5 offset:12288
    s_mov_b32 s89, 23552
    buffer_load_dwordx4 a[92:95], v11, s[32:35], s89 offen offset:0 sc1
    s_waitcnt lgkmcnt(8)
    v_mfma_f32_16x16x32_bf16 v[236:239], v[116:119], v[76:79], v[236:239]
    ds_read_b128 v[156:159], v5 offset:13312
    v_mfma_f32_16x16x32_bf16 v[240:243], v[120:123], v[76:79], v[240:243]
    ds_read_b128 v[160:163], v5 offset:14336
    s_waitcnt vmcnt(12)
    s_waitcnt lgkmcnt(7)
    v_mfma_f32_16x16x32_bf16 v[224:227], v[124:127], v[80:83], v[224:227]
    ds_read_b128 v[104:107], v5 offset:15360
    v_mfma_f32_16x16x32_bf16 v[228:231], v[128:131], v[80:83], v[228:231]
    ds_read_b128 v[108:111], v5 offset:16384
    v_mfma_f32_16x16x32_bf16 v[232:235], v[132:135], v[80:83], v[232:235]
    ds_read_b128 v[112:115], v5 offset:17408
    buffer_load_dwordx4 a[96:99], v11, s[32:35], s89 offen offset:1024 sc1
    s_waitcnt lgkmcnt(8)
    v_mfma_f32_16x16x32_bf16 v[236:239], v[136:139], v[80:83], v[236:239]
    ds_read_b128 v[116:119], v5 offset:18432
    v_mfma_f32_16x16x32_bf16 v[240:243], v[140:143], v[80:83], v[240:243]
    ds_read_b128 v[120:123], v5 offset:19456
    s_waitcnt vmcnt(12)
    s_waitcnt lgkmcnt(7)
    v_mfma_f32_16x16x32_bf16 v[224:227], v[144:147], v[84:87], v[224:227]
    ds_read_b128 v[124:127], v5 offset:20480
    v_mfma_f32_16x16x32_bf16 v[228:231], v[148:151], v[84:87], v[228:231]
    ds_read_b128 v[128:131], v5 offset:21504
    v_mfma_f32_16x16x32_bf16 v[232:235], v[152:155], v[84:87], v[232:235]
    ds_read_b128 v[132:135], v5 offset:22528
    buffer_load_dwordx4 a[100:103], v11, s[32:35], s89 offen offset:2048 sc1
    s_waitcnt lgkmcnt(8)
    v_mfma_f32_16x16x32_bf16 v[236:239], v[156:159], v[84:87], v[236:239]
    ds_read_b128 v[136:139], v5 offset:23552
    v_mfma_f32_16x16x32_bf16 v[240:243], v[160:163], v[84:87], v[240:243]
    ds_read_b128 v[140:143], v5 offset:24576
    s_waitcnt vmcnt(12)
    s_waitcnt lgkmcnt(7)
    v_mfma_f32_16x16x32_bf16 v[224:227], v[104:107], v[88:91], v[224:227]
    v_mfma_f32_16x16x32_bf16 v[228:231], v[108:111], v[88:91], v[228:231]
    v_mfma_f32_16x16x32_bf16 v[232:235], v[112:115], v[88:91], v[232:235]
    buffer_load_dwordx4 a[104:107], v11, s[32:35], s89 offen offset:3072 sc1
    s_waitcnt lgkmcnt(5)
    v_mfma_f32_16x16x32_bf16 v[236:239], v[116:119], v[88:91], v[236:239]
    v_mfma_f32_16x16x32_bf16 v[240:243], v[120:123], v[88:91], v[240:243]
    s_waitcnt vmcnt(12)
    s_waitcnt lgkmcnt(2)
    v_mfma_f32_16x16x32_bf16 v[224:227], v[124:127], v[92:95], v[224:227]
    v_mfma_f32_16x16x32_bf16 v[228:231], v[128:131], v[92:95], v[228:231]
    v_mfma_f32_16x16x32_bf16 v[232:235], v[132:135], v[92:95], v[232:235]
    s_mov_b32 s89, 27648
    buffer_load_dwordx4 a[108:111], v11, s[32:35], s89 offen offset:0 sc1
    s_waitcnt lgkmcnt(0)
    v_mfma_f32_16x16x32_bf16 v[236:239], v[136:139], v[92:95], v[236:239]
    v_mfma_f32_16x16x32_bf16 v[240:243], v[140:143], v[92:95], v[240:243]
    s_nop 0
    v_pk_fma_f32 v[224:225], v[224:225], v[164:165], v[204:205]
    v_pk_fma_f32 v[226:227], v[226:227], v[166:167], v[206:207]
    v_pk_fma_f32 v[228:229], v[228:229], v[168:169], v[208:209]
    v_pk_fma_f32 v[230:231], v[230:231], v[170:171], v[210:211]
    v_pk_fma_f32 v[232:233], v[232:233], v[172:173], v[212:213]
    v_pk_fma_f32 v[234:235], v[234:235], v[174:175], v[214:215]
    v_pk_fma_f32 v[236:237], v[236:237], v[176:177], v[216:217]
    v_pk_fma_f32 v[238:239], v[238:239], v[178:179], v[218:219]
    v_pk_fma_f32 v[240:241], v[240:241], v[180:181], v[220:221]
    v_pk_fma_f32 v[242:243], v[242:243], v[182:183], v[222:223]
    v_pk_mul_f32 v[184:185], v[184:185], v[224:225]
    v_pk_mul_f32 v[186:187], v[186:187], v[226:227]
    v_pk_mul_f32 v[188:189], v[188:189], v[228:229]
    v_pk_mul_f32 v[190:191], v[190:191], v[230:231]
    v_pk_mul_f32 v[192:193], v[192:193], v[232:233]
    v_pk_mul_f32 v[194:195], v[194:195], v[234:235]
    v_pk_mul_f32 v[196:197], v[196:197], v[236:237]
    v_pk_mul_f32 v[198:199], v[198:199], v[238:239]
    v_pk_mul_f32 v[200:201], v[200:201], v[240:241]
    v_pk_mul_f32 v[202:203], v[202:203], v[242:243]
    v_cvt_pk_bf16_f32 v16, v184, v185
    v_cvt_pk_bf16_f32 v17, v186, v187
    v_cvt_pk_bf16_f32 v18, v188, v189
    v_cvt_pk_bf16_f32 v19, v190, v191
    v_cvt_pk_bf16_f32 v20, v192, v193
    v_cvt_pk_bf16_f32 v21, v194, v195
    v_cvt_pk_bf16_f32 v22, v196, v197
    v_cvt_pk_bf16_f32 v23, v198, v199
    v_cvt_pk_bf16_f32 v24, v200, v201
    v_cvt_pk_bf16_f32 v25, v202, v203
    v_mov_b32 v26, v24
    v_mov_b32 v27, v25
    v_permlane16_swap_b32 v16, v18
    v_permlane16_swap_b32 v17, v19
    v_permlane16_swap_b32 v20, v22
    v_permlane16_swap_b32 v21, v23
    v_permlane16_swap_b32 v24, v26
    v_permlane16_swap_b32 v25, v27
    buffer_store_dwordx4 v[16:19], v9, s[32:35], 0 offen offset:0 sc1
    s_mov_b32 s89, 4096
    buffer_store_dwordx4 v[20:23], v9, s[32:35], s89 offen offset:0 sc1
    s_mov_b32 s89, 8192
    buffer_store_dwordx4 v[24:27], v10, s[32:35], s89 offen offset:0 sc1
    s_lshl_b32 s3, s81, 12
    s_add_u32 s3, s3, 7864320
    s_lshl_b32 s2, s80, 10
    s_add_u32 s3, s3, s2
    v_and_b32 v7, 7, v0
    v_lshl_add_u32 v7, v7, 7, s3
    s_lshl_b32 s3, s83, 10
    s_lshl_b32 s2, s26, 8
    s_add_u32 s3, s3, s2
    s_add_u32 s3, s3, 7340032
    v_add_u32 v8, s3, v1
    s_mul_i32 s3, s81, 81920
    s_mul_i32 s2, s80, 20480
    s_add_u32 s3, s3, s2
    s_add_u32 s3, s3, 4194304
    v_add_u32 v3, s3, v1
    s_mul_i32 s2, s80, 20480
    s_add_u32 s67, s2, 61440
    v_add_u32 v12, 61440, v1
    v_add_u32 v13, 40960, v12
    s_lshl_b32 s3, s81, 13
    s_add_u32 s3, s3, 7340032
    v_and_b32 v14, 31, v0
    v_lshl_add_u32 v6, v14, 4, s3
    v_lshrrev_b32 v14, 5, v0
    v_lshl_add_u32 v6, v14, 12, v6
    s_mul_i32 s3, s82, 48
    s_mul_i32 s2, s80, 12
    s_add_u32 s3, s3, s2
    s_mul_i32 s3, s3, 5120
    s_add_u32 s3, s3, 23068672
    v_add_u32 v15, s3, v1
    s_lshl_b32 s3, s81, 12
    s_add_u32 s3, s3, 7864320
    s_lshl_b32 s2, s82, 9
    s_lshl_b32 s66, s80, 7
    s_add_u32 s3, s3, s2
    s_add_u32 s3, s3, s66
    v_mov_b32 v5, s3
    s_mov_b32 s89, 28672
    buffer_load_dwordx4 a[112:115], v11, s[32:35], s89 offen offset:0 sc1
    buffer_load_dwordx4 a[116:119], v11, s[32:35], s89 offen offset:1024 sc1
    buffer_load_dwordx4 a[120:123], v11, s[32:35], s89 offen offset:2048 sc1
    buffer_load_dwordx4 a[124:127], v11, s[32:35], s89 offen offset:3072 sc1
    s_mov_b32 s89, 32768
    buffer_load_dwordx4 a[128:131], v11, s[32:35], s89 offen offset:0 sc1
    buffer_load_dwordx4 a[132:135], v11, s[32:35], s89 offen offset:1024 sc1
    s_mov_b64 exec, 1
    s_waitcnt vmcnt(6)
    v_mov_b32 v14, s84
    buffer_store_dword v14, v5, s[32:35], 0 offen sc1
    s_mov_b64 exec, -1
    v_cvt_pk_bf16_f32 v246, v224, v225
    v_cvt_pk_bf16_f32 v247, v226, v227
    v_cvt_pk_bf16_f32 v248, v228, v229
    v_cvt_pk_bf16_f32 v249, v230, v231
    v_cvt_pk_bf16_f32 v250, v232, v233
    v_cvt_pk_bf16_f32 v251, v234, v235
    v_cvt_pk_bf16_f32 v252, v236, v237
    v_cvt_pk_bf16_f32 v253, v238, v239
    v_cvt_pk_bf16_f32 v254, v240, v241
    v_cvt_pk_bf16_f32 v255, v242, v243
    v_pk_add_f32 v[28:29], v[224:225], v[226:227]
    v_pk_mul_f32 v[30:31], v[224:225], v[224:225]
    v_pk_fma_f32 v[30:31], v[226:227], v[226:227], v[30:31]
    v_pk_add_f32 v[28:29], v[28:29], v[228:229]
    v_pk_fma_f32 v[30:31], v[228:229], v[228:229], v[30:31]
    v_pk_add_f32 v[28:29], v[28:29], v[230:231]
    v_pk_fma_f32 v[30:31], v[230:231], v[230:231], v[30:31]
    v_pk_add_f32 v[28:29], v[28:29], v[232:233]
    v_pk_fma_f32 v[30:31], v[232:233], v[232:233], v[30:31]
    v_pk_add_f32 v[28:29], v[28:29], v[234:235]
    v_pk_fma_f32 v[30:31], v[234:235], v[234:235], v[30:31]
    v_pk_add_f32 v[28:29], v[28:29], v[236:237]
    v_pk_fma_f32 v[30:31], v[236:237], v[236:237], v[30:31]
    v_pk_add_f32 v[28:29], v[28:29], v[238:239]
    v_pk_fma_f32 v[30:31], v[238:239], v[238:239], v[30:31]
    v_pk_add_f32 v[28:29], v[28:29], v[240:241]
    v_pk_fma_f32 v[30:31], v[240:241], v[240:241], v[30:31]
    v_pk_add_f32 v[28:29], v[28:29], v[242:243]
    v_pk_fma_f32 v[30:31], v[242:243], v[242:243], v[30:31]
    v_add_f32 v28, v28, v29
    v_add_f32 v29, v30, v31
    s_nop 1
    v_permlane32_swap_b32 v28, v29
    v_add_f32 v28, v28, v29
    v_mov_b32 v29, v28
    s_nop 1
    v_permlane16_swap_b32 v28, v29
    v_add_f32 v28, v28, v29
    v_mov_b32 v30, v28
    v_mov_b32 v29, s84
    v_mov_b32 v31, s84
    v_permlane32_swap_b32 v28, v30
    s_mov_b64 exec, 0xffff
    buffer_store_dwordx4 v[28:31], v8, s[32:35], 0 offen offset:0 sc1
    s_mov_b64 exec, -1
    buffer_load_dwordx4 a[136:139], v11, s[32:35], s89 offen offset:2048 sc1
    buffer_load_dwordx4 a[140:143], v11, s[32:35], s89 offen offset:3072 sc1
    s_mov_b32 s89, 36864
    buffer_load_dwordx4 a[144:147], v11, s[32:35], s89 offen offset:0 sc1
    buffer_load_dwordx4 a[148:151], v11, s[32:35], s89 offen offset:1024 sc1
    buffer_load_dwordx4 a[152:155], v11, s[32:35], s89 offen offset:2048 sc1
    buffer_load_dwordx4 a[156:159], v11, s[32:35], s89 offen offset:3072 sc1
    s_mov_b32 s89, 40960
    buffer_load_dwordx4 a[160:163], v11, s[32:35], s89 offen offset:0 sc1
    buffer_load_dwordx4 a[164:167], v11, s[32:35], s89 offen offset:1024 sc1
    buffer_load_dwordx4 a[168:171], v11, s[32:35], s89 offen offset:2048 sc1
    buffer_load_dwordx4 a[172:175], v11, s[32:35], s89 offen offset:3072 sc1
    s_mov_b32 s89, 45056
    buffer_load_dwordx4 a[176:179], v11, s[32:35], s89 offen offset:0 sc1
    buffer_load_dwordx4 a[180:183], v11, s[32:35], s89 offen offset:1024 sc1
    s_barrier
    v_add_u32 v4, 512, v7
    s_mov_b32 s88, 400000
L_poll_39:
    s_mov_b64 exec, 0xf
    buffer_load_dword v14, v7, s[32:35], 0 offen sc1
    s_sub_u32 s88, s88, 1
    s_cbranch_scc1 L_end
    s_waitcnt vmcnt(0)
    v_cmp_ne_u32 vcc, s84, v14
    s_cbranch_vccnz L_poll_39
    s_mov_b64 exec, -1
    s_mov_b64 exec, 0xf
    buffer_load_dword v5, v4, s[32:35], 0 offen sc1
    s_mov_b64 exec, -1
    s_add_u32 m0, s67, 0
    s_nop 0
    buffer_load_dwordx4 v3, s[32:35], 0 offen sc1 lds
    s_mov_b32 s89, 1024
    s_add_u32 m0, s67, 1024
    s_nop 0
    buffer_load_dwordx4 v3, s[32:35], s89 offen sc1 lds
    s_mov_b32 s89, 2048
    s_add_u32 m0, s67, 2048
    s_nop 0
    buffer_load_dwordx4 v3, s[32:35], s89 offen sc1 lds
    s_mov_b32 s89, 3072
    s_add_u32 m0, s67, 3072
    s_nop 0
    buffer_load_dwordx4 v3, s[32:35], s89 offen sc1 lds
    s_mov_b32 s98, s67
    v_mov_b32 v2, v3
    s_mov_b32 s89, 47104
    buffer_load_dwordx4 a[184:187], v11, s[32:35], s89 offen offset:0 sc1
    buffer_load_dwordx4 a[188:191], v11, s[32:35], s89 offen offset:1024 sc1
    buffer_load_dwordx4 a[192:195], v11, s[32:35], s89 offen offset:2048 sc1
    buffer_load_dwordx4 a[196:199], v11, s[32:35], s89 offen offset:3072 sc1
    s_mov_b32 s89, 51200
    buffer_load_dwordx4 a[200:203], v11, s[32:35], s89 offen offset:0 sc1
    buffer_load_dwordx4 a[204:207], v11, s[32:35], s89 offen offset:1024 sc1
    s_mov_b32 s27, 4096
    s_add_u32 m0, s98, 4096
    s_nop 0
    buffer_load_dwordx4 v2, s[32:35], s27 offen sc1 lds
    s_mov_b32 s27, 5120
    s_add_u32 m0, s98, 5120
    s_nop 0
    buffer_load_dwordx4 v2, s[32:35], s27 offen sc1 lds
    s_mov_b32 s27, 6144
    s_add_u32 m0, s98, 6144
    s_nop 0
    buffer_load_dwordx4 v2, s[32:35], s27 offen sc1 lds
    s_mov_b32 s27, 7168
    s_add_u32 m0, s98, 7168
    s_nop 0
    buffer_load_dwordx4 v2, s[32:35], s27 offen sc1 lds
    s_mov_b32 s27, 8192
    s_add_u32 m0, s98, 8192
    s_nop 0
    buffer_load_dwordx4 v2, s[32:35], s27 offen sc1 lds
    s_mov_b32 s27, 9216
    s_add_u32 m0, s98, 9216
    s_nop 0
    buffer_load_dwordx4 v2, s[32:35], s27 offen sc1 lds
    s_waitcnt vmcnt(12)
    s_barrier
    ds_read_b128 v[112:115], v12 offset:0
    ds_read_b128 v[116:119], v12 offset:1024
    s_mov_b32 s92, 0
    s_mov_b32 s93, -1
    s_waitcnt lgkmcnt(0)
    v_mfma_f32_32x32x16_bf16 v[16:31], a[0:3], v[112:115], 0
    ds_read_b128 v[120:123], v12 offset:2048
    v_mfma_f32_32x32x16_bf16 v[32:47], a[0:3], v[116:119], 0
    ds_read_b128 v[124:127], v12 offset:3072
    buffer_load_dwordx4 a[208:211], v11, s[32:35], s89 offen offset:2048 sc1
    v_mfma_f32_32x32x16_bf16 v[48:63], a[4:7], v[112:115], 0
    v_mov_b32 v205, v245
    v_add_u32 v205, 32768, v205
    buffer_load_dword v204, v205, s[32:35], 0 offen sc1
    buffer_load_dwordx4 v[164:167], v6, s[32:35], 0 offen offset:0 sc1
    buffer_load_dwordx4 v[168:171], v6, s[32:35], 0 offen offset:1024 sc1
    buffer_load_dwordx4 v[172:175], v6, s[32:35], 0 offen offset:2048 sc1
    buffer_load_dwordx4 v[176:179], v6, s[32:35], 0 offen offset:3072 sc1
    buffer_load_dwordx4 v[180:183], v6, s[32:35], 0 offen offset:512 sc1
    buffer_load_dwordx4 v[184:187], v6, s[32:35], 0 offen offset:1536 sc1
    buffer_load_dwordx4 v[188:191], v6, s[32:35], 0 offen offset:2560 sc1
    buffer_load_dwordx4 v[192:195], v6, s[32:35], 0 offen offset:3584 sc1
    v_mfma_f32_32x32x16_bf16 v[64:79], a[4:7], v[116:119], 0
    buffer_load_dwordx4 a[212:215], v11, s[32:35], s89 offen offset:3072 sc1
    v_mfma_f32_32x32x16_bf16 v[80:95], a[8:11], v[112:115], 0
    v_mfma_f32_32x32x16_bf16 v[96:111], a[8:11], v[116:119], 0
    s_waitcnt lgkmcnt(0)
    v_mfma_f32_32x32x16_bf16 v[16:31], a[12:15], v[120:123], v[16:31]
    ds_read_b128 v[112:115], v12 offset:20480
    v_mfma_f32_32x32x16_bf16 v[32:47], a[12:15], v[124:127], v[32:47]
    ds_read_b128 v[116:119], v12 offset:21504
    s_mov_b64 exec, 0xf
    v_cmp_ne_u32 vcc, s84, v5
    s_mov_b64 exec, -1
    s_cbranch_vccz L_ptok_41
    s_mov_b32 s88, 400000
L_poll_42:
    s_mov_b64 exec, 0xf
    buffer_load_dword v5, v4, s[32:35], 0 offen sc1
    s_sub_u32 s88, s88, 1
    s_cbranch_scc1 L_end
    s_waitcnt vmcnt(0)
    v_cmp_ne_u32 vcc, s84, v5
    s_cbranch_vccnz L_poll_42
    s_mov_b64 exec, -1
L_ptok_41:
    s_mov_b32 s27, 10240
    s_add_u32 m0, s98, 10240
    s_nop 0
    buffer_load_dwordx4 v2, s[32:35], s27 offen sc1 lds
    v_mfma_f32_32x32x16_bf16 v[48:63], a[16:19], v[120:123], v[48:63]
    v_mfma_f32_32x32x16_bf16 v[64:79], a[16:19], v[124:127], v[64:79]
    s_mov_b32 s27, 11264
    s_add_u32 m0, s98, 11264
    s_nop 0
    buffer_load_dwordx4 v2, s[32:35], s27 offen sc1 lds
    v_mfma_f32_32x32x16_bf16 v[80:95], a[20:23], v[120:123], v[80:95]
    v_mfma_f32_32x32x16_bf16 v[96:111], a[20:23], v[124:127], v[96:111]
    s_mov_b32 s27, 12288
    s_add_u32 m0, s98, 12288
    s_nop 0
    buffer_load_dwordx4 v2, s[32:35], s27 offen sc1 lds
    s_waitcnt lgkmcnt(0)
    v_mfma_f32_32x32x16_bf16 v[16:31], a[24:27], v[112:115], v[16:31]
    ds_read_b128 v[120:123], v12 offset:22528
    v_mfma_f32_32x32x16_bf16 v[32:47], a[24:27], v[116:119], v[32:47]
    ds_read_b128 v[124:127], v12 offset:23552
    s_mov_b32 s27, 13312
    s_add_u32 m0, s98, 13312
    s_nop 0
    buffer_load_dwordx4 v2, s[32:35], s27 offen sc1 lds
    v_mfma_f32_32x32x16_bf16 v[48:63], a[28:31], v[112:115], v[48:63]
    v_mfma_f32_32x32x16_bf16 v[64:79], a[28:31], v[116:119], v[64:79]
    s_mov_b32 s27, 14336
    s_add_u32 m0, s98, 14336
    s_nop 0
    buffer_load_dwordx4 v2, s[32:35], s27 offen sc1 lds
    v_mfma_f32_32x32x16_bf16 v[80:95], a[32:35], v[112:115], v[80:95]
    v_mfma_f32_32x32x16_bf16 v[96:111], a[32:35], v[116:119], v[96:111]
    s_mov_b32 s27, 15360
    s_add_u32 m0, s98, 15360
    s_nop 0
    buffer_load_dwordx4 v2, s[32:35], s27 offen sc1 lds
    s_waitcnt lgkmcnt(0)
    v_mfma_f32_32x32x16_bf16 v[16:31], a[36:39], v[120:123], v[16:31]
    ds_read_b128 v[112:115], v13 offset:0
    v_mfma_f32_32x32x16_bf16 v[32:47], a[36:39], v[124:127], v[32:47]
    ds_read_b128 v[116:119], v13 offset:1024
    s_mov_b32 s27, 16384
    s_add_u32 m0, s98, 16384
    s_nop 0
    buffer_load_dwordx4 v2, s[32:35], s27 offen sc1 lds
    v_mfma_f32_32x32x16_bf16 v[48:63], a[40:43], v[120:123], v[48:63]
    v_mfma_f32_32x32x16_bf16 v[64:79], a[40:43], v[124:127], v[64:79]
    s_mov_b32 s27, 17408
    s_add_u32 m0, s98, 17408
    s_nop 0
    buffer_load_dwordx4 v2, s[32:35], s27 offen sc1 lds
    v_mfma_f32_32x32x16_bf16 v[80:95], a[44:47], v[120:123], v[80:95]
    v_mfma_f32_32x32x16_bf16 v[96:111], a[44:47], v[124:127], v[96:111]
    s_waitcnt lgkmcnt(0)
    v_mfma_f32_32x32x16_bf16 v[16:31], a[48:51], v[112:115], v[16:31]
    ds_read_b128 v[120:123], v13 offset:2048
    v_mfma_f32_32x32x16_bf16 v[32:47], a[48:51], v[116:119], v[32:47]
    ds_read_b128 v[124:127], v13 offset:3072
    s_mov_b32 s27, 18432
    s_add_u32 m0, s98, 18432
    s_nop 0
    buffer_load_dwordx4 v2, s[32:35], s27 offen sc1 lds
    v_mfma_f32_32x32x16_bf16 v[48:63], a[52:55], v[112:115], v[48:63]
    v_mfma_f32_32x32x16_bf16 v[64:79], a[52:55], v[116:119], v[64:79]
    s_mov_b32 s27, 19456
    s_add_u32 m0, s98, 19456
    s_nop 0
    buffer_load_dwordx4 v2, s[32:35], s27 offen sc1 lds
    v_mfma_f32_32x32x16_bf16 v[80:95], a[56:59], v[112:115], v[80:95]
    v_mfma_f32_32x32x16_bf16 v[96:111], a[56:59], v[116:119], v[96:111]
    s_mov_b32 s89, 55296
    buffer_load_dwordx4 a[216:219], v11, s[32:35], s89 offen offset:0 sc1
    s_waitcnt lgkmcnt(0)
    v_mfma_f32_32x32x16_bf16 v[16:31], a[60:63], v[120:123], v[16:31]
    ds_read_b128 v[112:115], v13 offset:20480
    v_mfma_f32_32x32x16_bf16 v[32:47], a[60:63], v[124:127], v[32:47]
    ds_read_b128 v[116:119], v13 offset:21504
    buffer_load_dwordx4 a[220:223], v11, s[32:35], s89 offen offset:1024 sc1
    v_mfma_f32_32x32x16_bf16 v[48:63], a[64:67], v[120:123], v[48:63]
    s_waitcnt vmcnt(13)
    s_mov_b32 s88, 400000
L_stchk_44:
    v_min_u32 v196, v165, v167
    v_max_u32 v197, v165, v167
    v_min3_u32 v196, v196, v169, v171
    v_max3_u32 v197, v197, v169, v171
    v_min3_u32 v196, v196, v173, v175
    v_max3_u32 v197, v197, v173, v175
    v_min3_u32 v196, v196, v177, v179
    v_max3_u32 v197, v197, v177, v179
    v_min3_u32 v196, v196, v181, v183
    v_max3_u32 v197, v197, v181, v183
    v_min3_u32 v196, v196, v185, v187
    v_max3_u32 v197, v197, v185, v187
    v_min3_u32 v196, v196, v189, v191
    v_max3_u32 v197, v197, v189, v191
    v_min3_u32 v196, v196, v193, v195
    v_max3_u32 v197, v197, v193, v195
    v_cmp_ne_u32 vcc, s84, v196
    v_cmp_ne_u32 s[96:97], s84, v197
    s_or_b64 vcc, vcc, s[96:97]
    s_cbranch_vccz L_stok_45
    s_sub_u32 s88, s88, 1
    s_cbranch_scc1 L_end
    s_waitcnt vmcnt(0)
    buffer_load_dwordx4 v[164:167], v6, s[32:35], 0 offen offset:0 sc1
    buffer_load_dwordx4 v[168:171], v6, s[32:35], 0 offen offset:1024 sc1
    buffer_load_dwordx4 v[172:175], v6, s[32:35], 0 offen offset:2048 sc1
    buffer_load_dwordx4 v[176:179], v6, s[32:35], 0 offen offset:3072 sc1
    buffer_load_dwordx4 v[180:183], v6, s[32:35], 0 offen offset:512 sc1
    buffer_load_dwordx4 v[184:187], v6, s[32:35], 0 offen offset:1536 sc1
    buffer_load_dwordx4 v[188:191], v6, s[32:35], 0 offen offset:2560 sc1
    buffer_load_dwordx4 v[192:195], v6, s[32:35], 0 offen offset:3584 sc1
    s_waitcnt vmcnt(0)
    s_branch L_stchk_44
L_stok_45:
    v_add_f32 v128, v164, v168
    v_add_f32 v129, v166, v170
    v_add_f32 v132, v172, v176
    v_mfma_f32_32x32x16_bf16 v[64:79], a[64:67], v[124:127], v[64:79]
    s_mov_b32 s89, 57344
    buffer_load_dwordx4 a[224:227], v11, s[32:35], s89 offen offset:0 sc1
    v_mfma_f32_32x32x16_bf16 v[80:95], a[68:71], v[120:123], v[80:95]
    v_add_f32 v133, v174, v178
    v_add_f32 v128, v128, v132
    v_add_f32 v129, v129, v133
    v_mov_b32 v130, v128
    v_mfma_f32_32x32x16_bf16 v[96:111], a[68:71], v[124:127], v[96:111]
    buffer_load_dwordx4 a[228:231], v11, s[32:35], s89 offen offset:1024 sc1
    s_waitcnt lgkmcnt(0)
    v_mfma_f32_32x32x16_bf16 v[16:31], a[72:75], v[112:115], v[16:31]
    ds_read_b128 v[120:123], v13 offset:22528
    v_mfma_f32_32x32x16_bf16 v[32:47], a[72:75], v[116:119], v[32:47]
    ds_read_b128 v[124:127], v13 offset:23552
    buffer_load_dwordx4 a[232:235], v11, s[32:35], s89 offen offset:2048 sc1
    v_mfma_f32_32x32x16_bf16 v[48:63], a[76:79], v[112:115], v[48:63]
    v_mov_b32 v131, v129
    v_permlane32_swap_b32 v128, v130
    s_nop 0
    v_permlane32_swap_b32 v129, v131
    v_add_f32 v128, v128, v130
    v_mfma_f32_32x32x16_bf16 v[64:79], a[76:79], v[116:119], v[64:79]
    buffer_load_dwordx4 a[236:239], v11, s[32:35], s89 offen offset:3072 sc1
    v_mfma_f32_32x32x16_bf16 v[80:95], a[80:83], v[112:115], v[80:95]
    v_add_f32 v129, v129, v131
    v_mul_f32 v128, 0x3acccccd, v128
    v_mul_f32 v129, 0x3acccccd, v129
    v_fma_f32 v129, -v128, v128, v129
    v_mfma_f32_32x32x16_bf16 v[96:111], a[80:83], v[116:119], v[96:111]
    s_waitcnt lgkmcnt(0)
    s_barrier
    v_mfma_f32_32x32x16_bf16 v[16:31], a[84:87], v[120:123], v[16:31]
    ds_read_b128 v[112:115], v12 offset:4096
    v_mfma_f32_32x32x16_bf16 v[32:47], a[84:87], v[124:127], v[32:47]
    ds_read_b128 v[116:119], v12 offset:5120
    s_mov_b32 s89, 61440
    buffer_load_dwordx4 a[0:3], v11, s[32:35], s89 offen offset:0 sc1
    v_mfma_f32_32x32x16_bf16 v[48:63], a[88:91], v[120:123], v[48:63]
    v_max_f32 v129, 0, v129
    v_add_f32 v129, 0x3727c5ac, v129
    v_rsq_f32 v130, v129
    v_sub_f32 v128, 0, v128
    v_mfma_f32_32x32x16_bf16 v[64:79], a[88:91], v[124:127], v[64:79]
    buffer_load_dwordx4 a[4:7], v11, s[32:35], s89 offen offset:1024 sc1
    v_mfma_f32_32x32x16_bf16 v[80:95], a[92:95], v[120:123], v[80:95]
    v_mul_f32 v131, v129, v130
    v_cndmask_b32 v131, v128, v131, s[92:93]
    v_cvt_pk_bf16_f32 v146, v131, v131
    v_and_b32 v147, 0xffff0000, v146
    v_mfma_f32_32x32x16_bf16 v[96:111], a[92:95], v[124:127], v[96:111]
    buffer_load_dwordx4 a[8:11], v11, s[32:35], s89 offen offset:2048 sc1
    s_waitcnt lgkmcnt(0)
    v_mfma_f32_32x32x16_bf16 v[16:31], a[96:99], v[112:115], v[16:31]
    ds_read_b128 v[120:123], v12 offset:6144
    v_mfma_f32_32x32x16_bf16 v[32:47], a[96:99], v[116:119], v[32:47]
    ds_read_b128 v[124:127], v12 offset:7168
    buffer_load_dwordx4 a[12:15], v11, s[32:35], s89 offen offset:3072 sc1
    v_mfma_f32_32x32x16_bf16 v[48:63], a[100:103], v[112:115], v[48:63]
    v_sub_f32 v147, v131, v147
    v_mov_b32 v144, v146
    v_cvt_pk_bf16_f32 v145, v147, 0
    v_mov_b32 v146, 0
    v_mfma_f32_32x32x16_bf16 v[64:79], a[100:103], v[116:119], v[64:79]
    s_mov_b32 s89, 65536
    buffer_load_dwordx4 a[16:19], v11, s[32:35], s89 offen offset:0 sc1
    v_mfma_f32_32x32x16_bf16 v[80:95], a[104:107], v[112:115], v[80:95]
    v_mov_b32 v147, 0
    v_mul_f32 v132, 0xc0135761, v130
    v_mul_f32 v133, v130, v130
    v_mul_f32 v133, v133, v132
    v_mfma_f32_32x32x16_bf16 v[96:111], a[104:107], v[116:119], v[96:111]
    buffer_load_dwordx4 a[20:23], v11, s[32:35], s89 offen offset:1024 sc1
    s_waitcnt lgkmcnt(0)
    v_mfma_f32_32x32x16_bf16 v[16:31], a[108:111], v[120:123], v[16:31]
    ds_read_b128 v[112:115], v12 offset:8192
    v_mfma_f32_32x32x16_bf16 v[32:47], a[108:111], v[124:127], v[32:47]
    ds_read_b128 v[116:119], v12 offset:9216
    buffer_load_dwordx4 a[24:27], v11, s[32:35], s89 offen offset:2048 sc1
    v_mfma_f32_32x32x16_bf16 v[48:63], a[112:115], v[120:123], v[48:63]
    v_mul_f32 v134, 0x3d372713, v133
    v_mov_b32 v128, v129
    v_add_f32 v136, v180, v184
    v_add_f32 v137, v182, v186
    v_mfma_f32_32x32x16_bf16 v[64:79], a[112:115], v[124:127], v[64:79]
    buffer_load_dwordx4 a[28:31], v11, s[32:35], s89 offen offset:3072 sc1
    v_mfma_f32_32x32x16_bf16 v[80:95], a[116:119], v[120:123], v[80:95]
    v_add_f32 v140, v188, v192
    v_add_f32 v141, v190, v194
    v_add_f32 v136, v136, v140
    v_add_f32 v137, v137, v141
    v_mfma_f32_32x32x16_bf16 v[96:111], a[116:119], v[124:127], v[96:111]
    s_mov_b32 s89, 69632
    buffer_load_dwordx4 a[32:35], v11, s[32:35], s89 offen offset:0 sc1
    s_waitcnt lgkmcnt(0)
    v_mfma_f32_32x32x16_bf16 v[16:31], a[120:123], v[112:115], v[16:31]
    ds_read_b128 v[120:123], v12 offset:24576
    v_mfma_f32_32x32x16_bf16 v[32:47], a[120:123], v[116:119], v[32:47]
    ds_read_b128 v[124:127], v12 offset:25600
    buffer_load_dwordx4 a[36:39], v11, s[32:35], s89 offen offset:1024 sc1
    v_mfma_f32_32x32x16_bf16 v[48:63], a[124:127], v[112:115], v[48:63]
    v_mov_b32 v138, v136
    v_mov_b32 v139, v137
    s_nop 0
    v_permlane32_swap_b32 v136, v138
    v_permlane32_swap_b32 v137, v139
    v_mfma_f32_32x32x16_bf16 v[64:79], a[124:127], v[116:119], v[64:79]
    buffer_load_dwordx4 a[40:43], v11, s[32:35], s89 offen offset:2048 sc1
    v_mfma_f32_32x32x16_bf16 v[80:95], a[128:131], v[112:115], v[80:95]
    v_add_f32 v136, v136, v138
    v_add_f32 v137, v137, v139
    v_mul_f32 v136, 0x3acccccd, v136
    v_mul_f32 v137, 0x3acccccd, v137
    v_mfma_f32_32x32x16_bf16 v[96:111], a[128:131], v[116:119], v[96:111]
    s_waitcnt lgkmcnt(0)
    v_mfma_f32_32x32x16_bf16 v[16:31], a[132:135], v[120:123], v[16:31]
    ds_read_b128 v[112:115], v12 offset:26624
    v_mfma_f32_32x32x16_bf16 v[32:47], a[132:135], v[124:127], v[32:47]
    ds_read_b128 v[116:119], v12 offset:27648
    buffer_load_dwordx4 a[44:47], v11, s[32:35], s89 offen offset:3072 sc1
    v_mfma_f32_32x32x16_bf16 v[48:63], a[136:139], v[120:123], v[48:63]
    v_fma_f32 v137, -v136, v136, v137
    v_max_f32 v137, 0, v137
    v_add_f32 v137, 0x3727c5ac, v137
    v_rsq_f32 v138, v137
    v_mfma_f32_32x32x16_bf16 v[64:79], a[136:139], v[124:127], v[64:79]
    s_mov_b32 s89, 73728
    buffer_load_dwordx4 a[48:51], v11, s[32:35], s89 offen offset:0 sc1
    v_mfma_f32_32x32x16_bf16 v[80:95], a[140:143], v[120:123], v[80:95]
    v_sub_f32 v136, 0, v136
    v_mul_f32 v139, v137, v138
    v_cndmask_b32 v139, v136, v139, s[92:93]
    v_cvt_pk_bf16_f32 v150, v139, v139
    v_mfma_f32_32x32x16_bf16 v[96:111], a[140:143], v[124:127], v[96:111]
    buffer_load_dwordx4 a[52:55], v11, s[32:35], s89 offen offset:1024 sc1
    s_waitcnt lgkmcnt(0)
    v_mfma_f32_32x32x16_bf16 v[16:31], a[144:147], v[112:115], v[16:31]
    ds_read_b128 v[120:123], v12 offset:28672
    v_mfma_f32_32x32x16_bf16 v[32:47], a[144:147], v[116:119], v[32:47]
    ds_read_b128 v[124:127], v12 offset:29696
    buffer_load_dwordx4 a[56:59], v11, s[32:35], s89 offen offset:2048 sc1
    v_mfma_f32_32x32x16_bf16 v[48:63], a[148:151], v[112:115], v[48:63]
    v_and_b32 v151, 0xffff0000, v150
    v_sub_f32 v151, v139, v151
    v_mov_b32 v148, v150
    v_cvt_pk_bf16_f32 v149, v151, 0
    v_mfma_f32_32x32x16_bf16 v[64:79], a[148:151], v[116:119], v[64:79]
    buffer_load_dwordx4 a[60:63], v11, s[32:35], s89 offen offset:3072 sc1
    v_mfma_f32_32x32x16_bf16 v[80:95], a[152:155], v[112:115], v[80:95]
    v_mov_b32 v150, 0
    v_mov_b32 v151, 0
    v_mul_f32 v140, 0xc0135761, v138
    v_mul_f32 v141, v138, v138
    v_mfma_f32_32x32x16_bf16 v[96:111], a[152:155], v[116:119], v[96:111]
    s_mov_b32 s89, 77824
    buffer_load_dwordx4 a[64:67], v11, s[32:35], s89 offen offset:0 sc1
    s_waitcnt lgkmcnt(0)
    v_mfma_f32_32x32x16_bf16 v[16:31], a[156:159], v[120:123], v[16:31]
    ds_read_b128 v[112:115], v13 offset:4096
    v_mfma_f32_32x32x16_bf16 v[32:47], a[156:159], v[124:127], v[32:47]
    ds_read_b128 v[116:119], v13 offset:5120
    buffer_load_dwordx4 a[68:71], v11, s[32:35], s89 offen offset:1024 sc1
    v_mfma_f32_32x32x16_bf16 v[48:63], a[160:163], v[120:123], v[48:63]
    v_mul_f32 v141, v141, v140
    v_mul_f32 v142, 0x3d372713, v141
    v_mov_b32 v136, v137
    v_cmp_ne_u32 vcc, s84, v204
    s_cbranch_vccz L_ptok_46
    s_mov_b32 s88, 400000
L_poll_47:
    buffer_load_dword v204, v205, s[32:35], 0 offen sc1
    s_sub_u32 s88, s88, 1
    s_cbranch_scc1 L_end
    s_waitcnt vmcnt(0)
    v_cmp_ne_u32 vcc, s84, v204
    s_cbranch_vccnz L_poll_47
L_ptok_46:
    v_mfma_f32_32x32x16_bf16 v[64:79], a[160:163], v[124:127], v[64:79]
    s_mov_b32 s89, 79872
    buffer_load_dwordx4 a[72:75], v11, s[32:35], s89 offen offset:0 sc1
    v_mfma_f32_32x32x16_bf16 v[80:95], a[164:167], v[120:123], v[80:95]
    s_mul_i32 s3, s82, 12
    s_mul_i32 s2, s80, 3
    s_add_u32 s3, s3, s2
    s_lshl_b32 s3, s3, 8
    v_mfma_f32_32x32x16_bf16 v[96:111], a[164:167], v[124:127], v[96:111]
    s_waitcnt lgkmcnt(0)
    v_mfma_f32_32x32x16_bf16 v[16:31], a[168:171], v[112:115], v[16:31]
    ds_read_b128 v[120:123], v13 offset:6144
    v_mfma_f32_32x32x16_bf16 v[32:47], a[168:171], v[116:119], v[32:47]
    ds_read_b128 v[124:127], v13 offset:7168
    buffer_load_dwordx4 a[76:79], v11, s[32:35], s89 offen offset:1024 sc1
    v_mfma_f32_32x32x16_bf16 v[48:63], a[172:175], v[112:115], v[48:63]
    s_add_u32 s3, s3, 262144
    v_lshl_add_u32 v14, v0, 2, s3
    buffer_load_dword v164, v14, s[32:35], 0 offen offset:0 sc1
    buffer_load_dword v165, v14, s[32:35], 0 offen offset:256 sc1
    v_mfma_f32_32x32x16_bf16 v[64:79], a[172:175], v[116:119], v[64:79]
    buffer_load_dwordx4 a[80:83], v11, s[32:35], s89 offen offset:2048 sc1
    v_mfma_f32_32x32x16_bf16 v[80:95], a[176:179], v[112:115], v[80:95]
    buffer_load_dword v166, v14, s[32:35], 0 offen offset:512 sc1
    s_mov_b32 s89, 24576
    buffer_load_dword v167, v14, s[32:35], s89 offen offset:0 sc1
    buffer_load_dword v168, v14, s[32:35], s89 offen offset:256 sc1
    buffer_load_dword v169, v14, s[32:35], s89 offen offset:512 sc1
    v_mfma_f32_32x32x16_bf16 v[96:111], a[176:179], v[116:119], v[96:111]
    s_mov_b32 s89, 82944
    buffer_load_dwordx4 a[84:87], v11, s[32:35], s89 offen offset:0 sc1
    s_waitcnt lgkmcnt(0)
    v_mfma_f32_32x32x16_bf16 v[16:31], a[180:183], v[120:123], v[16:31]
    ds_read_b128 v[112:115], v13 offset:8192
    v_mfma_f32_32x32x16_bf16 v[32:47], a[180:183], v[124:127], v[32:47]
    ds_read_b128 v[116:119], v13 offset:9216
    buffer_load_dwordx4 a[88:91], v11, s[32:35], s89 offen offset:1024 sc1
    v_mfma_f32_32x32x16_bf16 v[48:63], a[184:187], v[120:123], v[48:63]
    s_mov_b32 s89, 49152
    buffer_load_dword v170, v14, s[32:35], s89 offen offset:0 sc1
    buffer_load_dword v171, v14, s[32:35], s89 offen offset:256 sc1
    buffer_load_dword v172, v14, s[32:35], s89 offen offset:512 sc1
    s_mov_b32 s89, 73728
    buffer_load_dword v173, v14, s[32:35], s89 offen offset:0 sc1
    v_mfma_f32_32x32x16_bf16 v[64:79], a[184:187], v[124:127], v[64:79]
    s_mov_b32 s89, 84992
    buffer_load_dwordx4 a[92:95], v11, s[32:35], s89 offen offset:0 sc1
    v_mfma_f32_32x32x16_bf16 v[80:95], a[188:191], v[120:123], v[80:95]
    s_mov_b32 s89, 73984
    buffer_load_dword v174, v14, s[32:35], s89 offen offset:0 sc1
    buffer_load_dword v175, v14, s[32:35], s89 offen offset:256 sc1
    s_mov_b32 s89, 98304
    buffer_load_dword v176, v14, s[32:35], s89 offen offset:0 sc1
    buffer_load_dword v177, v14, s[32:35], s89 offen offset:256 sc1
    v_mfma_f32_32x32x16_bf16 v[96:111], a[188:191], v[124:127], v[96:111]
    s_mov_b32 s89, 86016
    buffer_load_dwordx4 a[96:99], v11, s[32:35], s89 offen offset:0 sc1
    s_waitcnt lgkmcnt(0)
    v_mfma_f32_32x32x16_bf16 v[16:31], a[192:195], v[112:115], v[16:31]
    ds_read_b128 v[120:123], v13 offset:24576
    v_mfma_f32_32x32x16_bf16 v[32:47], a[192:195], v[116:119], v[32:47]
    ds_read_b128 v[124:127], v13 offset:25600
    buffer_load_dwordx4 a[100:103], v11, s[32:35], s89 offen offset:1024 sc1
    v_mfma_f32_32x32x16_bf16 v[48:63], a[196:199], v[112:115], v[48:63]
    s_mov_b32 s89, 98816
    buffer_load_dword v178, v14, s[32:35], s89 offen offset:0 sc1
    s_mov_b32 s89, 122880
    buffer_load_dword v179, v14, s[32:35], s89 offen offset:0 sc1
    buffer_load_dword v180, v14, s[32:35], s89 offen offset:256 sc1
    buffer_load_dword v181, v14, s[32:35], s89 offen offset:512 sc1
    v_mfma_f32_32x32x16_bf16 v[64:79], a[196:199], v[116:119], v[64:79]
    s_mov_b32 s89, 88064
    buffer_load_dwordx4 a[104:107], v11, s[32:35], s89 offen offset:0 sc1
    v_mfma_f32_32x32x16_bf16 v[80:95], a[200:203], v[112:115], v[80:95]
    s_mov_b32 s89, 147456
    buffer_load_dword v182, v14, s[32:35], s89 offen offset:0 sc1
    s_waitcnt vmcnt(62)
    buffer_load_dword v183, v14, s[32:35], s89 offen offset:256 sc1
    s_waitcnt vmcnt(62)
    buffer_load_dword v184, v14, s[32:35], s89 offen offset:512 sc1
    s_waitcnt vmcnt(62)
    s_mov_b32 s89, 172032
    buffer_load_dword v185, v14, s[32:35], s89 offen offset:0 sc1
    v_mfma_f32_32x32x16_bf16 v[96:111], a[200:203], v[116:119], v[96:111]
    s_waitcnt lgkmcnt(0)
    v_mfma_f32_32x32x16_bf16 v[16:31], a[204:207], v[120:123], v[16:31]
    ds_read_b128 v[112:115], v13 offset:26624
    v_mfma_f32_32x32x16_bf16 v[32:47], a[204:207], v[124:127], v[32:47]
    ds_read_b128 v[116:119], v13 offset:27648
    s_waitcnt vmcnt(62)
    s_mov_b32 s89, 89088
    buffer_load_dwordx4 a[108:111], v11, s[32:35], s89 offen offset:0 sc1
    v_mfma_f32_32x32x16_bf16 v[48:63], a[208:211], v[120:123], v[48:63]
    s_waitcnt vmcnt(62)
    s_mov_b32 s89, 172288
    buffer_load_dword v186, v14, s[32:35], s89 offen offset:0 sc1
    s_waitcnt vmcnt(62)
    buffer_load_dword v187, v14, s[32:35], s89 offen offset:256 sc1
    s_waitcnt vmcnt(62)
    s_mov_b32 s89, 196608
    buffer_load_dword v188, v14, s[32:35], s89 offen offset:0 sc1
    s_waitcnt vmcnt(62)
    buffer_load_dword v189, v14, s[32:35], s89 offen offset:256 sc1
    v_mfma_f32_32x32x16_bf16 v[64:79], a[208:211], v[124:127], v[64:79]
    s_waitcnt vmcnt(62)
    s_mov_b32 s89, 90112
    buffer_load_dwordx4 a[112:115], v11, s[32:35], s89 offen offset:0 sc1
    v_mfma_f32_32x32x16_bf16 v[80:95], a[212:215], v[120:123], v[80:95]
    s_waitcnt vmcnt(62)
    s_mov_b32 s89, 197120
    buffer_load_dword v190, v14, s[32:35], s89 offen offset:0 sc1
    s_waitcnt vmcnt(62)
    s_mov_b32 s89, 221184
    buffer_load_dword v191, v14, s[32:35], s89 offen offset:0 sc1
    s_waitcnt vmcnt(62)
    buffer_load_dword v192, v14, s[32:35], s89 offen offset:256 sc1
    s_waitcnt vmcnt(62)
    buffer_load_dword v193, v14, s[32:35], s89 offen offset:512 sc1
    v_mfma_f32_32x32x16_bf16 v[96:111], a[212:215], v[124:127], v[96:111]
    s_waitcnt vmcnt(62)
    s_mov_b32 s89, 91136
    buffer_load_dwordx4 a[116:119], v11, s[32:35], s89 offen offset:0 sc1
    s_waitcnt lgkmcnt(0)
    v_mfma_f32_32x32x16_bf16 v[16:31], a[216:219], v[112:115], v[16:31]
    ds_read_b128 v[120:123], v13 offset:28672
    v_mfma_f32_32x32x16_bf16 v[32:47], a[216:219], v[116:119], v[32:47]
    ds_read_b128 v[124:127], v13 offset:29696
    s_waitcnt vmcnt(62)
    buffer_load_dwordx4 a[120:123], v11, s[32:35], s89 offen offset:1024 sc1
    v_mfma_f32_32x32x16_bf16 v[48:63], a[220:223], v[112:115], v[48:63]
    s_mul_i32 s3, s81, 196608
    s_mul_i32 s2, s82, 6144
    s_add_u32 s3, s3, s2
    s_mul_i32 s2, s80, 1536
    v_mfma_f32_32x32x16_bf16 v[64:79], a[220:223], v[116:119], v[64:79]
    s_waitcnt vmcnt(62)
    buffer_load_dwordx4 a[124:127], v11, s[32:35], s89 offen offset:2048 sc1
    v_mfma_f32_32x32x16_bf16 v[80:95], a[224:227], v[112:115], v[80:95]
    s_add_u32 s3, s3, s2
    s_add_u32 s3, s3, 8388608
    v_and_b32 v4, 15, v0
    v_lshl_add_u32 v3, v4, 4, s3
    v_mfma_f32_32x32x16_bf16 v[96:111], a[224:227], v[116:119], v[96:111]
    s_waitcnt vmcnt(62)
    buffer_load_dwordx4 a[128:131], v11, s[32:35], s89 offen offset:3072 sc1
    s_waitcnt lgkmcnt(0)
    s_barrier
    v_mfma_f32_32x32x16_bf16 v[16:31], a[228:231], v[120:123], v[16:31]
    ds_read_b128 v[112:115], v12 offset:10240
    v_mfma_f32_32x32x16_bf16 v[32:47], a[228:231], v[124:127], v[32:47]
    ds_read_b128 v[116:119], v12 offset:11264
    s_waitcnt vmcnt(62)
    s_mov_b32 s89, 95232
    buffer_load_dwordx4 a[132:135], v11, s[32:35], s89 offen offset:0 sc1
    v_mfma_f32_32x32x16_bf16 v[48:63], a[232:235], v[120:123], v[48:63]
    v_bfe_u32 v4, v0, 4, 1
    v_mul_u32_u24 v4, 49152, v4
    v_lshrrev_b32 v5, 5, v0
    v_lshlrev_b32 v5, 8, v5
    v_mfma_f32_32x32x16_bf16 v[64:79], a[232:235], v[124:127], v[64:79]
    s_waitcnt vmcnt(62)
    buffer_load_dwordx4 a[136:139], v11, s[32:35], s89 offen offset:1024 sc1
    v_mfma_f32_32x32x16_bf16 v[80:95], a[236:239], v[120:123], v[80:95]
    v_add3_u32 v3, v3, v4, v5
    v_mfma_f32_32x32x16_bf16 v[96:111], a[236:239], v[124:127], v[96:111]
    s_waitcnt vmcnt(62)
    buffer_load_dwordx4 a[140:143], v11, s[32:35], s89 offen offset:2048 sc1
    s_waitcnt lgkmcnt(0)
    v_mfma_f32_32x32x16_bf16 v[16:31], a[0:3], v[112:115], v[16:31]
    ds_read_b128 v[120:123], v12 offset:12288
    v_mfma_f32_32x32x16_bf16 v[32:47], a[0:3], v[116:119], v[32:47]
    ds_read_b128 v[124:127], v12 offset:13312
    s_waitcnt vmcnt(62)
    buffer_load_dwordx4 a[144:147], v11, s[32:35], s89 offen offset:3072 sc1
    v_mfma_f32_32x32x16_bf16 v[48:63], a[4:7], v[112:115], v[48:63]
    v_mfma_f32_32x32x16_bf16 v[64:79], a[4:7], v[116:119], v[64:79]
    s_waitcnt vmcnt(62)
    s_mov_b32 s89, 99328
    buffer_load_dwordx4 a[148:151], v11, s[32:35], s89 offen offset:0 sc1
    v_mfma_f32_32x32x16_bf16 v[80:95], a[8:11], v[112:115], v[80:95]
    v_mfma_f32_32x32x16_bf16 v[96:111], a[8:11], v[116:119], v[96:111]
    s_waitcnt vmcnt(62)
    s_waitcnt lgkmcnt(0)
    v_mfma_f32_32x32x16_bf16 v[16:31], a[12:15], v[120:123], v[16:31]
    ds_read_b128 v[112:115], v12 offset:14336
    v_mfma_f32_32x32x16_bf16 v[32:47], a[12:15], v[124:127], v[32:47]
    ds_read_b128 v[116:119], v12 offset:15360
    buffer_load_dwordx4 a[152:155], v11, s[32:35], s89 offen offset:1024 sc1
    v_mfma_f32_32x32x16_bf16 v[48:63], a[16:19], v[120:123], v[48:63]
    v_mfma_f32_32x32x16_bf16 v[64:79], a[16:19], v[124:127], v[64:79]
    s_waitcnt vmcnt(62)
    buffer_load_dwordx4 a[156:159], v11, s[32:35], s89 offen offset:2048 sc1
    v_mfma_f32_32x32x16_bf16 v[80:95], a[20:23], v[120:123], v[80:95]
    v_mfma_f32_32x32x16_bf16 v[96:111], a[20:23], v[124:127], v[96:111]
    s_waitcnt vmcnt(62)
    buffer_load_dwordx4 a[160:163], v11, s[32:35], s89 offen offset:3072 sc1
    s_waitcnt vmcnt(62)
    s_waitcnt lgkmcnt(0)
    v_mfma_f32_32x32x16_bf16 v[16:31], a[24:27], v[112:115], v[16:31]
    ds_read_b128 v[120:123], v12 offset:16384
    v_mfma_f32_32x32x16_bf16 v[32:47], a[24:27], v[116:119], v[32:47]
    ds_read_b128 v[124:127], v12 offset:17408
    s_mov_b32 s89, 103424
    buffer_load_dwordx4 a[164:167], v11, s[32:35], s89 offen offset:0 sc1
    v_mfma_f32_32x32x16_bf16 v[48:63], a[28:31], v[112:115], v[48:63]
    v_mfma_f32_32x32x16_bf16 v[64:79], a[28:31], v[116:119], v[64:79]
    s_waitcnt vmcnt(62)
    buffer_load_dwordx4 a[168:171], v11, s[32:35], s89 offen offset:1024 sc1
    v_mfma_f32_32x32x16_bf16 v[80:95], a[32:35], v[112:115], v[80:95]
    s_waitcnt vmcnt(14)
    v_add_f32 v8, v164, v167
    v_add_f32 v8, v8, v170
    v_mfma_f32_32x32x16_bf16 v[96:111], a[32:35], v[116:119], v[96:111]
    buffer_load_dwordx4 a[172:175], v11, s[32:35], s89 offen offset:2048 sc1
    s_waitcnt lgkmcnt(0)
    v_mfma_f32_32x32x16_bf16 v[16:31], a[36:39], v[120:123], v[16:31]
    ds_read_b128 v[112:115], v12 offset:18432
    v_mfma_f32_32x32x16_bf16 v[32:47], a[36:39], v[124:127], v[32:47]
    ds_read_b128 v[116:119], v12 offset:19456
    buffer_load_dwordx4 a[176:179], v11, s[32:35], s89 offen offset:3072 sc1
    v_mfma_f32_32x32x16_bf16 v[48:63], a[40:43], v[120:123], v[48:63]
    v_add_f32 v8, v8, v173
    v_add_f32 v8, v8, v176
    v_add_f32 v8, v8, v179
    v_add_f32 v8, v8, v182
    v_mfma_f32_32x32x16_bf16 v[64:79], a[40:43], v[124:127], v[64:79]
    s_mov_b32 s89, 107520
    buffer_load_dwordx4 a[180:183], v11, s[32:35], s89 offen offset:0 sc1
    v_mfma_f32_32x32x16_bf16 v[80:95], a[44:47], v[120:123], v[80:95]
    v_add_f32 v8, v8, v185
    v_add_f32 v8, v8, v188
    v_add_f32 v8, v8, v191
    v_add_f32 v9, v165, v168
    v_mfma_f32_32x32x16_bf16 v[96:111], a[44:47], v[124:127], v[96:111]
    s_waitcnt lgkmcnt(0)
    v_mfma_f32_32x32x16_bf16 v[16:31], a[48:51], v[112:115], v[16:31]
    ds_read_b128 v[120:123], v12 offset:30720
    v_mfma_f32_32x32x16_bf16 v[32:47], a[48:51], v[116:119], v[32:47]
    ds_read_b128 v[124:127], v12 offset:31744
    buffer_load_dwordx4 a[184:187], v11, s[32:35], s89 offen offset:1024 sc1
    v_mfma_f32_32x32x16_bf16 v[48:63], a[52:55], v[112:115], v[48:63]
    v_add_f32 v9, v9, v171
    v_add_f32 v9, v9, v174
    v_add_f32 v9, v9, v177
    v_add_f32 v9, v9, v180
    v_mfma_f32_32x32x16_bf16 v[64:79], a[52:55], v[116:119], v[64:79]
    buffer_load_dwordx4 a[188:191], v11, s[32:35], s89 offen offset:2048 sc1
    v_mfma_f32_32x32x16_bf16 v[80:95], a[56:59], v[112:115], v[80:95]
    v_add_f32 v9, v9, v183
    v_add_f32 v9, v9, v186
    v_add_f32 v9, v9, v189
    v_add_f32 v9, v9, v192
    v_mfma_f32_32x32x16_bf16 v[96:111], a[56:59], v[116:119], v[96:111]
    buffer_load_dwordx4 a[192:195], v11, s[32:35], s89 offen offset:3072 sc1
    s_waitcnt lgkmcnt(0)
    v_mfma_f32_32x32x16_bf16 v[16:31], a[60:63], v[120:123], v[16:31]
    ds_read_b128 v[112:115], v12 offset:32768
    v_mfma_f32_32x32x16_bf16 v[32:47], a[60:63], v[124:127], v[32:47]
    ds_read_b128 v[116:119], v12 offset:33792
    s_mov_b32 s89, 111616
    buffer_load_dwordx4 a[196:199], v11, s[32:35], s89 offen offset:0 sc1
    v_mfma_f32_32x32x16_bf16 v[48:63], a[64:67], v[120:123], v[48:63]
    v_add_f32 v10, v166, v169
    v_add_f32 v10, v10, v172
    v_add_f32 v10, v10, v175
    v_add_f32 v10, v10, v178
    v_mfma_f32_32x32x16_bf16 v[64:79], a[64:67], v[124:127], v[64:79]
    buffer_load_dwordx4 a[200:203], v11, s[32:35], s89 offen offset:1024 sc1
    v_mfma_f32_32x32x16_bf16 v[80:95], a[68:71], v[120:123], v[80:95]
    v_add_f32 v10, v10, v181
    v_add_f32 v10, v10, v184
    v_add_f32 v10, v10, v187
    v_add_f32 v10, v10, v190
    v_mfma_f32_32x32x16_bf16 v[96:111], a[68:71], v[124:127], v[96:111]
    buffer_load_dwordx4 a[204:207], v11, s[32:35], s89 offen offset:2048 sc1
    s_waitcnt lgkmcnt(0)
    v_mfma_f32_32x32x16_bf16 v[16:31], a[72:75], v[112:115], v[16:31]
    ds_read_b128 v[120:123], v12 offset:34816
    v_mfma_f32_32x32x16_bf16 v[32:47], a[72:75], v[116:119], v[32:47]
    ds_read_b128 v[124:127], v12 offset:35840
    buffer_load_dwordx4 a[208:211], v11, s[32:35], s89 offen offset:3072 sc1
    v_mfma_f32_32x32x16_bf16 v[48:63], a[76:79], v[112:115], v[48:63]
    v_add_f32 v10, v10, v193
    v_cvt_pk_bf16_f32 v154, v8, v8
    v_and_b32 v155, 0xffff0000, v154
    v_sub_f32 v155, v8, v155
    v_mfma_f32_32x32x16_bf16 v[64:79], a[76:79], v[116:119], v[64:79]
    s_mov_b32 s89, 115712
    buffer_load_dwordx4 a[212:215], v11, s[32:35], s89 offen offset:0 sc1
    v_mfma_f32_32x32x16_bf16 v[80:95], a[80:83], v[112:115], v[80:95]
    v_cvt_pk_bf16_f32 v152, v8, v155
    v_and_b32 v153, 0xffff, v154
    v_mov_b32 v154, 0
    v_mov_b32 v155, 0
    v_mfma_f32_32x32x16_bf16 v[96:111], a[80:83], v[116:119], v[96:111]
    s_waitcnt lgkmcnt(0)
    v_mfma_f32_32x32x16_bf16 v[16:31], a[84:87], v[120:123], v[16:31]
    ds_read_b128 v[112:115], v12 offset:36864
    v_mfma_f32_32x32x16_bf16 v[32:47], a[84:87], v[124:127], v[32:47]
    ds_read_b128 v[116:119], v12 offset:37888
    buffer_load_dwordx4 a[216:219], v11, s[32:35], s89 offen offset:1024 sc1
    v_mfma_f32_32x32x16_bf16 v[48:63], a[88:91], v[120:123], v[48:63]
    v_cvt_pk_bf16_f32 v158, v9, v9
    v_and_b32 v159, 0xffff0000, v158
    v_sub_f32 v159, v9, v159
    v_cvt_pk_bf16_f32 v156, v9, v159
    v_mfma_f32_32x32x16_bf16 v[64:79], a[88:91], v[124:127], v[64:79]
    buffer_load_dwordx4 a[220:223], v11, s[32:35], s89 offen offset:2048 sc1
    v_mfma_f32_32x32x16_bf16 v[80:95], a[92:95], v[120:123], v[80:95]
    v_and_b32 v157, 0xffff, v158
    v_mov_b32 v158, 0
    v_mov_b32 v159, 0
    v_cvt_pk_bf16_f32 v162, v10, v10
    v_mfma_f32_32x32x16_bf16 v[96:111], a[92:95], v[124:127], v[96:111]
    buffer_load_dwordx4 a[224:227], v11, s[32:35], s89 offen offset:3072 sc1
    s_waitcnt lgkmcnt(0)
    v_mfma_f32_32x32x16_bf16 v[16:31], a[96:99], v[112:115], v[16:31]
    ds_read_b128 v[120:123], v12 offset:38912
    v_mfma_f32_32x32x16_bf16 v[32:47], a[96:99], v[116:119], v[32:47]
    ds_read_b128 v[124:127], v12 offset:39936
    s_mov_b32 s89, 119808
    buffer_load_dwordx4 a[228:231], v11, s[32:35], s89 offen offset:0 sc1
    v_mfma_f32_32x32x16_bf16 v[48:63], a[100:103], v[112:115], v[48:63]
    v_and_b32 v163, 0xffff0000, v162
    v_sub_f32 v163, v10, v163
    v_cvt_pk_bf16_f32 v160, v10, v163
    v_and_b32 v161, 0xffff, v162
    v_mfma_f32_32x32x16_bf16 v[64:79], a[100:103], v[116:119], v[64:79]
    buffer_load_dwordx4 a[232:235], v11, s[32:35], s89 offen offset:1024 sc1
    v_mfma_f32_32x32x16_bf16 v[80:95], a[104:107], v[112:115], v[80:95]
    v_mov_b32 v162, 0
    v_mov_b32 v163, 0
    v_mfma_f32_32x32x16_bf16 v[96:111], a[104:107], v[116:119], v[96:111]
    buffer_load_dwordx4 a[236:239], v11, s[32:35], s89 offen offset:2048 sc1
    s_waitcnt vmcnt(30)
    s_waitcnt lgkmcnt(0)
    v_mfma_f32_32x32x16_bf16 v[16:31], a[108:111], v[120:123], v[16:31]
    ds_read_b128 v[112:115], v13 offset:10240
    v_mfma_f32_32x32x16_bf16 v[32:47], a[108:111], v[124:127], v[32:47]
    ds_read_b128 v[116:119], v13 offset:11264
    buffer_load_dwordx4 a[0:3], v15, s[32:35], 0 offen offset:0 sc1
    v_mfma_f32_32x32x16_bf16 v[48:63], a[112:115], v[120:123], v[48:63]
    v_mfma_f32_32x32x16_bf16 v[64:79], a[112:115], v[124:127], v[64:79]
    buffer_load_dwordx4 a[4:7], v15, s[32:35], 0 offen offset:1024 sc1
    v_mfma_f32_32x32x16_bf16 v[80:95], a[116:119], v[120:123], v[80:95]
    v_mfma_f32_32x32x16_bf16 v[96:111], a[116:119], v[124:127], v[96:111]
    buffer_load_dwordx4 a[8:11], v15, s[32:35], 0 offen offset:2048 sc1
    s_waitcnt vmcnt(32)
    s_waitcnt vmcnt(31)
    s_waitcnt vmcnt(30)
    s_waitcnt lgkmcnt(0)
    v_mfma_f32_32x32x16_bf16 v[16:31], a[120:123], v[112:115], v[16:31]
    ds_read_b128 v[120:123], v13 offset:12288
    v_mfma_f32_32x32x16_bf16 v[32:47], a[120:123], v[116:119], v[32:47]
    ds_read_b128 v[124:127], v13 offset:13312
    buffer_load_dwordx4 a[12:15], v15, s[32:35], 0 offen offset:3072 sc1
    v_mfma_f32_32x32x16_bf16 v[48:63], a[124:127], v[112:115], v[48:63]
    v_mfma_f32_32x32x16_bf16 v[64:79], a[124:127], v[116:119], v[64:79]
    s_mov_b32 s89, 4096
    buffer_load_dwordx4 a[16:19], v15, s[32:35], s89 offen offset:0 sc1
    v_mfma_f32_32x32x16_bf16 v[80:95], a[128:131], v[112:115], v[80:95]
    v_mfma_f32_32x32x16_bf16 v[96:111], a[128:131], v[116:119], v[96:111]
    s_waitcnt vmcnt(31)
    s_waitcnt vmcnt(30)
    s_waitcnt vmcnt(29)
    s_waitcnt lgkmcnt(0)
    v_mfma_f32_32x32x16_bf16 v[16:31], a[132:135], v[120:123], v[16:31]
    ds_read_b128 v[112:115], v13 offset:14336
    v_mfma_f32_32x32x16_bf16 v[32:47], a[132:135], v[124:127], v[32:47]
    ds_read_b128 v[116:119], v13 offset:15360
    buffer_load_dwordx4 a[20:23], v15, s[32:35], s89 offen offset:1024 sc1
    v_mfma_f32_32x32x16_bf16 v[48:63], a[136:139], v[120:123], v[48:63]
    v_mfma_f32_32x32x16_bf16 v[64:79], a[136:139], v[124:127], v[64:79]
    buffer_load_dwordx4 a[24:27], v15, s[32:35], s89 offen offset:2048 sc1
    v_mfma_f32_32x32x16_bf16 v[80:95], a[140:143], v[120:123], v[80:95]
    v_mfma_f32_32x32x16_bf16 v[96:111], a[140:143], v[124:127], v[96:111]
    buffer_load_dwordx4 a[28:31], v15, s[32:35], s89 offen offset:3072 sc1
    s_waitcnt vmcnt(31)
    s_waitcnt vmcnt(30)
    s_waitcnt vmcnt(29)
    s_waitcnt lgkmcnt(0)
    v_mfma_f32_32x32x16_bf16 v[16:31], a[144:147], v[112:115], v[16:31]
    ds_read_b128 v[120:123], v13 offset:16384
    v_mfma_f32_32x32x16_bf16 v[32:47], a[144:147], v[116:119], v[32:47]
    ds_read_b128 v[124:127], v13 offset:17408
    s_mov_b32 s89, 8192
    buffer_load_dwordx4 a[32:35], v15, s[32:35], s89 offen offset:0 sc1
    v_mfma_f32_32x32x16_bf16 v[48:63], a[148:151], v[112:115], v[48:63]
    v_mfma_f32_32x32x16_bf16 v[64:79], a[148:151], v[116:119], v[64:79]
    buffer_load_dwordx4 a[36:39], v15, s[32:35], s89 offen offset:1024 sc1
    v_mfma_f32_32x32x16_bf16 v[80:95], a[152:155], v[112:115], v[80:95]
    v_mfma_f32_32x32x16_bf16 v[96:111], a[152:155], v[116:119], v[96:111]
    buffer_load_dwordx4 a[40:43], v15, s[32:35], s89 offen offset:2048 sc1
    s_waitcnt vmcnt(31)
    s_waitcnt vmcnt(30)
    s_waitcnt vmcnt(29)
    s_waitcnt lgkmcnt(0)
    v_mfma_f32_32x32x16_bf16 v[16:31], a[156:159], v[120:123], v[16:31]
    ds_read_b128 v[112:115], v13 offset:18432
    v_mfma_f32_32x32x16_bf16 v[32:47], a[156:159], v[124:127], v[32:47]
    ds_read_b128 v[116:119], v13 offset:19456
    buffer_load_dwordx4 a[44:47], v15, s[32:35], s89 offen offset:3072 sc1
    v_mfma_f32_32x32x16_bf16 v[48:63], a[160:163], v[120:123], v[48:63]
    v_mfma_f32_32x32x16_bf16 v[64:79], a[160:163], v[124:127], v[64:79]
    s_mov_b32 s89, 12288
    buffer_load_dwordx4 a[48:51], v15, s[32:35], s89 offen offset:0 sc1
    v_mfma_f32_32x32x16_bf16 v[80:95], a[164:167], v[120:123], v[80:95]
    v_mfma_f32_32x32x16_bf16 v[96:111], a[164:167], v[124:127], v[96:111]
    s_waitcnt vmcnt(30)
    s_waitcnt vmcnt(29)
    s_waitcnt vmcnt(28)
    s_waitcnt lgkmcnt(0)
    v_mfma_f32_32x32x16_bf16 v[16:31], a[168:171], v[112:115], v[16:31]
    ds_read_b128 v[120:123], v13 offset:30720
    v_mfma_f32_32x32x16_bf16 v[32:47], a[168:171], v[116:119], v[32:47]
    ds_read_b128 v[124:127], v13 offset:31744
    buffer_load_dwordx4 a[52:55], v15, s[32:35], s89 offen offset:1024 sc1
    v_mfma_f32_32x32x16_bf16 v[48:63], a[172:175], v[112:115], v[48:63]
    v_mfma_f32_32x32x16_bf16 v[64:79], a[172:175], v[116:119], v[64:79]
    buffer_load_dwordx4 a[56:59], v15, s[32:35], s89 offen offset:2048 sc1
    v_mfma_f32_32x32x16_bf16 v[80:95], a[176:179], v[112:115], v[80:95]
    v_mfma_f32_32x32x16_bf16 v[96:111], a[176:179], v[116:119], v[96:111]
    buffer_load_dwordx4 a[60:63], v15, s[32:35], s89 offen offset:3072 sc1
    s_waitcnt vmcnt(30)
    s_waitcnt vmcnt(29)
    s_waitcnt vmcnt(28)
    s_waitcnt lgkmcnt(0)
    v_mfma_f32_32x32x16_bf16 v[16:31], a[180:183], v[120:123], v[16:31]
    ds_read_b128 v[112:115], v13 offset:32768
    v_mfma_f32_32x32x16_bf16 v[32:47], a[180:183], v[124:127], v[32:47]
    ds_read_b128 v[116:119], v13 offset:33792
    s_mov_b32 s89, 16384
    buffer_load_dwordx4 a[64:67], v15, s[32:35], s89 offen offset:0 sc1
    v_mfma_f32_32x32x16_bf16 v[48:63], a[184:187], v[120:123], v[48:63]
    v_mfma_f32_32x32x16_bf16 v[64:79], a[184:187], v[124:127], v[64:79]
    buffer_load_dwordx4 a[68:71], v15, s[32:35], s89 offen offset:1024 sc1
    v_mfma_f32_32x32x16_bf16 v[80:95], a[188:191], v[120:123], v[80:95]
    v_mfma_f32_32x32x16_bf16 v[96:111], a[188:191], v[124:127], v[96:111]
    buffer_load_dwordx4 a[72:75], v15, s[32:35], s89 offen offset:2048 sc1
    s_waitcnt vmcnt(30)
    s_waitcnt vmcnt(29)
    s_waitcnt vmcnt(28)
    s_waitcnt lgkmcnt(0)
    v_mfma_f32_32x32x16_bf16 v[16:31], a[192:195], v[112:115], v[16:31]
    ds_read_b128 v[120:123], v13 offset:34816
    v_mfma_f32_32x32x16_bf16 v[32:47], a[192:195], v[116:119], v[32:47]
    ds_read_b128 v[124:127], v13 offset:35840
    buffer_load_dwordx4 a[76:79], v15, s[32:35], s89 offen offset:3072 sc1
    v_mfma_f32_32x32x16_bf16 v[48:63], a[196:199], v[112:115], v[48:63]
    v_mfma_f32_32x32x16_bf16 v[64:79], a[196:199], v[116:119], v[64:79]
    s_mov_b32 s89, 20480
    buffer_load_dwordx4 a[80:83], v15, s[32:35], s89 offen offset:0 sc1
    v_mfma_f32_32x32x16_bf16 v[80:95], a[200:203], v[112:115], v[80:95]
    v_mfma_f32_32x32x16_bf16 v[96:111], a[200:203], v[116:119], v[96:111]
    s_waitcnt vmcnt(29)
    s_waitcnt vmcnt(28)
    s_waitcnt vmcnt(27)
    s_waitcnt lgkmcnt(0)
    v_mfma_f32_32x32x16_bf16 v[16:31], a[204:207], v[120:123], v[16:31]
    ds_read_b128 v[112:115], v13 offset:36864
    v_mfma_f32_32x32x16_bf16 v[32:47], a[204:207], v[124:127], v[32:47]
    ds_read_b128 v[116:119], v13 offset:37888
    buffer_load_dwordx4 a[84:87], v15, s[32:35], s89 offen offset:1024 sc1
    v_mfma_f32_32x32x16_bf16 v[48:63], a[208:211], v[120:123], v[48:63]
    v_mfma_f32_32x32x16_bf16 v[64:79], a[208:211], v[124:127], v[64:79]
    buffer_load_dwordx4 a[88:91], v15, s[32:35], s89 offen offset:2048 sc1
    v_mfma_f32_32x32x16_bf16 v[80:95], a[212:215], v[120:123], v[80:95]
    v_mfma_f32_32x32x16_bf16 v[96:111], a[212:215], v[124:127], v[96:111]
    buffer_load_dwordx4 a[92:95], v15, s[32:35], s89 offen offset:3072 sc1
    s_waitcnt vmcnt(29)
    s_waitcnt vmcnt(28)
    s_waitcnt vmcnt(27)
    s_waitcnt lgkmcnt(0)
    v_mfma_f32_32x32x16_bf16 v[16:31], a[216:219], v[112:115], v[16:31]
    ds_read_b128 v[120:123], v13 offset:38912
    v_mfma_f32_32x32x16_bf16 v[32:47], a[216:219], v[116:119], v[32:47]
    ds_read_b128 v[124:127], v13 offset:39936
    s_mov_b32 s89, 24576
    buffer_load_dwordx4 a[96:99], v15, s[32:35], s89 offen offset:0 sc1
    v_mfma_f32_32x32x16_bf16 v[48:63], a[220:223], v[112:115], v[48:63]
    v_mfma_f32_32x32x16_bf16 v[64:79], a[220:223], v[116:119], v[64:79]
    buffer_load_dwordx4 a[100:103], v15, s[32:35], s89 offen offset:1024 sc1
    v_mfma_f32_32x32x16_bf16 v[80:95], a[224:227], v[112:115], v[80:95]
    v_mfma_f32_32x32x16_bf16 v[96:111], a[224:227], v[116:119], v[96:111]
    buffer_load_dwordx4 a[104:107], v15, s[32:35], s89 offen offset:2048 sc1
    s_waitcnt vmcnt(29)
    s_waitcnt vmcnt(28)
    s_waitcnt vmcnt(27)
    s_waitcnt lgkmcnt(0)
    v_mfma_f32_32x32x16_bf16 v[16:31], a[228:231], v[120:123], v[16:31]
    v_mfma_f32_32x32x16_bf16 v[32:47], a[228:231], v[124:127], v[32:47]
    buffer_load_dwordx4 a[108:111], v15, s[32:35], s89 offen offset:3072 sc1
    v_mfma_f32_32x32x16_bf16 v[48:63], a[232:235], v[120:123], v[48:63]
    v_mfma_f32_32x32x16_bf16 v[64:79], a[232:235], v[124:127], v[64:79]
    s_mov_b32 s89, 28672
    buffer_load_dwordx4 a[112:115], v15, s[32:35], s89 offen offset:0 sc1
    v_mfma_f32_32x32x16_bf16 v[80:95], a[236:239], v[120:123], v[80:95]
    v_mfma_f32_32x32x16_bf16 v[96:111], a[236:239], v[124:127], v[96:111]
    buffer_load_dwordx4 a[116:119], v15, s[32:35], s89 offen offset:1024 sc1
    v_mfma_f32_32x32x16_bf16 v[16:31], v[152:155], v[144:147], v[16:31]
    v_mfma_f32_32x32x16_bf16 v[32:47], v[152:155], v[148:151], v[32:47]
    v_mfma_f32_32x32x16_bf16 v[48:63], v[156:159], v[144:147], v[48:63]
    v_mfma_f32_32x32x16_bf16 v[64:79], v[156:159], v[148:151], v[64:79]
    v_mfma_f32_32x32x16_bf16 v[80:95], v[160:163], v[144:147], v[80:95]
    v_mfma_f32_32x32x16_bf16 v[96:111], v[160:163], v[148:151], v[96:111]
    s_nop 6
    v_pk_mul_f32 v[164:165], v[16:17], v[16:17]
    v_pk_mul_f32 v[166:167], v[18:19], v[18:19]
    v_pk_mul_f32 v[168:169], v[20:21], v[20:21]
    v_pk_mul_f32 v[170:171], v[22:23], v[22:23]
    v_pk_fma_f32 v[164:165], v[164:165], v[134:135], v[132:133] op_sel_hi:[1,0,0]
    v_pk_fma_f32 v[166:167], v[166:167], v[134:135], v[132:133] op_sel_hi:[1,0,0]
    v_pk_fma_f32 v[168:169], v[168:169], v[134:135], v[132:133] op_sel_hi:[1,0,0]
    v_pk_fma_f32 v[170:171], v[170:171], v[134:135], v[132:133] op_sel_hi:[1,0,0]
    v_pk_mul_f32 v[164:165], v[164:165], v[16:17]
    v_pk_mul_f32 v[166:167], v[166:167], v[18:19]
    v_pk_mul_f32 v[168:169], v[168:169], v[20:21]
    v_pk_mul_f32 v[170:171], v[170:171], v[22:23]
    v_exp_f32 v164, v164
    v_exp_f32 v165, v165
    buffer_load_dwordx4 a[120:123], v15, s[32:35], s89 offen offset:2048 sc1
    v_exp_f32 v166, v166
    v_exp_f32 v167, v167
    v_exp_f32 v168, v168
    v_exp_f32 v169, v169
    v_exp_f32 v170, v170
    v_exp_f32 v171, v171
    v_pk_mul_f32 v[16:17], v[16:17], v[24:25]
    v_pk_mul_f32 v[18:19], v[18:19], v[26:27]
    v_pk_mul_f32 v[20:21], v[20:21], v[28:29]
    v_pk_mul_f32 v[22:23], v[22:23], v[30:31]
    v_pk_fma_f32 v[164:165], v[164:165], v[128:129], v[128:129] op_sel_hi:[1,0,0]
    v_pk_fma_f32 v[166:167], v[166:167], v[128:129], v[128:129] op_sel_hi:[1,0,0]
    v_pk_fma_f32 v[168:169], v[168:169], v[128:129], v[128:129] op_sel_hi:[1,0,0]
    v_pk_fma_f32 v[170:171], v[170:171], v[128:129], v[128:129] op_sel_hi:[1,0,0]
    buffer_load_dwordx4 a[124:127], v15, s[32:35], s89 offen offset:3072 sc1
    v_rcp_f32 v164, v164
    v_rcp_f32 v165, v165
    v_rcp_f32 v166, v166
    v_rcp_f32 v167, v167
    v_rcp_f32 v168, v168
    v_rcp_f32 v169, v169
    v_rcp_f32 v170, v170
    v_rcp_f32 v171, v171
    v_pk_mul_f32 v[16:17], v[16:17], v[164:165]
    v_pk_mul_f32 v[18:19], v[18:19], v[166:167]
    v_pk_mul_f32 v[20:21], v[20:21], v[168:169]
    v_pk_mul_f32 v[22:23], v[22:23], v[170:171]
    v_cvt_pk_bf16_f32 v24, v16, v17
    v_cvt_pk_bf16_f32 v25, v18, v19
    s_mov_b32 s89, 32768
    buffer_load_dwordx4 a[128:131], v15, s[32:35], s89 offen offset:0 sc1
    v_cvt_pk_bf16_f32 v26, v20, v21
    v_cvt_pk_bf16_f32 v27, v22, v23
    buffer_store_dwordx4 v[24:27], v3, s[32:35], 0 offen offset:0 sc1
    v_pk_mul_f32 v[172:173], v[48:49], v[48:49]
    v_pk_mul_f32 v[174:175], v[50:51], v[50:51]
    v_pk_mul_f32 v[176:177], v[52:53], v[52:53]
    v_pk_mul_f32 v[178:179], v[54:55], v[54:55]
    v_pk_fma_f32 v[172:173], v[172:173], v[134:135], v[132:133] op_sel_hi:[1,0,0]
    v_pk_fma_f32 v[174:175], v[174:175], v[134:135], v[132:133] op_sel_hi:[1,0,0]
    v_pk_fma_f32 v[176:177], v[176:177], v[134:135], v[132:133] op_sel_hi:[1,0,0]
    v_pk_fma_f32 v[178:179], v[178:179], v[134:135], v[132:133] op_sel_hi:[1,0,0]
    v_pk_mul_f32 v[172:173], v[172:173], v[48:49]
    v_pk_mul_f32 v[174:175], v[174:175], v[50:51]
    v_pk_mul_f32 v[176:177], v[176:177], v[52:53]
    buffer_load_dwordx4 a[132:135], v15, s[32:35], s89 offen offset:1024 sc1
    v_pk_mul_f32 v[178:179], v[178:179], v[54:55]
    v_exp_f32 v172, v172
    v_exp_f32 v173, v173
    v_exp_f32 v174, v174
    v_exp_f32 v175, v175
    v_exp_f32 v176, v176
    v_exp_f32 v177, v177
    v_exp_f32 v178, v178
    v_exp_f32 v179, v179
    v_pk_mul_f32 v[48:49], v[48:49], v[56:57]
    v_pk_mul_f32 v[50:51], v[50:51], v[58:59]
    v_pk_mul_f32 v[52:53], v[52:53], v[60:61]
    v_pk_mul_f32 v[54:55], v[54:55], v[62:63]
    v_pk_fma_f32 v[172:173], v[172:173], v[128:129], v[128:129] op_sel_hi:[1,0,0]
    buffer_load_dwordx4 a[136:139], v15, s[32:35], s89 offen offset:2048 sc1
    v_pk_fma_f32 v[174:175], v[174:175], v[128:129], v[128:129] op_sel_hi:[1,0,0]
    v_pk_fma_f32 v[176:177], v[176:177], v[128:129], v[128:129] op_sel_hi:[1,0,0]
    v_pk_fma_f32 v[178:179], v[178:179], v[128:129], v[128:129] op_sel_hi:[1,0,0]
    v_rcp_f32 v172, v172
    v_rcp_f32 v173, v173
    v_rcp_f32 v174, v174
    v_rcp_f32 v175, v175
    v_rcp_f32 v176, v176
    v_rcp_f32 v177, v177
    v_rcp_f32 v178, v178
    v_rcp_f32 v179, v179
    v_pk_mul_f32 v[48:49], v[48:49], v[172:173]
    v_pk_mul_f32 v[50:51], v[50:51], v[174:175]
    v_pk_mul_f32 v[52:53], v[52:53], v[176:177]
    buffer_load_dwordx4 a[140:143], v15, s[32:35], s89 offen offset:3072 sc1
    v_pk_mul_f32 v[54:55], v[54:55], v[178:179]
    v_cvt_pk_bf16_f32 v56, v48, v49
    v_cvt_pk_bf16_f32 v57, v50, v51
    v_cvt_pk_bf16_f32 v58, v52, v53
    v_cvt_pk_bf16_f32 v59, v54, v55
    buffer_store_dwordx4 v[56:59], v3, s[32:35], 0 offen offset:512 sc1
    v_pk_mul_f32 v[164:165], v[80:81], v[80:81]
    v_pk_mul_f32 v[166:167], v[82:83], v[82:83]
    v_pk_mul_f32 v[168:169], v[84:85], v[84:85]
    v_pk_mul_f32 v[170:171], v[86:87], v[86:87]
    v_pk_fma_f32 v[164:165], v[164:165], v[134:135], v[132:133] op_sel_hi:[1,0,0]
    v_pk_fma_f32 v[166:167], v[166:167], v[134:135], v[132:133] op_sel_hi:[1,0,0]
    v_pk_fma_f32 v[168:169], v[168:169], v[134:135], v[132:133] op_sel_hi:[1,0,0]
    v_pk_fma_f32 v[170:171], v[170:171], v[134:135], v[132:133] op_sel_hi:[1,0,0]
    s_mov_b32 s89, 36864
    buffer_load_dwordx4 a[144:147], v15, s[32:35], s89 offen offset:0 sc1
    v_pk_mul_f32 v[164:165], v[164:165], v[80:81]
    v_pk_mul_f32 v[166:167], v[166:167], v[82:83]
    v_pk_mul_f32 v[168:169], v[168:169], v[84:85]
    v_pk_mul_f32 v[170:171], v[170:171], v[86:87]
    v_exp_f32 v164, v164
    v_exp_f32 v165, v165
    v_exp_f32 v166, v166
    v_exp_f32 v167, v167
    v_exp_f32 v168, v168
    v_exp_f32 v169, v169
    v_exp_f32 v170, v170
    v_exp_f32 v171, v171
    v_pk_mul_f32 v[80:81], v[80:81], v[88:89]
    v_pk_mul_f32 v[82:83], v[82:83], v[90:91]
    buffer_load_dwordx4 a[148:151], v15, s[32:35], s89 offen offset:1024 sc1
    v_pk_mul_f32 v[84:85], v[84:85], v[92:93]
    v_pk_mul_f32 v[86:87], v[86:87], v[94:95]
    v_pk_fma_f32 v[164:165], v[164:165], v[128:129], v[128:129] op_sel_hi:[1,0,0]
    v_pk_fma_f32 v[166:167], v[166:167], v[128:129], v[128:129] op_sel_hi:[1,0,0]
    v_pk_fma_f32 v[168:169], v[168:169], v[128:129], v[128:129] op_sel_hi:[1,0,0]
    v_pk_fma_f32 v[170:171], v[170:171], v[128:129], v[128:129] op_sel_hi:[1,0,0]
    v_rcp_f32 v164, v164
    v_rcp_f32 v165, v165
    v_rcp_f32 v166, v166
    v_rcp_f32 v167, v167
    v_rcp_f32 v168, v168
    v_rcp_f32 v169, v169
    v_rcp_f32 v170, v170
    v_rcp_f32 v171, v171
    buffer_load_dwordx4 a[152:155], v15, s[32:35], s89 offen offset:2048 sc1
    v_pk_mul_f32 v[80:81], v[80:81], v[164:165]
    v_pk_mul_f32 v[82:83], v[82:83], v[166:167]
    v_pk_mul_f32 v[84:85], v[84:85], v[168:169]
    v_pk_mul_f32 v[86:87], v[86:87], v[170:171]
    v_cvt_pk_bf16_f32 v88, v80, v81
    v_cvt_pk_bf16_f32 v89, v82, v83
    v_cvt_pk_bf16_f32 v90, v84, v85
    v_cvt_pk_bf16_f32 v91, v86, v87
    buffer_store_dwordx4 v[88:91], v3, s[32:35], 0 offen offset:1024 sc1
    v_pk_mul_f32 v[172:173], v[32:33], v[32:33]
    v_pk_mul_f32 v[174:175], v[34:35], v[34:35]
    v_pk_mul_f32 v[176:177], v[36:37], v[36:37]
    v_pk_mul_f32 v[178:179], v[38:39], v[38:39]
    v_pk_fma_f32 v[172:173], v[172:173], v[142:143], v[140:141] op_sel_hi:[1,0,0]
    buffer_load_dwordx4 a[156:159], v15, s[32:35], s89 offen offset:3072 sc1
    v_pk_fma_f32 v[174:175], v[174:175], v[142:143], v[140:141] op_sel_hi:[1,0,0]
    v_pk_fma_f32 v[176:177], v[176:177], v[142:143], v[140:141] op_sel_hi:[1,0,0]
    v_pk_fma_f32 v[178:179], v[178:179], v[142:143], v[140:141] op_sel_hi:[1,0,0]
    v_pk_mul_f32 v[172:173], v[172:173], v[32:33]
    v_pk_mul_f32 v[174:175], v[174:175], v[34:35]
    v_pk_mul_f32 v[176:177], v[176:177], v[36:37]
    v_pk_mul_f32 v[178:179], v[178:179], v[38:39]
    v_exp_f32 v172, v172
    v_exp_f32 v173, v173
    v_exp_f32 v174, v174
    v_exp_f32 v175, v175
    v_exp_f32 v176, v176
    v_exp_f32 v177, v177
    v_exp_f32 v178, v178
    s_mov_b32 s89, 40960
    buffer_load_dwordx4 a[160:163], v15, s[32:35], s89 offen offset:0 sc1
    v_exp_f32 v179, v179
    v_pk_mul_f32 v[32:33], v[32:33], v[40:41]
    v_pk_mul_f32 v[34:35], v[34:35], v[42:43]
    v_pk_mul_f32 v[36:37], v[36:37], v[44:45]
    v_pk_mul_f32 v[38:39], v[38:39], v[46:47]
    v_pk_fma_f32 v[172:173], v[172:173], v[136:137], v[136:137] op_sel_hi:[1,0,0]
    v_pk_fma_f32 v[174:175], v[174:175], v[136:137], v[136:137] op_sel_hi:[1,0,0]
    v_pk_fma_f32 v[176:177], v[176:177], v[136:137], v[136:137] op_sel_hi:[1,0,0]
    v_pk_fma_f32 v[178:179], v[178:179], v[136:137], v[136:137] op_sel_hi:[1,0,0]
    v_rcp_f32 v172, v172
    v_rcp_f32 v173, v173
    v_rcp_f32 v174, v174
    v_rcp_f32 v175, v175
    v_rcp_f32 v176, v176
    buffer_load_dwordx4 a[164:167], v15, s[32:35], s89 offen offset:1024 sc1
    v_rcp_f32 v177, v177
    v_rcp_f32 v178, v178
    v_rcp_f32 v179, v179
    v_pk_mul_f32 v[32:33], v[32:33], v[172:173]
    v_pk_mul_f32 v[34:35], v[34:35], v[174:175]
    v_pk_mul_f32 v[36:37], v[36:37], v[176:177]
    v_pk_mul_f32 v[38:39], v[38:39], v[178:179]
    v_cvt_pk_bf16_f32 v40, v32, v33
    v_cvt_pk_bf16_f32 v41, v34, v35
    v_cvt_pk_bf16_f32 v42, v36, v37
    v_cvt_pk_bf16_f32 v43, v38, v39
    s_mov_b32 s89, 98304
    buffer_store_dwordx4 v[40:43], v3, s[32:35], s89 offen offset:0 sc1
    v_pk_mul_f32 v[164:165], v[64:65], v[64:65]
    v_pk_mul_f32 v[166:167], v[66:67], v[66:67]
    s_mov_b32 s89, 43008
    buffer_load_dwordx4 a[168:171], v15, s[32:35], s89 offen offset:0 sc1
    v_pk_mul_f32 v[168:169], v[68:69], v[68:69]
    v_pk_mul_f32 v[170:171], v[70:71], v[70:71]
    v_pk_fma_f32 v[164:165], v[164:165], v[142:143], v[140:141] op_sel_hi:[1,0,0]
    v_pk_fma_f32 v[166:167], v[166:167], v[142:143], v[140:141] op_sel_hi:[1,0,0]
    v_pk_fma_f32 v[168:169], v[168:169], v[142:143], v[140:141] op_sel_hi:[1,0,0]
    v_pk_fma_f32 v[170:171], v[170:171], v[142:143], v[140:141] op_sel_hi:[1,0,0]
    v_pk_mul_f32 v[164:165], v[164:165], v[64:65]
    v_pk_mul_f32 v[166:167], v[166:167], v[66:67]
    v_pk_mul_f32 v[168:169], v[168:169], v[68:69]
    v_pk_mul_f32 v[170:171], v[170:171], v[70:71]
    v_exp_f32 v164, v164
    v_exp_f32 v165, v165
    v_exp_f32 v166, v166
    v_exp_f32 v167, v167
    buffer_load_dwordx4 a[172:175], v15, s[32:35], s89 offen offset:1024 sc1
    v_exp_f32 v168, v168
    v_exp_f32 v169, v169
    v_exp_f32 v170, v170
    v_exp_f32 v171, v171
    v_pk_mul_f32 v[64:65], v[64:65], v[72:73]
    v_pk_mul_f32 v[66:67], v[66:67], v[74:75]
    v_pk_mul_f32 v[68:69], v[68:69], v[76:77]
    v_pk_mul_f32 v[70:71], v[70:71], v[78:79]
    v_pk_fma_f32 v[164:165], v[164:165], v[136:137], v[136:137] op_sel_hi:[1,0,0]
    v_pk_fma_f32 v[166:167], v[166:167], v[136:137], v[136:137] op_sel_hi:[1,0,0]
    v_pk_fma_f32 v[168:169], v[168:169], v[136:137], v[136:137] op_sel_hi:[1,0,0]
    v_pk_fma_f32 v[170:171], v[170:171], v[136:137], v[136:137] op_sel_hi:[1,0,0]
    v_rcp_f32 v164, v164
    v_rcp_f32 v165, v165
    v_rcp_f32 v166, v166
    v_rcp_f32 v167, v167
    v_rcp_f32 v168, v168
    v_rcp_f32 v169, v169
    v_rcp_f32 v170, v170
    v_rcp_f32 v171, v171
    v_pk_mul_f32 v[64:65], v[64:65], v[164:165]
    v_pk_mul_f32 v[66:67], v[66:67], v[166:167]
    v_pk_mul_f32 v[68:69], v[68:69], v[168:169]
    v_pk_mul_f32 v[70:71], v[70:71], v[170:171]
    v_cvt_pk_bf16_f32 v72, v64, v65
    v_cvt_pk_bf16_f32 v73, v66, v67
    v_cvt_pk_bf16_f32 v74, v68, v69
    v_cvt_pk_bf16_f32 v75, v70, v71
    s_mov_b32 s89, 98816
    buffer_store_dwordx4 v[72:75], v3, s[32:35], s89 offen offset:0 sc1
    s_lshl_b32 s3, s81, 12
    s_add_u32 s3, s3, 7995392
    s_lshl_b32 s2, s82, 9
    s_lshl_b32 s66, s80, 7
    s_add_u32 s3, s3, s2
    s_add_u32 s3, s3, s66
    v_mov_b32 v8, s3
    v_mov_b32 v9, s84
    s_waitcnt vmcnt(7)
    s_mov_b64 exec, 1
    buffer_store_dword v9, v8, s[32:35], 0 offen sc1
    s_mov_b64 exec, -1
    v_pk_mul_f32 v[172:173], v[96:97], v[96:97]
    v_pk_mul_f32 v[174:175], v[98:99], v[98:99]
    v_pk_mul_f32 v[176:177], v[100:101], v[100:101]
    v_pk_mul_f32 v[178:179], v[102:103], v[102:103]
    v_pk_fma_f32 v[172:173], v[172:173], v[142:143], v[140:141] op_sel_hi:[1,0,0]
    v_pk_fma_f32 v[174:175], v[174:175], v[142:143], v[140:141] op_sel_hi:[1,0,0]
    v_pk_fma_f32 v[176:177], v[176:177], v[142:143], v[140:141] op_sel_hi:[1,0,0]
    v_pk_fma_f32 v[178:179], v[178:179], v[142:143], v[140:141] op_sel_hi:[1,0,0]
    v_pk_mul_f32 v[172:173], v[172:173], v[96:97]
    v_pk_mul_f32 v[174:175], v[174:175], v[98:99]
    v_pk_mul_f32 v[176:177], v[176:177], v[100:101]
    v_pk_mul_f32 v[178:179], v[178:179], v[102:103]
    v_exp_f32 v172, v172
    v_exp_f32 v173, v173
    v_exp_f32 v174, v174
    v_exp_f32 v175, v175
    v_exp_f32 v176, v176
    v_exp_f32 v177, v177
    v_exp_f32 v178, v178
    v_exp_f32 v179, v179
    v_pk_mul_f32 v[96:97], v[96:97], v[104:105]
    v_pk_mul_f32 v[98:99], v[98:99], v[106:107]
    v_pk_mul_f32 v[100:101], v[100:101], v[108:109]
    v_pk_mul_f32 v[102:103], v[102:103], v[110:111]
    v_pk_fma_f32 v[172:173], v[172:173], v[136:137], v[136:137] op_sel_hi:[1,0,0]
    v_pk_fma_f32 v[174:175], v[174:175], v[136:137], v[136:137] op_sel_hi:[1,0,0]
    v_pk_fma_f32 v[176:177], v[176:177], v[136:137], v[136:137] op_sel_hi:[1,0,0]
    v_pk_fma_f32 v[178:179], v[178:179], v[136:137], v[136:137] op_sel_hi:[1,0,0]
    v_rcp_f32 v172, v172
    v_rcp_f32 v173, v173
    v_rcp_f32 v174, v174
    v_rcp_f32 v175, v175
    v_rcp_f32 v176, v176
    v_rcp_f32 v177, v177
    v_rcp_f32 v178, v178
    v_rcp_f32 v179, v179
    v_pk_mul_f32 v[96:97], v[96:97], v[172:173]
    v_pk_mul_f32 v[98:99], v[98:99], v[174:175]
    v_pk_mul_f32 v[100:101], v[100:101], v[176:177]
    v_pk_mul_f32 v[102:103], v[102:103], v[178:179]
    v_cvt_pk_bf16_f32 v104, v96, v97
    v_cvt_pk_bf16_f32 v105, v98, v99
    v_cvt_pk_bf16_f32 v106, v100, v101
    v_cvt_pk_bf16_f32 v107, v102, v103
    buffer_store_dwordx4 v[104:107], v3, s[32:35], s89 offen offset:512 sc1
    s_lshl_b32 s3, s81, 12
    s_add_u32 s3, s3, 7995392
    s_lshl_b32 s2, s80, 10
    s_add_u32 s3, s3, s2
    v_and_b32 v7, 7, v0
    v_lshl_add_u32 v7, v7, 7, s3
    s_mul_i32 s3, s81, 196608
    s_mul_i32 s2, s80, 12288
    s_add_u32 s3, s3, s2
    s_add_u32 s3, s3, 8388608
    v_add_u32 v3, s3, v1
    s_lshl_b32 s3, s81, 2
    s_add_u32 s3, s3, s26
    s_mul_i32 s3, s3, 20480
    s_mul_i32 s2, s82, 160
    s_add_u32 s3, s3, s2
    v_and_b32 v13, 15, v0
    v_mul_u32_u24 v13, 1280, v13
    v_lshrrev_b32 v14, 4, v0
    v_lshlrev_b32 v9, 4, v14
    v_and_b32 v9, 32, v9
    v_lshrrev_b32 v9, 1, v9
    v_add3_u32 v12, v13, v9, s3
    v_and_b32 v9, 1, v14
    v_lshl_add_u32 v10, v9, 30, v12
    v_lshl_add_u32 v12, v9, 5, v12
    v_lshlrev_b32 v13, 4, v14
    v_add_u32 v13, 155904, v13
    s_mul_i32 s3, s26, 15360
    v_add_u32 v2, s3, v1
    s_add_u32 s3, s26, 3
    s_and_b32 s3, s3, 3
    s_mul_i32 s3, s3, 15360
    s_add_u32 s3, s3, 0
    v_add_u32 v4, s3, v1
    s_add_u32 s3, s26, 2
    s_and_b32 s3, s3, 3
    s_mul_i32 s3, s3, 15360
    s_add_u32 s3, s3, 5120
    v_add_u32 v5, s3, v1
    s_add_u32 s3, s26, 1
    s_and_b32 s3, s3, 3
    s_mul_i32 s3, s3, 15360
    s_add_u32 s3, s3, 10240
    v_add_u32 v6, s3, v1
    s_add_u32 s3, s26, 1
    s_and_b32 s3, s3, 3
    s_mul_i32 s20, s3, 49152
    s_add_u32 s3, s26, 2
    s_and_b32 s3, s3, 3
    s_mul_i32 s21, s3, 49152
    s_add_u32 s3, s26, 3
    s_and_b32 s3, s3, 3
    s_mul_i32 s22, s3, 49152
    s_add_u32 s3, s26, 4
    s_and_b32 s3, s3, 3
    s_mul_i32 s23, s3, 49152
    v_add_u32 v203, 0x20000, v7
    s_cmp_ge_u32 0, s26
    s_cselect_b32 s3, 1, 0
    s_mul_i32 s20, s3, 49152
    s_sub_u32 s3, s3, s26
    s_add_u32 s3, s3, 3
    s_and_b32 s3, s3, 3
    s_mul_i32 s3, s3, 5120
    v_add_u32 v200, s3, v2
    s_cmp_ge_u32 1, s26
    s_cselect_b32 s3, 2, 1
    s_mul_i32 s21, s3, 49152
    s_sub_u32 s3, s3, s26
    s_add_u32 s3, s3, 3
    s_and_b32 s3, s3, 3
    s_mul_i32 s3, s3, 5120
    v_add_u32 v201, s3, v2
    s_cmp_ge_u32 2, s26
    s_cselect_b32 s3, 3, 2
    s_mul_i32 s22, s3, 49152
    s_sub_u32 s3, s3, s26
    s_add_u32 s3, s3, 3
    s_and_b32 s3, s3, 3
    s_mul_i32 s3, s3, 5120
    v_add_u32 v202, s3, v2
    ds_read_b128 v[160:163], v13 offset:640
    ds_read_b128 v[164:167], v13 offset:704
    ds_read_b128 v[168:171], v13 offset:768
    ds_read_b128 v[172:175], v13 offset:832
    ds_read_b128 v[176:179], v13 offset:896
    v_lshlrev_b32 v180, 16, v246
    v_and_b32 v181, 0xffff0000, v246
    v_lshlrev_b32 v182, 16, v247
    v_and_b32 v183, 0xffff0000, v247
    v_lshlrev_b32 v184, 16, v248
    v_and_b32 v185, 0xffff0000, v248
    v_lshlrev_b32 v186, 16, v249
    v_and_b32 v187, 0xffff0000, v249
    v_lshlrev_b32 v188, 16, v250
    v_and_b32 v189, 0xffff0000, v250
    v_lshlrev_b32 v190, 16, v251
    v_and_b32 v191, 0xffff0000, v251
    v_lshlrev_b32 v192, 16, v252
    v_and_b32 v193, 0xffff0000, v252
    v_lshlrev_b32 v194, 16, v253
    v_and_b32 v195, 0xffff0000, v253
    v_lshlrev_b32 v196, 16, v254
    v_and_b32 v197, 0xffff0000, v254
    v_lshlrev_b32 v198, 16, v255
    v_and_b32 v199, 0xffff0000, v255
    s_lshl_b32 s3, s81, 12
    s_add_u32 s3, s3, 8126464
    s_lshl_b32 s2, s82, 9
    s_lshl_b32 s66, s80, 7
    s_add_u32 s3, s3, s2
    s_add_u32 s3, s3, s66
    v_mov_b32 v8, s3
    s_mov_b32 s89, 45056
    buffer_load_dwordx4 a[176:179], v15, s[32:35], s89 offen offset:0 sc1
    buffer_load_dwordx4 a[180:183], v15, s[32:35], s89 offen offset:1024 sc1
    buffer_load_dwordx4 a[184:187], v15, s[32:35], s89 offen offset:2048 sc1
    buffer_load_dwordx4 a[188:191], v15, s[32:35], s89 offen offset:3072 sc1
    s_mov_b32 s89, 49152
    buffer_load_dwordx4 a[192:195], v15, s[32:35], s89 offen offset:0 sc1
    s_mov_b64 exec, 1
    s_waitcnt vmcnt(5)
    v_mov_b32 v14, s84
    buffer_store_dword v14, v8, s[32:35], 0 offen sc1
    s_mov_b64 exec, -1
    buffer_load_dwordx4 a[196:199], v15, s[32:35], s89 offen offset:1024 sc1
    buffer_load_dwordx4 a[200:203], v15, s[32:35], s89 offen offset:2048 sc1
    buffer_load_dwordx4 a[204:207], v15, s[32:35], s89 offen offset:3072 sc1
    s_mov_b32 s89, 53248
    buffer_load_dwordx4 a[208:211], v15, s[32:35], s89 offen offset:0 sc1
    buffer_load_dwordx4 a[212:215], v15, s[32:35], s89 offen offset:1024 sc1
    s_mov_b32 s88, 400000
L_poll_49:
    s_mov_b64 exec, 0xff
    buffer_load_dword v14, v7, s[32:35], 0 offen sc1
    s_sub_u32 s88, s88, 1
    s_cbranch_scc1 L_end
    s_waitcnt vmcnt(0)
    v_cmp_ne_u32 vcc, s84, v14
    s_cbranch_vccnz L_poll_49
    s_mov_b64 exec, -1
    buffer_load_dwordx4 v[16:19], v3, s[32:35], s20 offen offset:0 sc1
    buffer_load_dwordx4 v[20:23], v3, s[32:35], s20 offen offset:1024 sc1
    buffer_load_dwordx4 v[24:27], v3, s[32:35], s20 offen offset:2048 sc1
    s_mov_b32 s89, 55296
    buffer_load_dwordx4 a[216:219], v15, s[32:35], s89 offen offset:0 sc1
    buffer_load_dwordx4 a[220:223], v15, s[32:35], s89 offen offset:1024 sc1
    buffer_load_dwordx4 v[28:31], v3, s[32:35], s20 offen offset:3072 sc1
    buffer_load_dwordx4 a[224:227], v15, s[32:35], s89 offen offset:2048 sc1
    buffer_load_dwordx4 a[228:231], v15, s[32:35], s89 offen offset:3072 sc1
    s_add_u32 s89, s20, 4096
    buffer_load_dwordx4 v[32:35], v3, s[32:35], s89 offen offset:0 sc1
    s_mov_b32 s89, 59392
    buffer_load_dwordx4 a[232:235], v15, s[32:35], s89 offen offset:0 sc1
    buffer_load_dwordx4 a[236:239], v15, s[32:35], s89 offen offset:1024 sc1
    s_add_u32 s89, s20, 4096
    buffer_load_dwordx4 v[36:39], v3, s[32:35], s89 offen offset:1024 sc1
    buffer_load_dwordx4 v[40:43], v3, s[32:35], s89 offen offset:2048 sc1
    s_mov_b64 exec, 0xff
    buffer_load_dword v14, v203, s[32:35], 0 offen sc1
    s_mov_b64 exec, -1
    s_waitcnt vmcnt(13)
    v_mfma_f32_16x16x32_bf16 v[204:207], a[0:3], v[16:19], 0
    v_mfma_f32_16x16x32_bf16 v[208:211], a[4:7], v[16:19], 0
    v_mfma_f32_16x16x32_bf16 v[212:215], a[8:11], v[16:19], 0
    buffer_load_dwordx4 v[44:47], v3, s[32:35], s89 offen offset:3072 sc1
    v_mfma_f32_16x16x32_bf16 v[216:219], a[12:15], v[16:19], 0
    v_mfma_f32_16x16x32_bf16 v[220:223], a[16:19], v[16:19], 0
    s_waitcnt vmcnt(13)
    v_mfma_f32_16x16x32_bf16 v[204:207], a[20:23], v[20:23], v[204:207]
    v_mfma_f32_16x16x32_bf16 v[208:211], a[24:27], v[20:23], v[208:211]
    v_mfma_f32_16x16x32_bf16 v[212:215], a[28:31], v[20:23], v[212:215]
    s_add_u32 s89, s20, 8192
    buffer_load_dwordx4 v[48:51], v3, s[32:35], s89 offen offset:0 sc1
    v_mfma_f32_16x16x32_bf16 v[216:219], a[32:35], v[20:23], v[216:219]
    v_mfma_f32_16x16x32_bf16 v[220:223], a[36:39], v[20:23], v[220:223]
    s_waitcnt vmcnt(13)
    v_mfma_f32_16x16x32_bf16 v[204:207], a[40:43], v[24:27], v[204:207]
    v_mfma_f32_16x16x32_bf16 v[208:211], a[44:47], v[24:27], v[208:211]
    v_mfma_f32_16x16x32_bf16 v[212:215], a[48:51], v[24:27], v[212:215]
    buffer_load_dwordx4 v[52:55], v3, s[32:35], s89 offen offset:1024 sc1
    v_mfma_f32_16x16x32_bf16 v[216:219], a[52:55], v[24:27], v[216:219]
    v_mfma_f32_16x16x32_bf16 v[220:223], a[56:59], v[24:27], v[220:223]
    s_waitcnt vmcnt(11)
    v_mfma_f32_16x16x32_bf16 v[204:207], a[60:63], v[28:31], v[204:207]
    v_mfma_f32_16x16x32_bf16 v[208:211], a[64:67], v[28:31], v[208:211]
    v_mfma_f32_16x16x32_bf16 v[212:215], a[68:71], v[28:31], v[212:215]
    buffer_load_dwordx4 v[56:59], v3, s[32:35], s89 offen offset:2048 sc1
    v_mfma_f32_16x16x32_bf16 v[216:219], a[72:75], v[28:31], v[216:219]
    v_mfma_f32_16x16x32_bf16 v[220:223], a[76:79], v[28:31], v[220:223]
    s_waitcnt vmcnt(9)
    v_mfma_f32_16x16x32_bf16 v[204:207], a[80:83], v[32:35], v[204:207]
    v_mfma_f32_16x16x32_bf16 v[208:211], a[84:87], v[32:35], v[208:211]
    v_mfma_f32_16x16x32_bf16 v[212:215], a[88:91], v[32:35], v[212:215]
    buffer_load_dwordx4 v[60:63], v3, s[32:35], s89 offen offset:3072 sc1
    v_mfma_f32_16x16x32_bf16 v[216:219], a[92:95], v[32:35], v[216:219]
    v_mfma_f32_16x16x32_bf16 v[220:223], a[96:99], v[32:35], v[220:223]
    s_waitcnt vmcnt(7)
    v_mfma_f32_16x16x32_bf16 v[204:207], a[100:103], v[36:39], v[204:207]
    v_mfma_f32_16x16x32_bf16 v[208:211], a[104:107], v[36:39], v[208:211]
    v_mfma_f32_16x16x32_bf16 v[212:215], a[108:111], v[36:39], v[212:215]
    s_waitcnt vmcnt(5)
    s_mov_b64 exec, 0xff
    v_cmp_ne_u32 vcc, s84, v14
    s_mov_b64 exec, -1
    s_cbranch_vccz L_ptok_51
    s_mov_b32 s88, 400000
L_poll_52:
    s_mov_b64 exec, 0xff
    buffer_load_dword v14, v203, s[32:35], 0 offen sc1
    s_sub_u32 s88, s88, 1
    s_cbranch_scc1 L_end
    s_waitcnt vmcnt(0)
    v_cmp_ne_u32 vcc, s84, v14
    s_cbranch_vccnz L_poll_52
    s_mov_b64 exec, -1
L_ptok_51:
    buffer_load_dwordx4 v[64:67], v3, s[32:35], s21 offen offset:0 sc1
    v_mfma_f32_16x16x32_bf16 v[216:219], a[112:115], v[36:39], v[216:219]
    v_mfma_f32_16x16x32_bf16 v[220:223], a[116:119], v[36:39], v[220:223]
    v_mfma_f32_16x16x32_bf16 v[204:207], a[120:123], v[40:43], v[204:207]
    v_mfma_f32_16x16x32_bf16 v[208:211], a[124:127], v[40:43], v[208:211]
    v_mfma_f32_16x16x32_bf16 v[212:215], a[128:131], v[40:43], v[212:215]
    buffer_load_dwordx4 v[68:71], v3, s[32:35], s21 offen offset:1024 sc1
    v_mfma_f32_16x16x32_bf16 v[216:219], a[132:135], v[40:43], v[216:219]
    v_mfma_f32_16x16x32_bf16 v[220:223], a[136:139], v[40:43], v[220:223]
    s_waitcnt vmcnt(6)
    v_mfma_f32_16x16x32_bf16 v[204:207], a[140:143], v[44:47], v[204:207]
    v_mfma_f32_16x16x32_bf16 v[208:211], a[144:147], v[44:47], v[208:211]
    v_mfma_f32_16x16x32_bf16 v[212:215], a[148:151], v[44:47], v[212:215]
    buffer_load_dwordx4 v[72:75], v3, s[32:35], s21 offen offset:2048 sc1
    v_mfma_f32_16x16x32_bf16 v[216:219], a[152:155], v[44:47], v[216:219]
    v_mfma_f32_16x16x32_bf16 v[220:223], a[156:159], v[44:47], v[220:223]
    s_waitcnt vmcnt(6)
    v_mfma_f32_16x16x32_bf16 v[204:207], a[160:163], v[48:51], v[204:207]
    v_mfma_f32_16x16x32_bf16 v[208:211], a[164:167], v[48:51], v[208:211]
    v_mfma_f32_16x16x32_bf16 v[212:215], a[168:171], v[48:51], v[212:215]
    buffer_load_dwordx4 v[76:79], v3, s[32:35], s21 offen offset:3072 sc1
    v_mfma_f32_16x16x32_bf16 v[216:219], a[172:175], v[48:51], v[216:219]
    v_mfma_f32_16x16x32_bf16 v[220:223], a[176:179], v[48:51], v[220:223]
    s_waitcnt vmcnt(6)
    v_mfma_f32_16x16x32_bf16 v[204:207], a[180:183], v[52:55], v[204:207]
    v_mfma_f32_16x16x32_bf16 v[208:211], a[184:187], v[52:55], v[208:211]
    v_mfma_f32_16x16x32_bf16 v[212:215], a[188:191], v[52:55], v[212:215]
    s_add_u32 s89, s21, 4096
    buffer_load_dwordx4 v[80:83], v3, s[32:35], s89 offen offset:0 sc1
    v_mfma_f32_16x16x32_bf16 v[216:219], a[192:195], v[52:55], v[216:219]
    v_mfma_f32_16x16x32_bf16 v[220:223], a[196:199], v[52:55], v[220:223]
    s_waitcnt vmcnt(6)
    v_mfma_f32_16x16x32_bf16 v[204:207], a[200:203], v[56:59], v[204:207]
    v_mfma_f32_16x16x32_bf16 v[208:211], a[204:207], v[56:59], v[208:211]
    v_mfma_f32_16x16x32_bf16 v[212:215], a[208:211], v[56:59], v[212:215]
    buffer_load_dwordx4 v[84:87], v3, s[32:35], s89 offen offset:1024 sc1
    v_mfma_f32_16x16x32_bf16 v[216:219], a[212:215], v[56:59], v[216:219]
    v_mfma_f32_16x16x32_bf16 v[220:223], a[216:219], v[56:59], v[220:223]
    s_waitcnt vmcnt(6)
    v_mfma_f32_16x16x32_bf16 v[204:207], a[220:223], v[60:63], v[204:207]
    v_mfma_f32_16x16x32_bf16 v[208:211], a[224:227], v[60:63], v[208:211]
    v_mfma_f32_16x16x32_bf16 v[212:215], a[228:231], v[60:63], v[212:215]
    buffer_load_dwordx4 v[88:91], v3, s[32:35], s89 offen offset:2048 sc1
    v_mfma_f32_16x16x32_bf16 v[216:219], a[232:235], v[60:63], v[216:219]
    v_mfma_f32_16x16x32_bf16 v[220:223], a[236:239], v[60:63], v[220:223]
    s_waitcnt vmcnt(6)
    v_mfma_f32_16x16x32_bf16 v[224:227], a[0:3], v[64:67], 0
    v_mfma_f32_16x16x32_bf16 v[228:231], a[4:7], v[64:67], 0
    v_mfma_f32_16x16x32_bf16 v[232:235], a[8:11], v[64:67], 0
    buffer_load_dwordx4 v[92:95], v3, s[32:35], s89 offen offset:3072 sc1
    v_mfma_f32_16x16x32_bf16 v[236:239], a[12:15], v[64:67], 0
    v_mfma_f32_16x16x32_bf16 v[240:243], a[16:19], v[64:67], 0
    s_waitcnt vmcnt(6)
    v_mfma_f32_16x16x32_bf16 v[224:227], a[20:23], v[68:71], v[224:227]
    ds_write_b128 v200, v[204:207] offset:0
    v_mfma_f32_16x16x32_bf16 v[228:231], a[24:27], v[68:71], v[228:231]
    ds_write_b128 v200, v[208:211] offset:1024
    v_mfma_f32_16x16x32_bf16 v[232:235], a[28:31], v[68:71], v[232:235]
    s_add_u32 s89, s21, 8192
    buffer_load_dwordx4 v[96:99], v3, s[32:35], s89 offen offset:0 sc1
    v_mfma_f32_16x16x32_bf16 v[236:239], a[32:35], v[68:71], v[236:239]
    ds_write_b128 v200, v[212:215] offset:2048
    v_mfma_f32_16x16x32_bf16 v[240:243], a[36:39], v[68:71], v[240:243]
    ds_write_b128 v200, v[216:219] offset:3072
    s_waitcnt vmcnt(6)
    v_mfma_f32_16x16x32_bf16 v[224:227], a[40:43], v[72:75], v[224:227]
    ds_write_b128 v200, v[220:223] offset:4096
    v_mfma_f32_16x16x32_bf16 v[228:231], a[44:47], v[72:75], v[228:231]
    v_mfma_f32_16x16x32_bf16 v[232:235], a[48:51], v[72:75], v[232:235]
    buffer_load_dwordx4 v[100:103], v3, s[32:35], s89 offen offset:1024 sc1
    v_mfma_f32_16x16x32_bf16 v[236:239], a[52:55], v[72:75], v[236:239]
    v_mfma_f32_16x16x32_bf16 v[240:243], a[56:59], v[72:75], v[240:243]
    s_waitcnt vmcnt(6)
    v_mfma_f32_16x16x32_bf16 v[224:227], a[60:63], v[76:79], v[224:227]
    v_mfma_f32_16x16x32_bf16 v[228:231], a[64:67], v[76:79], v[228:231]
    v_mfma_f32_16x16x32_bf16 v[232:235], a[68:71], v[76:79], v[232:235]
    buffer_load_dwordx4 v[104:107], v3, s[32:35], s89 offen offset:2048 sc1
    v_mfma_f32_16x16x32_bf16 v[236:239], a[72:75], v[76:79], v[236:239]
    v_mfma_f32_16x16x32_bf16 v[240:243], a[76:79], v[76:79], v[240:243]
    s_waitcnt vmcnt(6)
    v_mfma_f32_16x16x32_bf16 v[224:227], a[80:83], v[80:83], v[224:227]
    v_mfma_f32_16x16x32_bf16 v[228:231], a[84:87], v[80:83], v[228:231]
    v_mfma_f32_16x16x32_bf16 v[232:235], a[88:91], v[80:83], v[232:235]
    buffer_load_dwordx4 v[108:111], v3, s[32:35], s89 offen offset:3072 sc1
    v_mfma_f32_16x16x32_bf16 v[236:239], a[92:95], v[80:83], v[236:239]
    v_mfma_f32_16x16x32_bf16 v[240:243], a[96:99], v[80:83], v[240:243]
    s_waitcnt vmcnt(6)
    v_mfma_f32_16x16x32_bf16 v[224:227], a[100:103], v[84:87], v[224:227]
    v_mfma_f32_16x16x32_bf16 v[228:231], a[104:107], v[84:87], v[228:231]
    v_mfma_f32_16x16x32_bf16 v[232:235], a[108:111], v[84:87], v[232:235]
    buffer_load_dwordx4 v[112:115], v3, s[32:35], s22 offen offset:0 sc1
    v_mfma_f32_16x16x32_bf16 v[236:239], a[112:115], v[84:87], v[236:239]
    v_mfma_f32_16x16x32_bf16 v[240:243], a[116:119], v[84:87], v[240:243]
    s_waitcnt vmcnt(6)
    v_mfma_f32_16x16x32_bf16 v[224:227], a[120:123], v[88:91], v[224:227]
    v_mfma_f32_16x16x32_bf16 v[228:231], a[124:127], v[88:91], v[228:231]
    v_mfma_f32_16x16x32_bf16 v[232:235], a[128:131], v[88:91], v[232:235]
    buffer_load_dwordx4 v[116:119], v3, s[32:35], s22 offen offset:1024 sc1
    v_mfma_f32_16x16x32_bf16 v[236:239], a[132:135], v[88:91], v[236:239]
    v_mfma_f32_16x16x32_bf16 v[240:243], a[136:139], v[88:91], v[240:243]
    s_waitcnt vmcnt(6)
    v_mfma_f32_16x16x32_bf16 v[224:227], a[140:143], v[92:95], v[224:227]
    v_mfma_f32_16x16x32_bf16 v[228:231], a[144:147], v[92:95], v[228:231]
    v_mfma_f32_16x16x32_bf16 v[232:235], a[148:151], v[92:95], v[232:235]
    buffer_load_dwordx4 v[120:123], v3, s[32:35], s22 offen offset:2048 sc1
    v_mfma_f32_16x16x32_bf16 v[236:239], a[152:155], v[92:95], v[236:239]
    v_mfma_f32_16x16x32_bf16 v[240:243], a[156:159], v[92:95], v[240:243]
    s_waitcnt vmcnt(6)
    v_mfma_f32_16x16x32_bf16 v[224:227], a[160:163], v[96:99], v[224:227]
    v_mfma_f32_16x16x32_bf16 v[228:231], a[164:167], v[96:99], v[228:231]
    v_mfma_f32_16x16x32_bf16 v[232:235], a[168:171], v[96:99], v[232:235]
    buffer_load_dwordx4 v[124:127], v3, s[32:35], s22 offen offset:3072 sc1
    v_mfma_f32_16x16x32_bf16 v[236:239], a[172:175], v[96:99], v[236:239]
    v_mfma_f32_16x16x32_bf16 v[240:243], a[176:179], v[96:99], v[240:243]
    s_waitcnt vmcnt(6)
    v_mfma_f32_16x16x32_bf16 v[224:227], a[180:183], v[100:103], v[224:227]
    v_mfma_f32_16x16x32_bf16 v[228:231], a[184:187], v[100:103], v[228:231]
    v_mfma_f32_16x16x32_bf16 v[232:235], a[188:191], v[100:103], v[232:235]
    s_add_u32 s89, s22, 4096
    buffer_load_dwordx4 v[128:131], v3, s[32:35], s89 offen offset:0 sc1
    v_mfma_f32_16x16x32_bf16 v[236:239], a[192:195], v[100:103], v[236:239]
    v_mfma_f32_16x16x32_bf16 v[240:243], a[196:199], v[100:103], v[240:243]
    s_waitcnt vmcnt(6)
    v_mfma_f32_16x16x32_bf16 v[224:227], a[200:203], v[104:107], v[224:227]
    v_mfma_f32_16x16x32_bf16 v[228:231], a[204:207], v[104:107], v[228:231]
    v_mfma_f32_16x16x32_bf16 v[232:235], a[208:211], v[104:107], v[232:235]
    buffer_load_dwordx4 v[132:135], v3, s[32:35], s89 offen offset:1024 sc1
    v_mfma_f32_16x16x32_bf16 v[236:239], a[212:215], v[104:107], v[236:239]
    v_mfma_f32_16x16x32_bf16 v[240:243], a[216:219], v[104:107], v[240:243]
    s_waitcnt vmcnt(6)
    v_mfma_f32_16x16x32_bf16 v[224:227], a[220:223], v[108:111], v[224:227]
    v_mfma_f32_16x16x32_bf16 v[228:231], a[224:227], v[108:111], v[228:231]
    v_mfma_f32_16x16x32_bf16 v[232:235], a[228:231], v[108:111], v[232:235]
    buffer_load_dwordx4 v[136:139], v3, s[32:35], s89 offen offset:2048 sc1
    v_mfma_f32_16x16x32_bf16 v[236:239], a[232:235], v[108:111], v[236:239]
    v_mfma_f32_16x16x32_bf16 v[240:243], a[236:239], v[108:111], v[240:243]
    s_waitcnt vmcnt(6)
    v_mfma_f32_16x16x32_bf16 v[204:207], a[0:3], v[112:115], 0
    v_mfma_f32_16x16x32_bf16 v[208:211], a[4:7], v[112:115], 0
    v_mfma_f32_16x16x32_bf16 v[212:215], a[8:11], v[112:115], 0
    buffer_load_dwordx4 v[140:143], v3, s[32:35], s89 offen offset:3072 sc1
    v_mfma_f32_16x16x32_bf16 v[216:219], a[12:15], v[112:115], 0
    v_mfma_f32_16x16x32_bf16 v[220:223], a[16:19], v[112:115], 0
    s_waitcnt vmcnt(6)
    v_mfma_f32_16x16x32_bf16 v[204:207], a[20:23], v[116:119], v[204:207]
    ds_write_b128 v201, v[224:227] offset:0
    v_mfma_f32_16x16x32_bf16 v[208:211], a[24:27], v[116:119], v[208:211]
    ds_write_b128 v201, v[228:231] offset:1024
    v_mfma_f32_16x16x32_bf16 v[212:215], a[28:31], v[116:119], v[212:215]
    s_add_u32 s89, s22, 8192
    buffer_load_dwordx4 v[144:147], v3, s[32:35], s89 offen offset:0 sc1
    v_mfma_f32_16x16x32_bf16 v[216:219], a[32:35], v[116:119], v[216:219]
    ds_write_b128 v201, v[232:235] offset:2048
    v_mfma_f32_16x16x32_bf16 v[220:223], a[36:39], v[116:119], v[220:223]
    ds_write_b128 v201, v[236:239] offset:3072
    s_waitcnt vmcnt(6)
    v_mfma_f32_16x16x32_bf16 v[204:207], a[40:43], v[120:123], v[204:207]
    ds_write_b128 v201, v[240:243] offset:4096
    v_mfma_f32_16x16x32_bf16 v[208:211], a[44:47], v[120:123], v[208:211]
    v_mfma_f32_16x16x32_bf16 v[212:215], a[48:51], v[120:123], v[212:215]
    buffer_load_dwordx4 v[148:151], v3, s[32:35], s89 offen offset:1024 sc1
    v_mfma_f32_16x16x32_bf16 v[216:219], a[52:55], v[120:123], v[216:219]
    v_mfma_f32_16x16x32_bf16 v[220:223], a[56:59], v[120:123], v[220:223]
    s_waitcnt vmcnt(6)
    v_mfma_f32_16x16x32_bf16 v[204:207], a[60:63], v[124:127], v[204:207]
    v_mfma_f32_16x16x32_bf16 v[208:211], a[64:67], v[124:127], v[208:211]
    v_mfma_f32_16x16x32_bf16 v[212:215], a[68:71], v[124:127], v[212:215]
    buffer_load_dwordx4 v[152:155], v3, s[32:35], s89 offen offset:2048 sc1
    v_mfma_f32_16x16x32_bf16 v[216:219], a[72:75], v[124:127], v[216:219]
    v_mfma_f32_16x16x32_bf16 v[220:223], a[76:79], v[124:127], v[220:223]
    s_waitcnt vmcnt(6)
    v_mfma_f32_16x16x32_bf16 v[204:207], a[80:83], v[128:131], v[204:207]
    v_mfma_f32_16x16x32_bf16 v[208:211], a[84:87], v[128:131], v[208:211]
    v_mfma_f32_16x16x32_bf16 v[212:215], a[88:91], v[128:131], v[212:215]
    buffer_load_dwordx4 v[156:159], v3, s[32:35], s89 offen offset:3072 sc1
    v_mfma_f32_16x16x32_bf16 v[216:219], a[92:95], v[128:131], v[216:219]
    v_mfma_f32_16x16x32_bf16 v[220:223], a[96:99], v[128:131], v[220:223]
    s_waitcnt vmcnt(6)
    v_mfma_f32_16x16x32_bf16 v[204:207], a[100:103], v[132:135], v[204:207]
    v_mfma_f32_16x16x32_bf16 v[208:211], a[104:107], v[132:135], v[208:211]
    v_mfma_f32_16x16x32_bf16 v[212:215], a[108:111], v[132:135], v[212:215]
    buffer_load_dwordx4 v[16:19], v3, s[32:35], s23 offen offset:0 sc1
    v_mfma_f32_16x16x32_bf16 v[216:219], a[112:115], v[132:135], v[216:219]
    v_mfma_f32_16x16x32_bf16 v[220:223], a[116:119], v[132:135], v[220:223]
    s_waitcnt vmcnt(6)
    v_mfma_f32_16x16x32_bf16 v[204:207], a[120:123], v[136:139], v[204:207]
    v_mfma_f32_16x16x32_bf16 v[208:211], a[124:127], v[136:139], v[208:211]
    v_mfma_f32_16x16x32_bf16 v[212:215], a[128:131], v[136:139], v[212:215]
    buffer_load_dwordx4 v[20:23], v3, s[32:35], s23 offen offset:1024 sc1
    v_mfma_f32_16x16x32_bf16 v[216:219], a[132:135], v[136:139], v[216:219]
    v_mfma_f32_16x16x32_bf16 v[220:223], a[136:139], v[136:139], v[220:223]
    s_waitcnt vmcnt(6)
    v_mfma_f32_16x16x32_bf16 v[204:207], a[140:143], v[140:143], v[204:207]
    v_mfma_f32_16x16x32_bf16 v[208:211], a[144:147], v[140:143], v[208:211]
    v_mfma_f32_16x16x32_bf16 v[212:215], a[148:151], v[140:143], v[212:215]
    buffer_load_dwordx4 v[24:27], v3, s[32:35], s23 offen offset:2048 sc1
    v_mfma_f32_16x16x32_bf16 v[216:219], a[152:155], v[140:143], v[216:219]
    v_mfma_f32_16x16x32_bf16 v[220:223], a[156:159], v[140:143], v[220:223]
    s_waitcnt vmcnt(6)
    v_mfma_f32_16x16x32_bf16 v[204:207], a[160:163], v[144:147], v[204:207]
    v_mfma_f32_16x16x32_bf16 v[208:211], a[164:167], v[144:147], v[208:211]
    v_mfma_f32_16x16x32_bf16 v[212:215], a[168:171], v[144:147], v[212:215]
    buffer_load_dwordx4 v[28:31], v3, s[32:35], s23 offen offset:3072 sc1
    v_mfma_f32_16x16x32_bf16 v[216:219], a[172:175], v[144:147], v[216:219]
    v_mfma_f32_16x16x32_bf16 v[220:223], a[176:179], v[144:147], v[220:223]
    s_waitcnt vmcnt(6)
    v_mfma_f32_16x16x32_bf16 v[204:207], a[180:183], v[148:151], v[204:207]
    v_mfma_f32_16x16x32_bf16 v[208:211], a[184:187], v[148:151], v[208:211]
    v_mfma_f32_16x16x32_bf16 v[212:215], a[188:191], v[148:151], v[212:215]
    s_add_u32 s89, s23, 4096
    buffer_load_dwordx4 v[32:35], v3, s[32:35], s89 offen offset:0 sc1
    v_mfma_f32_16x16x32_bf16 v[216:219], a[192:195], v[148:151], v[216:219]
    v_mfma_f32_16x16x32_bf16 v[220:223], a[196:199], v[148:151], v[220:223]
    s_waitcnt vmcnt(6)
    v_mfma_f32_16x16x32_bf16 v[204:207], a[200:203], v[152:155], v[204:207]
    v_mfma_f32_16x16x32_bf16 v[208:211], a[204:207], v[152:155], v[208:211]
    v_mfma_f32_16x16x32_bf16 v[212:215], a[208:211], v[152:155], v[212:215]
    buffer_load_dwordx4 v[36:39], v3, s[32:35], s89 offen offset:1024 sc1
    v_mfma_f32_16x16x32_bf16 v[216:219], a[212:215], v[152:155], v[216:219]
    v_mfma_f32_16x16x32_bf16 v[220:223], a[216:219], v[152:155], v[220:223]
    s_waitcnt vmcnt(6)
    v_mfma_f32_16x16x32_bf16 v[204:207], a[220:223], v[156:159], v[204:207]
    v_mfma_f32_16x16x32_bf16 v[208:211], a[224:227], v[156:159], v[208:211]
    v_mfma_f32_16x16x32_bf16 v[212:215], a[228:231], v[156:159], v[212:215]
    buffer_load_dwordx4 v[40:43], v3, s[32:35], s89 offen offset:2048 sc1
    v_mfma_f32_16x16x32_bf16 v[216:219], a[232:235], v[156:159], v[216:219]
    v_mfma_f32_16x16x32_bf16 v[220:223], a[236:239], v[156:159], v[220:223]
    s_waitcnt vmcnt(6)
    v_mfma_f32_16x16x32_bf16 v[224:227], a[0:3], v[16:19], 0
    v_mfma_f32_16x16x32_bf16 v[228:231], a[4:7], v[16:19], 0
    v_mfma_f32_16x16x32_bf16 v[232:235], a[8:11], v[16:19], 0
    buffer_load_dwordx4 v[44:47], v3, s[32:35], s89 offen offset:3072 sc1
    v_mfma_f32_16x16x32_bf16 v[236:239], a[12:15], v[16:19], 0
    v_mfma_f32_16x16x32_bf16 v[240:243], a[16:19], v[16:19], 0
    s_waitcnt vmcnt(6)
    v_mfma_f32_16x16x32_bf16 v[224:227], a[20:23], v[20:23], v[224:227]
    ds_write_b128 v202, v[204:207] offset:0
    v_mfma_f32_16x16x32_bf16 v[228:231], a[24:27], v[20:23], v[228:231]
    ds_write_b128 v202, v[208:211] offset:1024
    v_mfma_f32_16x16x32_bf16 v[232:235], a[28:31], v[20:23], v[232:235]
    s_add_u32 s89, s23, 8192
    buffer_load_dwordx4 v[48:51], v3, s[32:35], s89 offen offset:0 sc1
    v_mfma_f32_16x16x32_bf16 v[236:239], a[32:35], v[20:23], v[236:239]
    ds_write_b128 v202, v[212:215] offset:2048
    v_mfma_f32_16x16x32_bf16 v[240:243], a[36:39], v[20:23], v[240:243]
    ds_write_b128 v202, v[216:219] offset:3072
    s_waitcnt vmcnt(6)
    v_mfma_f32_16x16x32_bf16 v[224:227], a[40:43], v[24:27], v[224:227]
    ds_write_b128 v202, v[220:223] offset:4096
    v_mfma_f32_16x16x32_bf16 v[228:231], a[44:47], v[24:27], v[228:231]
    v_mfma_f32_16x16x32_bf16 v[232:235], a[48:51], v[24:27], v[232:235]
    buffer_load_dwordx4 v[52:55], v3, s[32:35], s89 offen offset:1024 sc1
    s_waitcnt lgkmcnt(0)
    s_barrier
    v_mfma_f32_16x16x32_bf16 v[236:239], a[52:55], v[24:27], v[236:239]
    ds_read_b128 v[64:67], v4 offset:0
    v_mfma_f32_16x16x32_bf16 v[240:243], a[56:59], v[24:27], v[240:243]
    ds_read_b128 v[68:71], v4 offset:1024
    s_waitcnt vmcnt(6)
    v_mfma_f32_16x16x32_bf16 v[224:227], a[60:63], v[28:31], v[224:227]
    ds_read_b128 v[72:75], v4 offset:2048
    v_mfma_f32_16x16x32_bf16 v[228:231], a[64:67], v[28:31], v[228:231]
    ds_read_b128 v[76:79], v4 offset:3072
    v_mfma_f32_16x16x32_bf16 v[232:235], a[68:71], v[28:31], v[232:235]
    buffer_load_dwordx4 v[56:59], v3, s[32:35], s89 offen offset:2048 sc1
    ds_read_b128 v[80:83], v4 offset:4096
    v_mfma_f32_16x16x32_bf16 v[236:239], a[72:75], v[28:31], v[236:239]
    ds_read_b128 v[84:87], v5 offset:0
    v_mfma_f32_16x16x32_bf16 v[240:243], a[76:79], v[28:31], v[240:243]
    ds_read_b128 v[88:91], v5 offset:1024
    s_waitcnt vmcnt(6)
    v_mfma_f32_16x16x32_bf16 v[224:227], a[80:83], v[32:35], v[224:227]
    ds_read_b128 v[92:95], v5 offset:2048
    v_mfma_f32_16x16x32_bf16 v[228:231], a[84:87], v[32:35], v[228:231]
    ds_read_b128 v[96:99], v5 offset:3072
    v_mfma_f32_16x16x32_bf16 v[232:235], a[88:91], v[32:35], v[232:235]
    buffer_load_dwordx4 v[60:63], v3, s[32:35], s89 offen offset:3072 sc1
    ds_read_b128 v[100:103], v5 offset:4096
    v_mfma_f32_16x16x32_bf16 v[236:239], a[92:95], v[32:35], v[236:239]
    ds_read_b128 v[104:107], v6 offset:0
    v_mfma_f32_16x16x32_bf16 v[240:243], a[96:99], v[32:35], v[240:243]
    ds_read_b128 v[108:111], v6 offset:1024
    s_waitcnt vmcnt(6)
    v_mfma_f32_16x16x32_bf16 v[224:227], a[100:103], v[36:39], v[224:227]
    ds_read_b128 v[112:115], v6 offset:2048
    v_mfma_f32_16x16x32_bf16 v[228:231], a[104:107], v[36:39], v[228:231]
    ds_read_b128 v[116:119], v6 offset:3072
    v_mfma_f32_16x16x32_bf16 v[232:235], a[108:111], v[36:39], v[232:235]
    ds_read_b128 v[120:123], v6 offset:4096
    v_mfma_f32_16x16x32_bf16 v[236:239], a[112:115], v[36:39], v[236:239]
    v_mfma_f32_16x16x32_bf16 v[240:243], a[116:119], v[36:39], v[240:243]
    s_waitcnt vmcnt(5)
    v_mfma_f32_16x16x32_bf16 v[224:227], a[120:123], v[40:43], v[224:227]
    s_waitcnt lgkmcnt(5)
    v_add_f32 v64, v64, v84
    v_mfma_f32_16x16x32_bf16 v[228:231], a[124:127], v[40:43], v[228:231]
    v_add_f32 v65, v65, v85
    v_add_f32 v66, v66, v86
    v_mfma_f32_16x16x32_bf16 v[232:235], a[128:131], v[40:43], v[232:235]
    v_add_f32 v67, v67, v87
    v_add_f32 v68, v68, v88
    v_mfma_f32_16x16x32_bf16 v[236:239], a[132:135], v[40:43], v[236:239]
    v_add_f32 v69, v69, v89
    v_add_f32 v70, v70, v90
    v_mfma_f32_16x16x32_bf16 v[240:243], a[136:139], v[40:43], v[240:243]
    v_add_f32 v71, v71, v91
    v_add_f32 v72, v72, v92
    s_waitcnt vmcnt(4)
    v_mfma_f32_16x16x32_bf16 v[224:227], a[140:143], v[44:47], v[224:227]
    v_add_f32 v73, v73, v93
    v_add_f32 v74, v74, v94
    v_mfma_f32_16x16x32_bf16 v[228:231], a[144:147], v[44:47], v[228:231]
    v_add_f32 v75, v75, v95
    v_add_f32 v76, v76, v96
    v_mfma_f32_16x16x32_bf16 v[232:235], a[148:151], v[44:47], v[232:235]
    v_add_f32 v77, v77, v97
    v_add_f32 v78, v78, v98
    v_mfma_f32_16x16x32_bf16 v[236:239], a[152:155], v[44:47], v[236:239]
    v_add_f32 v79, v79, v99
    v_add_f32 v80, v80, v100
    v_mfma_f32_16x16x32_bf16 v[240:243], a[156:159], v[44:47], v[240:243]
    v_add_f32 v81, v81, v101
    v_add_f32 v82, v82, v102
    s_waitcnt vmcnt(3)
    v_mfma_f32_16x16x32_bf16 v[224:227], a[160:163], v[48:51], v[224:227]
    v_add_f32 v83, v83, v103
    s_waitcnt lgkmcnt(0)
    v_mfma_f32_16x16x32_bf16 v[228:231], a[164:167], v[48:51], v[228:231]
    v_add_f32 v64, v64, v104
    v_add_f32 v65, v65, v105
    v_mfma_f32_16x16x32_bf16 v[232:235], a[168:171], v[48:51], v[232:235]
    v_add_f32 v66, v66, v106
    v_add_f32 v67, v67, v107
    v_mfma_f32_16x16x32_bf16 v[236:239], a[172:175], v[48:51], v[236:239]
    v_add_f32 v68, v68, v108
    v_add_f32 v69, v69, v109
    v_mfma_f32_16x16x32_bf16 v[240:243], a[176:179], v[48:51], v[240:243]
    v_add_f32 v70, v70, v110
    v_add_f32 v71, v71, v111
    s_waitcnt vmcnt(2)
    v_mfma_f32_16x16x32_bf16 v[224:227], a[180:183], v[52:55], v[224:227]
    v_add_f32 v72, v72, v112
    v_add_f32 v73, v73, v113
    v_mfma_f32_16x16x32_bf16 v[228:231], a[184:187], v[52:55], v[228:231]
    v_add_f32 v74, v74, v114
    v_add_f32 v75, v75, v115
    v_mfma_f32_16x16x32_bf16 v[232:235], a[188:191], v[52:55], v[232:235]
    v_add_f32 v76, v76, v116
    v_add_f32 v77, v77, v117
    v_mfma_f32_16x16x32_bf16 v[236:239], a[192:195], v[52:55], v[236:239]
    v_add_f32 v78, v78, v118
    v_add_f32 v79, v79, v119
    v_mfma_f32_16x16x32_bf16 v[240:243], a[196:199], v[52:55], v[240:243]
    v_add_f32 v80, v80, v120
    v_add_f32 v81, v81, v121
    s_waitcnt vmcnt(1)
    v_mfma_f32_16x16x32_bf16 v[224:227], a[200:203], v[56:59], v[224:227]
    v_add_f32 v82, v82, v122
    v_add_f32 v83, v83, v123
    v_mfma_f32_16x16x32_bf16 v[228:231], a[204:207], v[56:59], v[228:231]
    v_fmac_f32 v180, v160, v64
    v_fmac_f32 v181, v161, v65
    v_mfma_f32_16x16x32_bf16 v[232:235], a[208:211], v[56:59], v[232:235]
    v_fmac_f32 v182, v162, v66
    v_fmac_f32 v183, v163, v67
    v_mfma_f32_16x16x32_bf16 v[236:239], a[212:215], v[56:59], v[236:239]
    v_fmac_f32 v184, v164, v68
    v_fmac_f32 v185, v165, v69
    v_mfma_f32_16x16x32_bf16 v[240:243], a[216:219], v[56:59], v[240:243]
    v_fmac_f32 v186, v166, v70
    v_fmac_f32 v187, v167, v71
    s_waitcnt vmcnt(0)
    v_mfma_f32_16x16x32_bf16 v[224:227], a[220:223], v[60:63], v[224:227]
    v_fmac_f32 v188, v168, v72
    v_fmac_f32 v189, v169, v73
    v_mfma_f32_16x16x32_bf16 v[228:231], a[224:227], v[60:63], v[228:231]
    v_fmac_f32 v190, v170, v74
    v_fmac_f32 v191, v171, v75
    v_mfma_f32_16x16x32_bf16 v[232:235], a[228:231], v[60:63], v[232:235]
    v_fmac_f32 v192, v172, v76
    v_fmac_f32 v193, v173, v77
    v_mfma_f32_16x16x32_bf16 v[236:239], a[232:235], v[60:63], v[236:239]
    v_fmac_f32 v194, v174, v78
    v_fmac_f32 v195, v175, v79
    v_mfma_f32_16x16x32_bf16 v[240:243], a[236:239], v[60:63], v[240:243]
    v_fmac_f32 v196, v176, v80
    v_fmac_f32 v197, v177, v81
    v_fmac_f32 v198, v178, v82
    v_fmac_f32 v199, v179, v83
    v_pk_fma_f32 v[224:225], v[224:225], v[160:161], v[180:181]
    v_pk_fma_f32 v[226:227], v[226:227], v[162:163], v[182:183]
    v_pk_fma_f32 v[228:229], v[228:229], v[164:165], v[184:185]
    v_pk_fma_f32 v[230:231], v[230:231], v[166:167], v[186:187]
    v_pk_fma_f32 v[232:233], v[232:233], v[168:169], v[188:189]
    v_pk_fma_f32 v[234:235], v[234:235], v[170:171], v[190:191]
    v_pk_fma_f32 v[236:237], v[236:237], v[172:173], v[192:193]
    v_pk_fma_f32 v[238:239], v[238:239], v[174:175], v[194:195]
    v_pk_fma_f32 v[240:241], v[240:241], v[176:177], v[196:197]
    v_pk_fma_f32 v[242:243], v[242:243], v[178:179], v[198:199]
    v_cvt_pk_bf16_f32 v16, v224, v225
    v_cvt_pk_bf16_f32 v17, v226, v227
    v_cvt_pk_bf16_f32 v18, v228, v229
    v_cvt_pk_bf16_f32 v19, v230, v231
    v_cvt_pk_bf16_f32 v20, v232, v233
    v_cvt_pk_bf16_f32 v21, v234, v235
    v_cvt_pk_bf16_f32 v22, v236, v237
    v_cvt_pk_bf16_f32 v23, v238, v239
    v_cvt_pk_bf16_f32 v24, v240, v241
    v_cvt_pk_bf16_f32 v25, v242, v243
    v_mov_b32 v26, v24
    v_mov_b32 v27, v25
    v_permlane16_swap_b32 v16, v18
    v_permlane16_swap_b32 v17, v19
    v_permlane16_swap_b32 v20, v22
    v_permlane16_swap_b32 v21, v23
    v_permlane16_swap_b32 v24, v26
    v_permlane16_swap_b32 v25, v27
    buffer_store_dwordx4 v[16:19], v12, s[76:79], 0 offen offset:0 nt
    buffer_store_dwordx4 v[20:23], v12, s[76:79], 0 offen offset:64 nt
    buffer_store_dwordx4 v[24:27], v10, s[76:79], 0 offen offset:128 nt
    s_add_u32 s3, s83, s80
    s_cmp_lg_u32 s3, 0
    s_cbranch_scc1 L_notag_54
    v_mov_b32 v13, 0
    v_mov_b32 v14, s85
    s_mov_b64 exec, 1
    buffer_store_dword v14, v13, s[32:35], 0 offen sc1
    s_mov_b64 exec, -1
L_notag_54:
    s_endpgm
L_slowpath_32:
    s_waitcnt vmcnt(0)
    v_and_b32 v13, 31, v0
    v_lshrrev_b32 v14, 5, v0
    v_lshlrev_b32 v14, 9, v14
    v_lshl_add_u32 v14, v13, 4, v14
    v_add_u32 v8, 102400, v14
    v_lshlrev_b32 v13, 3, v13
    v_add_u32 v9, 103424, v13
    s_mul_i32 s3, s80, 3072
    v_add_u32 v10, s3, v1
    s_mov_b32 s31, 0
    s_mov_b32 vcc_lo, 0
    s_mov_b32 vcc_hi, -1
    s_mov_b64 s[92:93], vcc
L_slow_55:
    ds_read_b128 v[88:91], v8
    ds_read_b64 v[92:93], v9
    v_mov_b32 v72, 0xff800000
    s_waitcnt lgkmcnt(0)
    v_mfma_f32_32x32x16_bf16 v[16:31], a[0:3], v[88:91], 0
    v_mfma_f32_32x32x8_bf16 v[16:31], a[8:9], v[92:93], v[16:31]
    s_nop 11
    v_max3_f32 v72, v72, v16, v17
    v_max3_f32 v72, v72, v18, v19
    v_max3_f32 v72, v72, v20, v21
    v_max3_f32 v72, v72, v22, v23
    v_max3_f32 v72, v72, v24, v25
    v_max3_f32 v72, v72, v26, v27
    v_max3_f32 v72, v72, v28, v29
    v_max3_f32 v72, v72, v30, v31
    v_mfma_f32_32x32x16_bf16 v[16:31], a[4:7], v[88:91], 0
    v_mfma_f32_32x32x8_bf16 v[16:31], a[10:11], v[92:93], v[16:31]
    s_nop 11
    v_max3_f32 v72, v72, v16, v17
    v_max3_f32 v72, v72, v18, v19
    v_max3_f32 v72, v72, v20, v21
    s_nop 8
    v_max3_f32 v72, v72, v22, v23
    v_max3_f32 v72, v72, v24, v25
    v_max3_f32 v72, v72, v26, v27
    v_max3_f32 v72, v72, v28, v29
    v_max3_f32 v72, v72, v30, v31
    v_mfma_f32_32x32x16_bf16 v[16:31], a[28:31], v[88:91], 0
    v_mfma_f32_32x32x8_bf16 v[16:31], a[36:37], v[92:93], v[16:31]
    s_nop 11
    v_max3_f32 v72, v72, v16, v17
    v_max3_f32 v72, v72, v18, v19
    s_nop 9
    v_max3_f32 v72, v72, v20, v21
    v_max3_f32 v72, v72, v22, v23
    v_max3_f32 v72, v72, v24, v25
    v_max3_f32 v72, v72, v26, v27
    s_nop 5
    v_max3_f32 v72, v72, v28, v29
    v_max3_f32 v72, v72, v30, v31
    v_mfma_f32_32x32x16_bf16 v[16:31], a[32:35], v[88:91], 0
    v_mfma_f32_32x32x8_bf16 v[16:31], a[38:39], v[92:93], v[16:31]
    s_nop 11
    v_max3_f32 v72, v72, v16, v17
    s_nop 10
    v_max3_f32 v72, v72, v18, v19
    v_max3_f32 v72, v72, v20, v21
    v_max3_f32 v72, v72, v22, v23
    s_nop 7
    v_max3_f32 v72, v72, v24, v25
    v_max3_f32 v72, v72, v26, v27
    v_max3_f32 v72, v72, v28, v29
    v_max3_f32 v72, v72, v30, v31
    v_mfma_f32_32x32x16_bf16 v[16:31], a[56:59], v[88:91], 0
    v_mfma_f32_32x32x8_bf16 v[16:31], a[64:65], v[92:93], v[16:31]
    s_nop 11
    v_max3_f32 v72, v72, v16, v17
    v_max3_f32 v72, v72, v18, v19
    v_max3_f32 v72, v72, v20, v21
    v_max3_f32 v72, v72, v22, v23
    v_max3_f32 v72, v72, v24, v25
    v_max3_f32 v72, v72, v26, v27
    v_max3_f32 v72, v72, v28, v29
    v_max3_f32 v72, v72, v30, v31
    v_mfma_f32_32x32x16_bf16 v[16:31], a[60:63], v[88:91], 0
    v_mfma_f32_32x32x8_bf16 v[16:31], a[66:67], v[92:93], v[16:31]
    s_nop 11
    v_max3_f32 v72, v72, v16, v17
    v_max3_f32 v72, v72, v18, v19
    v_max3_f32 v72, v72, v20, v21
    s_nop 8
    v_max3_f32 v72, v72, v22, v23
    v_max3_f32 v72, v72, v24, v25
    v_max3_f32 v72, v72, v26, v27
    v_max3_f32 v72, v72, v28, v29
    v_max3_f32 v72, v72, v30, v31
    v_mfma_f32_32x32x16_bf16 v[16:31], a[84:87], v[88:91], 0
    v_mfma_f32_32x32x8_bf16 v[16:31], a[92:93], v[92:93], v[16:31]
    s_nop 11
    v_max3_f32 v72, v72, v16, v17
    v_max3_f32 v72, v72, v18, v19
    s_nop 9
    v_max3_f32 v72, v72, v20, v21
    v_max3_f32 v72, v72, v22, v23
    v_max3_f32 v72, v72, v24, v25
    v_max3_f32 v72, v72, v26, v27
    s_nop 5
    v_max3_f32 v72, v72, v28, v29
    v_max3_f32 v72, v72, v30, v31
    v_mfma_f32_32x32x16_bf16 v[16:31], a[88:91], v[88:91], 0
    v_mfma_f32_32x32x8_bf16 v[16:31], a[94:95], v[92:93], v[16:31]
    s_nop 11
    v_max3_f32 v72, v72, v16, v17
    s_nop 10
    v_max3_f32 v72, v72, v18, v19
    v_max3_f32 v72, v72, v20, v21
    v_max3_f32 v72, v72, v22, v23
    s_nop 7
    v_max3_f32 v72, v72, v24, v25
    v_max3_f32 v72, v72, v26, v27
    v_max3_f32 v72, v72, v28, v29
    v_max3_f32 v72, v72, v30, v31
    v_mfma_f32_32x32x16_bf16 v[16:31], a[112:115], v[88:91], 0
    v_mfma_f32_32x32x8_bf16 v[16:31], a[120:121], v[92:93], v[16:31]
    s_nop 11
    v_max3_f32 v72, v72, v16, v17
    v_max3_f32 v72, v72, v18, v19
    v_max3_f32 v72, v72, v20, v21
    v_max3_f32 v72, v72, v22, v23
    v_max3_f32 v72, v72, v24, v25
    v_max3_f32 v72, v72, v26, v27
    v_max3_f32 v72, v72, v28, v29
    v_max3_f32 v72, v72, v30, v31
    v_mfma_f32_32x32x16_bf16 v[16:31], a[116:119], v[88:91], 0
    v_mfma_f32_32x32x8_bf16 v[16:31], a[122:123], v[92:93], v[16:31]
    s_nop 11
    v_max3_f32 v72, v72, v16, v17
    v_max3_f32 v72, v72, v18, v19
    v_max3_f32 v72, v72, v20, v21
    s_nop 8
    v_max3_f32 v72, v72, v22, v23
    v_max3_f32 v72, v72, v24, v25
    v_max3_f32 v72, v72, v26, v27
    v_max3_f32 v72, v72, v28, v29
    v_max3_f32 v72, v72, v30, v31
    v_mfma_f32_32x32x16_bf16 v[16:31], a[140:143], v[88:91], 0
    v_mfma_f32_32x32x8_bf16 v[16:31], a[148:149], v[92:93], v[16:31]
    s_nop 11
    v_max3_f32 v72, v72, v16, v17
    v_max3_f32 v72, v72, v18, v19
    s_nop 9
    v_max3_f32 v72, v72, v20, v21
    v_max3_f32 v72, v72, v22, v23
    v_max3_f32 v72, v72, v24, v25
    v_max3_f32 v72, v72, v26, v27
    s_nop 5
    v_max3_f32 v72, v72, v28, v29
    v_max3_f32 v72, v72, v30, v31
    v_mfma_f32_32x32x16_bf16 v[16:31], a[144:147], v[88:91], 0
    v_mfma_f32_32x32x8_bf16 v[16:31], a[150:151], v[92:93], v[16:31]
    s_nop 11
    v_max3_f32 v72, v72, v16, v17
    s_nop 10
    v_max3_f32 v72, v72, v18, v19
    v_max3_f32 v72, v72, v20, v21
    v_max3_f32 v72, v72, v22, v23
    s_nop 7
    v_max3_f32 v72, v72, v24, v25
    v_max3_f32 v72, v72, v26, v27
    v_max3_f32 v72, v72, v28, v29
    v_max3_f32 v72, v72, v30, v31
    v_mfma_f32_32x32x16_bf16 v[16:31], a[168:171], v[88:91], 0
    v_mfma_f32_32x32x8_bf16 v[16:31], a[176:177], v[92:93], v[16:31]
    s_nop 11
    v_max3_f32 v72, v72, v16, v17
    v_max3_f32 v72, v72, v18, v19
    v_max3_f32 v72, v72, v20, v21
    v_max3_f32 v72, v72, v22, v23
    v_max3_f32 v72, v72, v24, v25
    v_max3_f32 v72, v72, v26, v27
    v_max3_f32 v72, v72, v28, v29
    v_max3_f32 v72, v72, v30, v31
    v_mfma_f32_32x32x16_bf16 v[16:31], a[172:175], v[88:91], 0
    v_mfma_f32_32x32x8_bf16 v[16:31], a[178:179], v[92:93], v[16:31]
    s_nop 11
    v_max3_f32 v72, v72, v16, v17
    v_max3_f32 v72, v72, v18, v19
    v_max3_f32 v72, v72, v20, v21
    s_nop 8
    v_max3_f32 v72, v72, v22, v23
    v_max3_f32 v72, v72, v24, v25
    v_max3_f32 v72, v72, v26, v27
    v_max3_f32 v72, v72, v28, v29
    v_max3_f32 v72, v72, v30, v31
    v_mfma_f32_32x32x16_bf16 v[16:31], a[196:199], v[88:91], 0
    v_mfma_f32_32x32x8_bf16 v[16:31], a[204:205], v[92:93], v[16:31]
    s_nop 11
    v_max3_f32 v72, v72, v16, v17
    v_max3_f32 v72, v72, v18, v19
    s_nop 9
    v_max3_f32 v72, v72, v20, v21
    v_max3_f32 v72, v72, v22, v23
    v_max3_f32 v72, v72, v24, v25
    v_max3_f32 v72, v72, v26, v27
    s_nop 5
    v_max3_f32 v72, v72, v28, v29
    v_max3_f32 v72, v72, v30, v31
    v_mfma_f32_32x32x16_bf16 v[16:31], a[200:203], v[88:91], 0
    v_mfma_f32_32x32x8_bf16 v[16:31], a[206:207], v[92:93], v[16:31]
    s_nop 11
    v_max3_f32 v72, v72, v16, v17
    s_nop 10
    v_max3_f32 v72, v72, v18, v19
    v_max3_f32 v72, v72, v20, v21
    v_max3_f32 v72, v72, v22, v23
    s_nop 7
    v_max3_f32 v72, v72, v24, v25
    v_max3_f32 v72, v72, v26, v27
    v_max3_f32 v72, v72, v28, v29
    v_max3_f32 v72, v72, v30, v31
    v_mov_b32 v73, v72
    s_nop 1
    v_permlane32_swap_b32 v72, v73
    v_max_f32 v72, v72, v73
    v_sub_f32 v32, 0, v72
    v_sub_f32 v33, 0, v72
    v_sub_f32 v34, 0, v72
    v_sub_f32 v35, 0, v72
    v_sub_f32 v36, 0, v72
    v_sub_f32 v37, 0, v72
    v_sub_f32 v38, 0, v72
    v_sub_f32 v39, 0, v72
    v_sub_f32 v40, 0, v72
    v_sub_f32 v41, 0, v72
    v_sub_f32 v42, 0, v72
    v_sub_f32 v43, 0, v72
    v_sub_f32 v44, 0, v72
    v_sub_f32 v45, 0, v72
    v_sub_f32 v46, 0, v72
    v_sub_f32 v47, 0, v72
    s_nop 1
    v_mfma_f32_32x32x16_bf16 v[16:31], a[0:3], v[88:91], v[32:47]
    v_mfma_f32_32x32x8_bf16 v[16:31], a[8:9], v[92:93], v[16:31]
    s_nop 11
    v_exp_f32 v16, v16
    v_exp_f32 v17, v17
    v_exp_f32 v18, v18
    v_exp_f32 v19, v19
    v_exp_f32 v20, v20
    v_exp_f32 v21, v21
    v_exp_f32 v22, v22
    v_exp_f32 v23, v23
    v_exp_f32 v24, v24
    v_exp_f32 v25, v25
    v_exp_f32 v26, v26
    s_nop 0
    v_exp_f32 v27, v27
    v_exp_f32 v28, v28
    v_exp_f32 v29, v29
    v_exp_f32 v30, v30
    v_exp_f32 v31, v31
    v_cvt_pk_bf16_f32 v48, v16, v17
    v_cvt_pk_bf16_f32 v49, v18, v19
    v_cvt_pk_bf16_f32 v50, v20, v21
    v_cvt_pk_bf16_f32 v51, v22, v23
    v_cvt_pk_bf16_f32 v52, v24, v25
    v_cvt_pk_bf16_f32 v53, v26, v27
    v_cvt_pk_bf16_f32 v54, v28, v29
    v_cvt_pk_bf16_f32 v55, v30, v31
    v_mfma_f32_32x32x16_bf16 v[56:71], a[12:15], v[48:51], 0
    s_nop 0
    v_mfma_f32_32x32x16_bf16 v[56:71], a[16:19], v[52:55], v[56:71]
    v_mfma_f32_32x32x16_bf16 v[16:31], a[4:7], v[88:91], v[32:47]
    v_mfma_f32_32x32x8_bf16 v[16:31], a[10:11], v[92:93], v[16:31]
    s_nop 11
    v_exp_f32 v16, v16
    v_exp_f32 v17, v17
    v_exp_f32 v18, v18
    v_exp_f32 v19, v19
    v_exp_f32 v20, v20
    v_exp_f32 v21, v21
    v_exp_f32 v22, v22
    v_exp_f32 v23, v23
    v_exp_f32 v24, v24
    v_exp_f32 v25, v25
    s_nop 1
    v_exp_f32 v26, v26
    v_exp_f32 v27, v27
    v_exp_f32 v28, v28
    v_exp_f32 v29, v29
    v_exp_f32 v30, v30
    v_exp_f32 v31, v31
    v_cvt_pk_bf16_f32 v48, v16, v17
    v_cvt_pk_bf16_f32 v49, v18, v19
    v_cvt_pk_bf16_f32 v50, v20, v21
    v_cvt_pk_bf16_f32 v51, v22, v23
    v_cvt_pk_bf16_f32 v52, v24, v25
    v_cvt_pk_bf16_f32 v53, v26, v27
    v_cvt_pk_bf16_f32 v54, v28, v29
    v_cvt_pk_bf16_f32 v55, v30, v31
    v_mfma_f32_32x32x16_bf16 v[56:71], a[20:23], v[48:51], v[56:71]
    s_nop 0
    v_mfma_f32_32x32x16_bf16 v[56:71], a[24:27], v[52:55], v[56:71]
    v_mfma_f32_32x32x16_bf16 v[16:31], a[28:31], v[88:91], v[32:47]
    v_mfma_f32_32x32x8_bf16 v[16:31], a[36:37], v[92:93], v[16:31]
    s_nop 11
    v_exp_f32 v16, v16
    v_exp_f32 v17, v17
    v_exp_f32 v18, v18
    v_exp_f32 v19, v19
    v_exp_f32 v20, v20
    v_exp_f32 v21, v21
    v_exp_f32 v22, v22
    v_exp_f32 v23, v23
    v_exp_f32 v24, v24
    v_exp_f32 v25, v25
    s_nop 1
    v_exp_f32 v26, v26
    v_exp_f32 v27, v27
    v_exp_f32 v28, v28
    v_exp_f32 v29, v29
    v_exp_f32 v30, v30
    v_exp_f32 v31, v31
    v_cvt_pk_bf16_f32 v48, v16, v17
    v_cvt_pk_bf16_f32 v49, v18, v19
    v_cvt_pk_bf16_f32 v50, v20, v21
    v_cvt_pk_bf16_f32 v51, v22, v23
    v_cvt_pk_bf16_f32 v52, v24, v25
    v_cvt_pk_bf16_f32 v53, v26, v27
    v_cvt_pk_bf16_f32 v54, v28, v29
    v_cvt_pk_bf16_f32 v55, v30, v31
    v_mfma_f32_32x32x16_bf16 v[56:71], a[40:43], v[48:51], v[56:71]
    s_nop 0
    v_mfma_f32_32x32x16_bf16 v[56:71], a[44:47], v[52:55], v[56:71]
    v_mfma_f32_32x32x16_bf16 v[16:31], a[32:35], v[88:91], v[32:47]
    v_mfma_f32_32x32x8_bf16 v[16:31], a[38:39], v[92:93], v[16:31]
    s_nop 11
    v_exp_f32 v16, v16
    v_exp_f32 v17, v17
    v_exp_f32 v18, v18
    v_exp_f32 v19, v19
    v_exp_f32 v20, v20
    v_exp_f32 v21, v21
    v_exp_f32 v22, v22
    v_exp_f32 v23, v23
    v_exp_f32 v24, v24
    v_exp_f32 v25, v25
    s_nop 1
    v_exp_f32 v26, v26
    v_exp_f32 v27, v27
    v_exp_f32 v28, v28
    v_exp_f32 v29, v29
    v_exp_f32 v30, v30
    v_exp_f32 v31, v31
    v_cvt_pk_bf16_f32 v48, v16, v17
    v_cvt_pk_bf16_f32 v49, v18, v19
    v_cvt_pk_bf16_f32 v50, v20, v21
    v_cvt_pk_bf16_f32 v51, v22, v23
    v_cvt_pk_bf16_f32 v52, v24, v25
    v_cvt_pk_bf16_f32 v53, v26, v27
    v_cvt_pk_bf16_f32 v54, v28, v29
    v_cvt_pk_bf16_f32 v55, v30, v31
    v_mfma_f32_32x32x16_bf16 v[56:71], a[48:51], v[48:51], v[56:71]
    s_nop 0
    v_mfma_f32_32x32x16_bf16 v[56:71], a[52:55], v[52:55], v[56:71]
    v_mfma_f32_32x32x16_bf16 v[16:31], a[56:59], v[88:91], v[32:47]
    v_mfma_f32_32x32x8_bf16 v[16:31], a[64:65], v[92:93], v[16:31]
    s_nop 11
    v_exp_f32 v16, v16
    v_exp_f32 v17, v17
    v_exp_f32 v18, v18
    v_exp_f32 v19, v19
    v_exp_f32 v20, v20
    v_exp_f32 v21, v21
    v_exp_f32 v22, v22
    v_exp_f32 v23, v23
    v_exp_f32 v24, v24
    v_exp_f32 v25, v25
    s_nop 1
    v_exp_f32 v26, v26
    v_exp_f32 v27, v27
    v_exp_f32 v28, v28
    v_exp_f32 v29, v29
    v_exp_f32 v30, v30
    v_exp_f32 v31, v31
    v_cvt_pk_bf16_f32 v48, v16, v17
    v_cvt_pk_bf16_f32 v49, v18, v19
    v_cvt_pk_bf16_f32 v50, v20, v21
    v_cvt_pk_bf16_f32 v51, v22, v23
    v_cvt_pk_bf16_f32 v52, v24, v25
    v_cvt_pk_bf16_f32 v53, v26, v27
    v_cvt_pk_bf16_f32 v54, v28, v29
    v_cvt_pk_bf16_f32 v55, v30, v31
    v_mfma_f32_32x32x16_bf16 v[56:71], a[68:71], v[48:51], v[56:71]
    s_nop 0
    v_mfma_f32_32x32x16_bf16 v[56:71], a[72:75], v[52:55], v[56:71]
    v_mfma_f32_32x32x16_bf16 v[16:31], a[60:63], v[88:91], v[32:47]
    v_mfma_f32_32x32x8_bf16 v[16:31], a[66:67], v[92:93], v[16:31]
    s_nop 11
    v_exp_f32 v16, v16
    v_exp_f32 v17, v17
    v_exp_f32 v18, v18
    v_exp_f32 v19, v19
    v_exp_f32 v20, v20
    v_exp_f32 v21, v21
    v_exp_f32 v22, v22
    v_exp_f32 v23, v23
    v_exp_f32 v24, v24
    v_exp_f32 v25, v25
    s_nop 1
    v_exp_f32 v26, v26
    v_exp_f32 v27, v27
    v_exp_f32 v28, v28
    v_exp_f32 v29, v29
    v_exp_f32 v30, v30
    v_exp_f32 v31, v31
    v_cvt_pk_bf16_f32 v48, v16, v17
    v_cvt_pk_bf16_f32 v49, v18, v19
    v_cvt_pk_bf16_f32 v50, v20, v21
    v_cvt_pk_bf16_f32 v51, v22, v23
    v_cvt_pk_bf16_f32 v52, v24, v25
    v_cvt_pk_bf16_f32 v53, v26, v27
    v_cvt_pk_bf16_f32 v54, v28, v29
    v_cvt_pk_bf16_f32 v55, v30, v31
    v_mfma_f32_32x32x16_bf16 v[56:71], a[76:79], v[48:51], v[56:71]
    s_nop 0
    v_mfma_f32_32x32x16_bf16 v[56:71], a[80:83], v[52:55], v[56:71]
    v_mfma_f32_32x32x16_bf16 v[16:31], a[84:87], v[88:91], v[32:47]
    v_mfma_f32_32x32x8_bf16 v[16:31], a[92:93], v[92:93], v[16:31]
    s_nop 11
    v_exp_f32 v16, v16
    v_exp_f32 v17, v17
    v_exp_f32 v18, v18
    v_exp_f32 v19, v19
    v_exp_f32 v20, v20
    v_exp_f32 v21, v21
    v_exp_f32 v22, v22
    v_exp_f32 v23, v23
    v_exp_f32 v24, v24
    v_exp_f32 v25, v25
    s_nop 1
    v_exp_f32 v26, v26
    v_exp_f32 v27, v27
    v_exp_f32 v28, v28
    v_exp_f32 v29, v29
    v_exp_f32 v30, v30
    v_exp_f32 v31, v31
    v_cvt_pk_bf16_f32 v48, v16, v17
    v_cvt_pk_bf16_f32 v49, v18, v19
    v_cvt_pk_bf16_f32 v50, v20, v21
    v_cvt_pk_bf16_f32 v51, v22, v23
    v_cvt_pk_bf16_f32 v52, v24, v25
    v_cvt_pk_bf16_f32 v53, v26, v27
    v_cvt_pk_bf16_f32 v54, v28, v29
    v_cvt_pk_bf16_f32 v55, v30, v31
    v_mfma_f32_32x32x16_bf16 v[56:71], a[96:99], v[48:51], v[56:71]
    s_nop 0
    v_mfma_f32_32x32x16_bf16 v[56:71], a[100:103], v[52:55], v[56:71]
    v_mfma_f32_32x32x16_bf16 v[16:31], a[88:91], v[88:91], v[32:47]
    v_mfma_f32_32x32x8_bf16 v[16:31], a[94:95], v[92:93], v[16:31]
    s_nop 11
    v_exp_f32 v16, v16
    v_exp_f32 v17, v17
    v_exp_f32 v18, v18
    v_exp_f32 v19, v19
    v_exp_f32 v20, v20
    v_exp_f32 v21, v21
    v_exp_f32 v22, v22
    v_exp_f32 v23, v23
    v_exp_f32 v24, v24
    v_exp_f32 v25, v25
    s_nop 1
    v_exp_f32 v26, v26
    v_exp_f32 v27, v27
    v_exp_f32 v28, v28
    v_exp_f32 v29, v29
    v_exp_f32 v30, v30
    v_exp_f32 v31, v31
    v_cvt_pk_bf16_f32 v48, v16, v17
    v_cvt_pk_bf16_f32 v49, v18, v19
    v_cvt_pk_bf16_f32 v50, v20, v21
    v_cvt_pk_bf16_f32 v51, v22, v23
    v_cvt_pk_bf16_f32 v52, v24, v25
    v_cvt_pk_bf16_f32 v53, v26, v27
    v_cvt_pk_bf16_f32 v54, v28, v29
    v_cvt_pk_bf16_f32 v55, v30, v31
    v_mfma_f32_32x32x16_bf16 v[56:71], a[104:107], v[48:51], v[56:71]
    s_nop 0
    v_mfma_f32_32x32x16_bf16 v[56:71], a[108:111], v[52:55], v[56:71]
    v_mfma_f32_32x32x16_bf16 v[16:31], a[112:115], v[88:91], v[32:47]
    v_mfma_f32_32x32x8_bf16 v[16:31], a[120:121], v[92:93], v[16:31]
    s_nop 11
    v_exp_f32 v16, v16
    v_exp_f32 v17, v17
    v_exp_f32 v18, v18
    v_exp_f32 v19, v19
    v_exp_f32 v20, v20
    v_exp_f32 v21, v21
    v_exp_f32 v22, v22
    v_exp_f32 v23, v23
    v_exp_f32 v24, v24
    v_exp_f32 v25, v25
    s_nop 1
    v_exp_f32 v26, v26
    v_exp_f32 v27, v27
    v_exp_f32 v28, v28
    v_exp_f32 v29, v29
    v_exp_f32 v30, v30
    v_exp_f32 v31, v31
    v_cvt_pk_bf16_f32 v48, v16, v17
    v_cvt_pk_bf16_f32 v49, v18, v19
    v_cvt_pk_bf16_f32 v50, v20, v21
    v_cvt_pk_bf16_f32 v51, v22, v23
    v_cvt_pk_bf16_f32 v52, v24, v25
    v_cvt_pk_bf16_f32 v53, v26, v27
    v_cvt_pk_bf16_f32 v54, v28, v29
    v_cvt_pk_bf16_f32 v55, v30, v31
    v_mfma_f32_32x32x16_bf16 v[56:71], a[124:127], v[48:51], v[56:71]
    s_nop 0
    v_mfma_f32_32x32x16_bf16 v[56:71], a[128:131], v[52:55], v[56:71]
    v_mfma_f32_32x32x16_bf16 v[16:31], a[116:119], v[88:91], v[32:47]
    v_mfma_f32_32x32x8_bf16 v[16:31], a[122:123], v[92:93], v[16:31]
    s_nop 11
    v_exp_f32 v16, v16
    v_exp_f32 v17, v17
    v_exp_f32 v18, v18
    v_exp_f32 v19, v19
    v_exp_f32 v20, v20
    v_exp_f32 v21, v21
    v_exp_f32 v22, v22
    v_exp_f32 v23, v23
    v_exp_f32 v24, v24
    v_exp_f32 v25, v25
    s_nop 1
    v_exp_f32 v26, v26
    v_exp_f32 v27, v27
    v_exp_f32 v28, v28
    v_exp_f32 v29, v29
    v_exp_f32 v30, v30
    v_exp_f32 v31, v31
    v_cvt_pk_bf16_f32 v48, v16, v17
    v_cvt_pk_bf16_f32 v49, v18, v19
    v_cvt_pk_bf16_f32 v50, v20, v21
    v_cvt_pk_bf16_f32 v51, v22, v23
    v_cvt_pk_bf16_f32 v52, v24, v25
    v_cvt_pk_bf16_f32 v53, v26, v27
    v_cvt_pk_bf16_f32 v54, v28, v29
    v_cvt_pk_bf16_f32 v55, v30, v31
    v_mfma_f32_32x32x16_bf16 v[56:71], a[132:135], v[48:51], v[56:71]
    s_nop 0
    v_mfma_f32_32x32x16_bf16 v[56:71], a[136:139], v[52:55], v[56:71]
    v_mfma_f32_32x32x16_bf16 v[16:31], a[140:143], v[88:91], v[32:47]
    v_mfma_f32_32x32x8_bf16 v[16:31], a[148:149], v[92:93], v[16:31]
    s_nop 11
    v_exp_f32 v16, v16
    v_exp_f32 v17, v17
    v_exp_f32 v18, v18
    v_exp_f32 v19, v19
    v_exp_f32 v20, v20
    v_exp_f32 v21, v21
    v_exp_f32 v22, v22
    v_exp_f32 v23, v23
    v_exp_f32 v24, v24
    v_exp_f32 v25, v25
    s_nop 1
    v_exp_f32 v26, v26
    v_exp_f32 v27, v27
    v_exp_f32 v28, v28
    v_exp_f32 v29, v29
    v_exp_f32 v30, v30
    v_exp_f32 v31, v31
    v_cvt_pk_bf16_f32 v48, v16, v17
    v_cvt_pk_bf16_f32 v49, v18, v19
    v_cvt_pk_bf16_f32 v50, v20, v21
    v_cvt_pk_bf16_f32 v51, v22, v23
    v_cvt_pk_bf16_f32 v52, v24, v25
    v_cvt_pk_bf16_f32 v53, v26, v27
    v_cvt_pk_bf16_f32 v54, v28, v29
    v_cvt_pk_bf16_f32 v55, v30, v31
    v_mfma_f32_32x32x16_bf16 v[56:71], a[152:155], v[48:51], v[56:71]
    s_nop 0
    v_mfma_f32_32x32x16_bf16 v[56:71], a[156:159], v[52:55], v[56:71]
    v_mfma_f32_32x32x16_bf16 v[16:31], a[144:147], v[88:91], v[32:47]
    v_mfma_f32_32x32x8_bf16 v[16:31], a[150:151], v[92:93], v[16:31]
    s_nop 11
    v_exp_f32 v16, v16
    v_exp_f32 v17, v17
    v_exp_f32 v18, v18
    v_exp_f32 v19, v19
    v_exp_f32 v20, v20
    v_exp_f32 v21, v21
    v_exp_f32 v22, v22
    v_exp_f32 v23, v23
    v_exp_f32 v24, v24
    v_exp_f32 v25, v25
    s_nop 1
    v_exp_f32 v26, v26
    v_exp_f32 v27, v27
    v_exp_f32 v28, v28
    v_exp_f32 v29, v29
    v_exp_f32 v30, v30
    v_exp_f32 v31, v31
    v_cvt_pk_bf16_f32 v48, v16, v17
    v_cvt_pk_bf16_f32 v49, v18, v19
    v_cvt_pk_bf16_f32 v50, v20, v21
    v_cvt_pk_bf16_f32 v51, v22, v23
    v_cvt_pk_bf16_f32 v52, v24, v25
    v_cvt_pk_bf16_f32 v53, v26, v27
    v_cvt_pk_bf16_f32 v54, v28, v29
    v_cvt_pk_bf16_f32 v55, v30, v31
    v_mfma_f32_32x32x16_bf16 v[56:71], a[160:163], v[48:51], v[56:71]
    s_nop 0
    v_mfma_f32_32x32x16_bf16 v[56:71], a[164:167], v[52:55], v[56:71]
    v_mfma_f32_32x32x16_bf16 v[16:31], a[168:171], v[88:91], v[32:47]
    v_mfma_f32_32x32x8_bf16 v[16:31], a[176:177], v[92:93], v[16:31]
    s_nop 11
    v_exp_f32 v16, v16
    v_exp_f32 v17, v17
    v_exp_f32 v18, v18
    v_exp_f32 v19, v19
    v_exp_f32 v20, v20
    v_exp_f32 v21, v21
    v_exp_f32 v22, v22
    v_exp_f32 v23, v23
    v_exp_f32 v24, v24
    v_exp_f32 v25, v25
    s_nop 1
    v_exp_f32 v26, v26
    v_exp_f32 v27, v27
    v_exp_f32 v28, v28
    v_exp_f32 v29, v29
    v_exp_f32 v30, v30
    v_exp_f32 v31, v31
    v_cvt_pk_bf16_f32 v48, v16, v17
    v_cvt_pk_bf16_f32 v49, v18, v19
    v_cvt_pk_bf16_f32 v50, v20, v21
    v_cvt_pk_bf16_f32 v51, v22, v23
    v_cvt_pk_bf16_f32 v52, v24, v25
    v_cvt_pk_bf16_f32 v53, v26, v27
    v_cvt_pk_bf16_f32 v54, v28, v29
    v_cvt_pk_bf16_f32 v55, v30, v31
    v_mfma_f32_32x32x16_bf16 v[56:71], a[180:183], v[48:51], v[56:71]
    s_nop 0
    v_mfma_f32_32x32x16_bf16 v[56:71], a[184:187], v[52:55], v[56:71]
    v_mfma_f32_32x32x16_bf16 v[16:31], a[172:175], v[88:91], v[32:47]
    v_mfma_f32_32x32x8_bf16 v[16:31], a[178:179], v[92:93], v[16:31]
    s_nop 11
    v_exp_f32 v16, v16
    v_exp_f32 v17, v17
    v_exp_f32 v18, v18
    v_exp_f32 v19, v19
    v_exp_f32 v20, v20
    v_exp_f32 v21, v21
    v_exp_f32 v22, v22
    v_exp_f32 v23, v23
    v_exp_f32 v24, v24
    v_exp_f32 v25, v25
    s_nop 1
    v_exp_f32 v26, v26
    v_exp_f32 v27, v27
    v_exp_f32 v28, v28
    v_exp_f32 v29, v29
    v_exp_f32 v30, v30
    v_exp_f32 v31, v31
    v_cvt_pk_bf16_f32 v48, v16, v17
    v_cvt_pk_bf16_f32 v49, v18, v19
    v_cvt_pk_bf16_f32 v50, v20, v21
    v_cvt_pk_bf16_f32 v51, v22, v23
    v_cvt_pk_bf16_f32 v52, v24, v25
    v_cvt_pk_bf16_f32 v53, v26, v27
    v_cvt_pk_bf16_f32 v54, v28, v29
    v_cvt_pk_bf16_f32 v55, v30, v31
    v_mfma_f32_32x32x16_bf16 v[56:71], a[188:191], v[48:51], v[56:71]
    s_nop 0
    v_mfma_f32_32x32x16_bf16 v[56:71], a[192:195], v[52:55], v[56:71]
    v_mfma_f32_32x32x16_bf16 v[16:31], a[196:199], v[88:91], v[32:47]
    v_mfma_f32_32x32x8_bf16 v[16:31], a[204:205], v[92:93], v[16:31]
    s_nop 11
    v_exp_f32 v16, v16
    v_exp_f32 v17, v17
    v_exp_f32 v18, v18
    v_exp_f32 v19, v19
    v_exp_f32 v20, v20
    v_exp_f32 v21, v21
    v_exp_f32 v22, v22
    v_exp_f32 v23, v23
    v_exp_f32 v24, v24
    v_exp_f32 v25, v25
    s_nop 1
    v_exp_f32 v26, v26
    v_exp_f32 v27, v27
    v_exp_f32 v28, v28
    v_exp_f32 v29, v29
    v_exp_f32 v30, v30
    v_exp_f32 v31, v31
    v_cvt_pk_bf16_f32 v48, v16, v17
    v_cvt_pk_bf16_f32 v49, v18, v19
    v_cvt_pk_bf16_f32 v50, v20, v21
    v_cvt_pk_bf16_f32 v51, v22, v23
    v_cvt_pk_bf16_f32 v52, v24, v25
    v_cvt_pk_bf16_f32 v53, v26, v27
    v_cvt_pk_bf16_f32 v54, v28, v29
    v_cvt_pk_bf16_f32 v55, v30, v31
    v_mfma_f32_32x32x16_bf16 v[56:71], a[208:211], v[48:51], v[56:71]
    s_nop 0
    v_mfma_f32_32x32x16_bf16 v[56:71], a[212:215], v[52:55], v[56:71]
    v_mfma_f32_32x32x16_bf16 v[16:31], a[200:203], v[88:91], v[32:47]
    v_mfma_f32_32x32x8_bf16 v[16:31], a[206:207], v[92:93], v[16:31]
    s_nop 11
    v_exp_f32 v16, v16
    v_exp_f32 v17, v17
    v_exp_f32 v18, v18
    v_exp_f32 v19, v19
    v_exp_f32 v20, v20
    v_exp_f32 v21, v21
    v_exp_f32 v22, v22
    v_exp_f32 v23, v23
    v_exp_f32 v24, v24
    v_exp_f32 v25, v25
    s_nop 1
    v_exp_f32 v26, v26
    v_exp_f32 v27, v27
    v_exp_f32 v28, v28
    v_exp_f32 v29, v29
    v_exp_f32 v30, v30
    v_exp_f32 v31, v31
    v_cvt_pk_bf16_f32 v48, v16, v17
    v_cvt_pk_bf16_f32 v49, v18, v19
    v_cvt_pk_bf16_f32 v50, v20, v21
    v_cvt_pk_bf16_f32 v51, v22, v23
    v_cvt_pk_bf16_f32 v52, v24, v25
    v_cvt_pk_bf16_f32 v53, v26, v27
    v_cvt_pk_bf16_f32 v54, v28, v29
    v_cvt_pk_bf16_f32 v55, v30, v31
    v_mfma_f32_32x32x16_bf16 v[56:71], a[216:219], v[48:51], v[56:71]
    s_nop 0
    v_mfma_f32_32x32x16_bf16 v[56:71], a[220:223], v[52:55], v[56:71]
    s_nop 11
    v_cndmask_b32 v65, v65, v72, s[92:93]
    ds_write_b128 v10, v[56:59] offset:0
    ds_write_b128 v10, v[60:63] offset:1024
    ds_write_b128 v10, v[64:67] offset:2048
    v_add_u32 v8, 1280, v8
    v_add_u32 v9, 1280, v9
    v_add_u32 v10, 12288, v10
    s_add_u32 s31, s31, 1
    s_cmp_lt_u32 s31, 8
    s_cbranch_scc1 L_slow_55
    s_waitcnt lgkmcnt(0)
    s_barrier
    ds_read_b128 v[16:19], v5 offset:0
    ds_read_b128 v[20:23], v5 offset:1024
    ds_read_b128 v[24:27], v5 offset:2048
    ds_read_b128 v[28:31], v5 offset:3072
    ds_read_b128 v[32:35], v5 offset:4096
    ds_read_b128 v[36:39], v5 offset:5120
    ds_read_b128 v[40:43], v5 offset:6144
    ds_read_b128 v[44:47], v5 offset:7168
    ds_read_b128 v[48:51], v5 offset:8192
    ds_read_b128 v[52:55], v5 offset:9216
    ds_read_b128 v[56:59], v5 offset:10240
    ds_read_b128 v[60:63], v5 offset:11264
    s_waitcnt lgkmcnt(0)
    v_mov_b32 v228, v25
    v_mov_b32 v232, v25
    v_mov_b32 v229, v37
    v_mov_b32 v233, v37
    v_mov_b32 v230, v49
    v_mov_b32 v234, v49
    v_mov_b32 v231, v61
    v_mov_b32 v235, v61
    v_permlane32_swap_b32 v228, v232
    v_permlane32_swap_b32 v229, v233
    v_permlane32_swap_b32 v230, v234
    v_permlane32_swap_b32 v231, v235
    v_max3_f32 v228, v232, v233, v234
    v_max_f32 v228, v228, v235
    v_sub_f32 v232, v232, v228
    v_sub_f32 v233, v233, v228
    v_sub_f32 v234, v234, v228
    v_sub_f32 v235, v235, v228
    v_exp_f32 v232, v232
    v_exp_f32 v233, v233
    v_exp_f32 v234, v234
    v_exp_f32 v235, v235
    v_mul_f32 v16, v232, v16
    v_mul_f32 v17, v232, v17
    v_mul_f32 v18, v232, v18
    v_mul_f32 v19, v232, v19
    v_mul_f32 v20, v232, v20
    v_mul_f32 v21, v232, v21
    v_mul_f32 v22, v232, v22
    v_mul_f32 v23, v232, v23
    v_mul_f32 v24, v232, v24
    v_mul_f32 v25, v232, v25
    v_mul_f32 v26, v232, v26
    v_mul_f32 v27, v232, v27
    v_fmac_f32 v16, v233, v28
    v_fmac_f32 v17, v233, v29
    v_fmac_f32 v18, v233, v30
    v_fmac_f32 v19, v233, v31
    v_fmac_f32 v20, v233, v32
    v_fmac_f32 v21, v233, v33
    v_fmac_f32 v22, v233, v34
    v_fmac_f32 v23, v233, v35
    v_fmac_f32 v24, v233, v36
    v_fmac_f32 v25, v233, v37
    v_fmac_f32 v26, v233, v38
    v_fmac_f32 v27, v233, v39
    v_fmac_f32 v16, v234, v40
    v_fmac_f32 v17, v234, v41
    v_fmac_f32 v18, v234, v42
    v_fmac_f32 v19, v234, v43
    v_fmac_f32 v20, v234, v44
    v_fmac_f32 v21, v234, v45
    v_fmac_f32 v22, v234, v46
    v_fmac_f32 v23, v234, v47
    v_fmac_f32 v24, v234, v48
    v_fmac_f32 v25, v234, v49
    v_fmac_f32 v26, v234, v50
    v_fmac_f32 v27, v234, v51
    v_fmac_f32 v16, v235, v52
    v_fmac_f32 v17, v235, v53
    v_fmac_f32 v18, v235, v54
    v_fmac_f32 v19, v235, v55
    v_fmac_f32 v20, v235, v56
    v_fmac_f32 v21, v235, v57
    v_fmac_f32 v22, v235, v58
    v_fmac_f32 v23, v235, v59
    v_fmac_f32 v24, v235, v60
    v_fmac_f32 v25, v235, v61
    v_fmac_f32 v26, v235, v62
    v_fmac_f32 v27, v235, v63
    v_mov_b32 v222, v24
    v_mov_b32 v216, v24
    s_nop 1
    v_permlane32_swap_b32 v222, v216
    v_rcp_f32 v214, v216
    s_nop 0
    v_pk_mul_f32 v[204:205], v[16:17], v[214:215] op_sel_hi:[1,0]
    v_pk_mul_f32 v[206:207], v[18:19], v[214:215] op_sel_hi:[1,0]
    v_pk_mul_f32 v[208:209], v[20:21], v[214:215] op_sel_hi:[1,0]
    v_pk_mul_f32 v[210:211], v[22:23], v[214:215] op_sel_hi:[1,0]
    v_cvt_pk_bf16_f32 v204, v204, v205
    v_cvt_pk_bf16_f32 v205, v206, v207
    v_cvt_pk_bf16_f32 v206, v208, v209
    v_cvt_pk_bf16_f32 v207, v210, v211
    s_cmp_lg_u32 s48, 0
    s_cbranch_scc1 L_keepearly_56
    buffer_store_dwordx4 v[204:207], v6, s[32:35], 0 offen offset:0 sc1
L_keepearly_56:
    v_pk_mul_f32 v[208:209], v[24:25], v[214:215] op_sel_hi:[1,0]
    v_pk_mul_f32 v[210:211], v[26:27], v[214:215] op_sel_hi:[1,0]
    v_cvt_pk_bf16_f32 v224, v208, v209
    v_cvt_pk_bf16_f32 v225, v210, v211
    ds_read_b128 v[16:19], v5 offset:12288
    ds_read_b128 v[20:23], v5 offset:13312
    ds_read_b128 v[24:27], v5 offset:14336
    ds_read_b128 v[28:31], v5 offset:15360
    ds_read_b128 v[32:35], v5 offset:16384
    ds_read_b128 v[36:39], v5 offset:17408
    ds_read_b128 v[40:43], v5 offset:18432
    ds_read_b128 v[44:47], v5 offset:19456
    ds_read_b128 v[48:51], v5 offset:20480
    ds_read_b128 v[52:55], v5 offset:21504
    ds_read_b128 v[56:59], v5 offset:22528
    ds_read_b128 v[60:63], v5 offset:23552
    s_waitcnt lgkmcnt(0)
    v_mov_b32 v228, v25
    v_mov_b32 v232, v25
    v_mov_b32 v229, v37
    v_mov_b32 v233, v37
    v_mov_b32 v230, v49
    v_mov_b32 v234, v49
    v_mov_b32 v231, v61
    v_mov_b32 v235, v61
    v_permlane32_swap_b32 v228, v232
    v_permlane32_swap_b32 v229, v233
    v_permlane32_swap_b32 v230, v234
    v_permlane32_swap_b32 v231, v235
    v_max3_f32 v228, v232, v233, v234
    v_max_f32 v228, v228, v235
    v_sub_f32 v232, v232, v228
    v_sub_f32 v233, v233, v228
    v_sub_f32 v234, v234, v228
    v_sub_f32 v235, v235, v228
    v_exp_f32 v232, v232
    v_exp_f32 v233, v233
    v_exp_f32 v234, v234
    v_exp_f32 v235, v235
    v_mul_f32 v16, v232, v16
    v_mul_f32 v17, v232, v17
    v_mul_f32 v18, v232, v18
    v_mul_f32 v19, v232, v19
    v_mul_f32 v20, v232, v20
    v_mul_f32 v21, v232, v21
    v_mul_f32 v22, v232, v22
    v_mul_f32 v23, v232, v23
    v_mul_f32 v24, v232, v24
    v_mul_f32 v25, v232, v25
    v_mul_f32 v26, v232, v26
    v_mul_f32 v27, v232, v27
    v_fmac_f32 v16, v233, v28
    v_fmac_f32 v17, v233, v29
    v_fmac_f32 v18, v233, v30
    v_fmac_f32 v19, v233, v31
    v_fmac_f32 v20, v233, v32
    v_fmac_f32 v21, v233, v33
    v_fmac_f32 v22, v233, v34
    v_fmac_f32 v23, v233, v35
    v_fmac_f32 v24, v233, v36
    v_fmac_f32 v25, v233, v37
    v_fmac_f32 v26, v233, v38
    v_fmac_f32 v27, v233, v39
    v_fmac_f32 v16, v234, v40
    v_fmac_f32 v17, v234, v41
    v_fmac_f32 v18, v234, v42
    v_fmac_f32 v19, v234, v43
    v_fmac_f32 v20, v234, v44
    v_fmac_f32 v21, v234, v45
    v_fmac_f32 v22, v234, v46
    v_fmac_f32 v23, v234, v47
    v_fmac_f32 v24, v234, v48
    v_fmac_f32 v25, v234, v49
    v_fmac_f32 v26, v234, v50
    v_fmac_f32 v27, v234, v51
    v_fmac_f32 v16, v235, v52
    v_fmac_f32 v17, v235, v53
    v_fmac_f32 v18, v235, v54
    v_fmac_f32 v19, v235, v55
    v_fmac_f32 v20, v235, v56
    v_fmac_f32 v21, v235, v57
    v_fmac_f32 v22, v235, v58
    v_fmac_f32 v23, v235, v59
    v_fmac_f32 v24, v235, v60
    v_fmac_f32 v25, v235, v61
    v_fmac_f32 v26, v235, v62
    v_fmac_f32 v27, v235, v63
    v_mov_b32 v222, v24
    v_mov_b32 v218, v24
    s_nop 1
    v_permlane32_swap_b32 v222, v218
    v_rcp_f32 v214, v218
    s_nop 0
    v_pk_mul_f32 v[204:205], v[16:17], v[214:215] op_sel_hi:[1,0]
    v_pk_mul_f32 v[206:207], v[18:19], v[214:215] op_sel_hi:[1,0]
    v_pk_mul_f32 v[208:209], v[20:21], v[214:215] op_sel_hi:[1,0]
    v_pk_mul_f32 v[210:211], v[22:23], v[214:215] op_sel_hi:[1,0]
    v_cvt_pk_bf16_f32 v204, v204, v205
    v_cvt_pk_bf16_f32 v205, v206, v207
    v_cvt_pk_bf16_f32 v206, v208, v209
    v_cvt_pk_bf16_f32 v207, v210, v211
    s_mov_b32 s89, 8192
    buffer_store_dwordx4 v[204:207], v6, s[32:35], s89 offen offset:0 sc1
    v_pk_mul_f32 v[208:209], v[24:25], v[214:215] op_sel_hi:[1,0]
    v_pk_mul_f32 v[210:211], v[26:27], v[214:215] op_sel_hi:[1,0]
    v_cvt_pk_bf16_f32 v226, v208, v209
    v_cvt_pk_bf16_f32 v227, v210, v211
    buffer_store_dwordx4 v[224:227], v7, s[32:35], 0 offen offset:0 sc1
    s_waitcnt vmcnt(0)
    s_barrier
    s_mul_i32 s3, s82, 102400
    s_add_u32 s3, s3, 25165824
    v_add_u32 v13, s3, v1
    s_mul_i32 s98, s80, 25600
    s_add_u32 s98, s98, 24576
    s_cmp_eq_u32 s80, 3
    s_cselect_b32 s98, 112640, s98
    s_mul_i32 s3, s80, 5
    s_add_u32 s3, s3, 0
    s_lshl_b32 s2, s82, 1
    s_add_u32 s2, s2, s3
    s_and_b32 s2, s2, 7
    s_and_b32 s66, s3, 8
    s_add_u32 s2, s2, s66
    s_cmp_ge_u32 s3, 16
    s_cselect_b32 s2, s3, s2
    s_mul_i32 s40, s2, 5120
    s_mul_i32 s3, s80, 5
    s_add_u32 s3, s3, 1
    s_lshl_b32 s2, s82, 1
    s_add_u32 s2, s2, s3
    s_and_b32 s2, s2, 7
    s_and_b32 s66, s3, 8
    s_add_u32 s2, s2, s66
    s_cmp_ge_u32 s3, 16
    s_cselect_b32 s2, s3, s2
    s_mul_i32 s41, s2, 5120
    s_mul_i32 s3, s80, 5
    s_add_u32 s3, s3, 2
    s_lshl_b32 s2, s82, 1
    s_add_u32 s2, s2, s3
    s_and_b32 s2, s2, 7
    s_and_b32 s66, s3, 8
    s_add_u32 s2, s2, s66
    s_cmp_ge_u32 s3, 16
    s_cselect_b32 s2, s3, s2
    s_mul_i32 s42, s2, 5120
    s_mul_i32 s3, s80, 5
    s_add_u32 s3, s3, 3
    s_lshl_b32 s2, s82, 1
    s_add_u32 s2, s2, s3
    s_and_b32 s2, s2, 7
    s_and_b32 s66, s3, 8
    s_add_u32 s2, s2, s66
    s_cmp_ge_u32 s3, 16
    s_cselect_b32 s2, s3, s2
    s_mul_i32 s43, s2, 5120
    s_mul_i32 s3, s80, 5
    s_add_u32 s3, s3, 4
    s_lshl_b32 s2, s82, 1
    s_add_u32 s2, s2, s3
    s_and_b32 s2, s2, 7
    s_and_b32 s66, s3, 8
    s_add_u32 s2, s2, s66
    s_cmp_ge_u32 s3, 16
    s_cselect_b32 s2, s3, s2
    s_mul_i32 s44, s2, 5120
    s_add_u32 s27, s40, 0
    s_add_u32 m0, s98, 0
    s_nop 0
    buffer_load_dwordx4 v13, s[32:35], s27 offen sc1 lds
    s_add_u32 s27, s40, 1024
    s_add_u32 m0, s98, 1024
    s_nop 0
    buffer_load_dwordx4 v13, s[32:35], s27 offen sc1 lds
    s_add_u32 s27, s40, 2048
    s_add_u32 m0, s98, 2048
    s_nop 0
    buffer_load_dwordx4 v13, s[32:35], s27 offen sc1 lds
    s_add_u32 s27, s40, 3072
    s_add_u32 m0, s98, 3072
    s_nop 0
    buffer_load_dwordx4 v13, s[32:35], s27 offen sc1 lds
    s_add_u32 s27, s40, 4096
    s_add_u32 m0, s98, 4096
    s_nop 0
    buffer_load_dwordx4 v13, s[32:35], s27 offen sc1 lds
    s_add_u32 s27, s41, 0
    s_add_u32 m0, s98, 5120
    s_nop 0
    buffer_load_dwordx4 v13, s[32:35], s27 offen sc1 lds
    s_add_u32 s27, s41, 1024
    s_add_u32 m0, s98, 6144
    s_nop 0
    buffer_load_dwordx4 v13, s[32:35], s27 offen sc1 lds
    s_add_u32 s27, s41, 2048
    s_add_u32 m0, s98, 7168
    s_nop 0
    buffer_load_dwordx4 v13, s[32:35], s27 offen sc1 lds
    s_add_u32 s27, s41, 3072
    s_add_u32 m0, s98, 8192
    s_nop 0
    buffer_load_dwordx4 v13, s[32:35], s27 offen sc1 lds
    s_add_u32 s27, s41, 4096
    s_add_u32 m0, s98, 9216
    s_nop 0
    buffer_load_dwordx4 v13, s[32:35], s27 offen sc1 lds
    s_add_u32 s27, s42, 0
    s_add_u32 m0, s98, 10240
    s_nop 0
    buffer_load_dwordx4 v13, s[32:35], s27 offen sc1 lds
    s_add_u32 s27, s42, 1024
    s_add_u32 m0, s98, 11264
    s_nop 0
    buffer_load_dwordx4 v13, s[32:35], s27 offen sc1 lds
    s_add_u32 s27, s42, 2048
    s_add_u32 m0, s98, 12288
    s_nop 0
    buffer_load_dwordx4 v13, s[32:35], s27 offen sc1 lds
    s_add_u32 s27, s42, 3072
    s_add_u32 m0, s98, 13312
    s_nop 0
    buffer_load_dwordx4 v13, s[32:35], s27 offen sc1 lds
    s_add_u32 s27, s42, 4096
    s_add_u32 m0, s98, 14336
    s_nop 0
    buffer_load_dwordx4 v13, s[32:35], s27 offen sc1 lds
    s_add_u32 s27, s43, 0
    s_add_u32 m0, s98, 15360
    s_nop 0
    buffer_load_dwordx4 v13, s[32:35], s27 offen sc1 lds
    s_add_u32 s27, s43, 1024
    s_add_u32 m0, s98, 16384
    s_nop 0
    buffer_load_dwordx4 v13, s[32:35], s27 offen sc1 lds
    s_add_u32 s27, s43, 2048
    s_add_u32 m0, s98, 17408
    s_nop 0
    buffer_load_dwordx4 v13, s[32:35], s27 offen sc1 lds
    s_add_u32 s27, s43, 3072
    s_add_u32 m0, s98, 18432
    s_nop 0
    buffer_load_dwordx4 v13, s[32:35], s27 offen sc1 lds
    s_add_u32 s27, s43, 4096
    s_add_u32 m0, s98, 19456
    s_nop 0
    buffer_load_dwordx4 v13, s[32:35], s27 offen sc1 lds
    s_add_u32 s27, s44, 0
    s_add_u32 m0, s98, 20480
    s_nop 0
    buffer_load_dwordx4 v13, s[32:35], s27 offen sc1 lds
    s_add_u32 s27, s44, 1024
    s_add_u32 m0, s98, 21504
    s_nop 0
    buffer_load_dwordx4 v13, s[32:35], s27 offen sc1 lds
    s_add_u32 s27, s44, 2048
    s_add_u32 m0, s98, 22528
    s_nop 0
    buffer_load_dwordx4 v13, s[32:35], s27 offen sc1 lds
    s_add_u32 s27, s44, 3072
    s_add_u32 m0, s98, 23552
    s_nop 0
    buffer_load_dwordx4 v13, s[32:35], s27 offen sc1 lds
    s_add_u32 s27, s44, 4096
    s_add_u32 m0, s98, 24576
    s_nop 0
    buffer_load_dwordx4 v13, s[32:35], s27 offen sc1 lds
    s_waitcnt vmcnt(0)
    s_barrier
    s_branch L_voteok_31
L_end:
    s_endpgm
.section .rodata,"a"
.p2align 6
.amdhsa_kernel adaLN_cond__grouped_kv_mqa__glu_gated_geglu__prompt_kernel
  .amdhsa_next_free_vgpr 512
  .amdhsa_next_free_sgpr 102
  .amdhsa_accum_offset 256
  .amdhsa_group_segment_fixed_size 0
  .amdhsa_kernarg_size 112
  .amdhsa_user_sgpr_count 2
  .amdhsa_user_sgpr_kernarg_segment_ptr 1
  .amdhsa_system_sgpr_workgroup_id_x 1
  .amdhsa_float_denorm_mode_32 3
.end_amdhsa_kernel
```
